```python
import torch

def _softmax(x, axis=-1):
    return torch.softmax(x, dim=axis)
def _gelu(x):
    return torch.nn.functional.gelu(x, approximate="tanh")
def _silu(x):
    return torch.nn.functional.silu(x)
def _sigmoid(x):
    return torch.sigmoid(x)
def _layernorm(x, axis=-1, eps=1e-5):
    m = x.mean(dim=axis, keepdim=True)
    v = x.var(dim=axis, keepdim=True, unbiased=False)
    return (x - m) / torch.sqrt(v + eps)
def _scatter_add(tgt, idx, src, axis=0):
    return tgt.clone().index_add_(axis, idx, src)
def _segment_sum(src, seg, n):
    out = torch.zeros((n,) + src.shape[1:], dtype=src.dtype)
    return out.index_add_(0, seg, src)
def _pad(x, pw):
    flat = tuple(v for pair in reversed(pw) for v in pair)
    return torch.nn.functional.pad(x, flat)

kernel_name = 'concat_heads__gqa_block_cached__mha_block_cached__near_ridge'

def setup_inputs():

    _w = (lambda a: (lambda t: t.to(torch.bfloat16) if t.is_floating_point() else t)(torch.as_tensor(a)))
    def _A_setup():
        B, Sq, D = 8, 96, 512
        Hq, Hkv, Sk, Dh = 32, 32, 512, 128
        assert Hq % Hkv == 0, (Hq, Hkv)
        return {
            "x": _w((lambda *s: torch.randn(*s, dtype=torch.bfloat16) * 0.8)(B, Sq, D)),
            "k_cache": _w((lambda *s: torch.randn(*s, dtype=torch.bfloat16) * 0.8)(B, Hkv, Sk, Dh)),
            "v_cache": _w((lambda *s: torch.randn(*s, dtype=torch.bfloat16) * 0.05)(B, Hkv, Sk, Dh)),
            "wq": _w((lambda *s: torch.randn(*s, dtype=torch.bfloat16) * 0.8)(D, Hq * Dh) * (D ** -0.5)),
            "wo": _w((lambda *s: torch.randn(*s, dtype=torch.bfloat16) * 0.05)(Hq * Dh, D) * ((Hq * Dh) ** -0.5)),
        }
    _A_in = _A_setup()

    def _B_setup():
        B, Sq, D = 8, 96, 512
        H, Sk, Dh = 32, 512, 128
        return {
            "x": _w((lambda *s: torch.randn(*s, dtype=torch.bfloat16) * 0.8)(B, Sq, D)),
            "k_cache": _w((lambda *s: torch.randn(*s, dtype=torch.bfloat16) * 0.8)(B, H, Sk, Dh)),
            "v_cache": _w((lambda *s: torch.randn(*s, dtype=torch.bfloat16) * 0.05)(B, H, Sk, Dh)),
            "wq": _w((lambda *s: torch.randn(*s, dtype=torch.bfloat16) * 0.8)(D, H * Dh) * (D ** -0.5)),
            "wo": _w((lambda *s: torch.randn(*s, dtype=torch.bfloat16) * 0.05)(H * Dh, D) * ((H * Dh) ** -0.5)),
        }
    _B_in = _B_setup()

    return {
        "A_x": _A_in["x"],
        "A_k_cache": _A_in["k_cache"],
        "A_v_cache": _A_in["v_cache"],
        "A_wq": _A_in["wq"],
        "A_wo": _A_in["wo"],
        "B_x": _B_in["x"],
        "B_k_cache": _B_in["k_cache"],
        "B_v_cache": _B_in["v_cache"],
        "B_wq": _B_in["wq"],
        "B_wo": _B_in["wo"],
    }

def reference(A_x, A_k_cache, A_v_cache, A_wq, A_wo, B_x, B_k_cache, B_v_cache, B_wq, B_wo):
    def _A_ref(x, k_cache, v_cache, wq, wo):
        B, Sq, D = x.shape
        Hq, Dh = 32, 128
        Hkv = k_cache.shape[1]
        rep = Hq // Hkv
        q = (lambda x, *d: x.permute(*d))((x @ wq).reshape(B, Sq, Hq, Dh), 0, 2, 1, 3)
        k = (lambda x, n, axis: torch.repeat_interleave(x, n, dim=axis))(k_cache, rep, axis=1)
        v = (lambda x, n, axis: torch.repeat_interleave(x, n, dim=axis))(v_cache, rep, axis=1)
        scores = torch.einsum("bhqd,bhkd->bhqk", q, k) * (Dh ** -0.5)
        p = _softmax(scores, axis=-1)
        o = torch.einsum("bhqk,bhkd->bhqd", p, v)
        return (lambda x, *d: x.permute(*d))(o, 0, 2, 1, 3).reshape(B, Sq, Hq * Dh) @ wo

    def _B_ref(x, k_cache, v_cache, wq, wo):
        B, Sq, D = x.shape
        H, Dh = 32, 128
        q = (lambda x, *d: x.permute(*d))((x @ wq).reshape(B, Sq, H, Dh), 0, 2, 1, 3)
        scores = torch.einsum("bhqd,bhkd->bhqk", q, k_cache) * (Dh ** -0.5)
        p = _softmax(scores, axis=-1)
        o = torch.einsum("bhqk,bhkd->bhqd", p, v_cache)
        return (lambda x, *d: x.permute(*d))(o, 0, 2, 1, 3).reshape(B, Sq, H * Dh) @ wo

    a = _A_ref(A_x, A_k_cache, A_v_cache, A_wq, A_wo)
    b = _B_ref(B_x, B_k_cache, B_v_cache, B_wq, B_wo)
    return torch.concatenate([a, b], axis=-1)
```

```asm
; @launch grid=(256,1,1) block=(256,1,1) lds=163840
.amdgcn_target "amdgcn-amd-amdhsa--gfx950"
.text
.globl concat_heads__gqa_block_cached__mha_block_cached__near_ridge_kernel
.p2align 8
.type concat_heads__gqa_block_cached__mha_block_cached__near_ridge_kernel,@function
concat_heads__gqa_block_cached__mha_block_cached__near_ridge_kernel:
    s_cmp_ge_u32 s2, 256
    s_cbranch_scc1 L_end
    s_and_b32 s3, s2, 7
    s_lshr_b32 s34, s2, 3
    s_lshr_b32 s35, s3, 2
    s_mul_i32 s36, s35, 40
    s_add_u32 s38, s0, s36
    s_addc_u32 s39, s1, 0
    s_load_dwordx8 s[40:47], s[38:39], 0
    s_load_dwordx2 s[48:49], s[0:1], 96
    v_lshrrev_b32 v32, 6, v0
    s_and_b32 s36, s3, 3
    v_readfirstlane_b32 s24, v32
    s_lshl_b32 s36, s36, 1
    s_lshr_b32 s37, s34, 3
    s_lshl_b32 s37, s37, 3
    s_add_u32 s36, s36, s37
    s_and_b32 s37, s34, 7
    s_lshl_b32 s25, s37, 5
    s_add_u32 s25, s25, s36
    s_lshl_b32 s50, s35, 8
    s_add_u32 s50, s50, s25
    s_mul_i32 s33, s50, 28672
    s_mul_i32 s50, s24, 6144
    s_add_u32 s33, s33, s50
    s_lshl_b32 s25, s25, 17
    s_lshl_b32 s50, s24, 13
    s_add_u32 s25, s25, s50
    s_lshl_b32 s28, s24, 15
    s_mul_i32 s30, s37, 98304
    s_lshl_b32 s31, s36, 8
    s_lshl_b32 s50, s24, 7
    s_add_u32 s31, s31, s50
    s_lshl_b32 s32, s24, 14
    s_lshl_b32 s27, s24, 10
    s_add_u32 s27, s27, 65536
    s_lshr_b32 s50, s34, 3
    s_add_u32 s50, s50, s37
    s_add_u32 s51, s50, 0
    s_and_b32 s51, s51, 3
    s_lshl_b32 s52, s51, 8
    s_add_u32 s52, s52, s30
    s_lshl_b32 s56, s51, 20
    s_add_u32 s56, s56, s31
    s_add_u32 s51, s50, 1
    s_and_b32 s51, s51, 3
    s_lshl_b32 s53, s51, 8
    s_add_u32 s53, s53, s30
    s_lshl_b32 s57, s51, 20
    s_add_u32 s57, s57, s31
    s_add_u32 s51, s50, 2
    s_and_b32 s51, s51, 3
    s_lshl_b32 s54, s51, 8
    s_add_u32 s54, s54, s30
    s_lshl_b32 s58, s51, 20
    s_add_u32 s58, s58, s31
    s_add_u32 s51, s50, 3
    s_and_b32 s51, s51, 3
    s_lshl_b32 s55, s51, 8
    s_add_u32 s55, s55, s30
    s_lshl_b32 s59, s51, 20
    s_add_u32 s59, s59, s31
    s_mov_b32 s50, 0
    s_add_u32 s51, s50, 0
    s_and_b32 s51, s51, 3
    s_lshl_b32 s51, s51, 15
    s_add_u32 s94, s25, s51
    s_add_u32 s51, s50, 1
    s_and_b32 s51, s51, 3
    s_lshl_b32 s51, s51, 15
    s_add_u32 s95, s25, s51
    s_add_u32 s51, s50, 2
    s_and_b32 s51, s51, 3
    s_lshl_b32 s51, s51, 15
    s_add_u32 s96, s25, s51
    s_add_u32 s51, s50, 3
    s_and_b32 s51, s51, 3
    s_lshl_b32 s51, s51, 15
    s_add_u32 s97, s25, s51
    v_mbcnt_lo_u32_b32 v33, -1, 0
    v_mbcnt_hi_u32_b32 v33, -1, v33
    v_lshrrev_b32 v34, 4, v33
    v_and_b32 v35, 15, v33
    v_lshrrev_b32 v36, 5, v33
    v_and_b32 v37, 31, v33
    v_lshlrev_b32 v7, 4, v33
    s_lshl_b32 s50, s24, 2
    v_add_u32 v39, s50, v34
    v_xor_b32 v40, v35, v39
    v_lshlrev_b32 v40, 4, v40
    v_lshl_add_u32 v9, v39, 10, v40
    v_lshrrev_b32 v39, 3, v33
    v_and_b32 v40, 7, v33
    v_and_b32 v41, 1, v34
    v_lshlrev_b32 v41, 2, v41
    v_xor_b32 v40, v40, v41
    v_lshlrev_b32 v40, 4, v40
    v_lshl_add_u32 v8, v39, 13, v40
    v_add_u32 v39, 0, v34
    v_xor_b32 v39, v35, v39
    v_lshlrev_b32 v39, 4, v39
    v_lshl_add_u32 v2, v34, 8, v39
    v_add_u32 v39, 4, v34
    v_xor_b32 v39, v35, v39
    v_lshlrev_b32 v39, 4, v39
    v_lshl_add_u32 v3, v34, 8, v39
    v_add_u32 v39, 8, v34
    v_xor_b32 v39, v35, v39
    v_lshlrev_b32 v39, 4, v39
    v_lshl_add_u32 v4, v34, 8, v39
    v_add_u32 v39, 12, v34
    v_xor_b32 v39, v35, v39
    v_lshlrev_b32 v39, 4, v39
    v_lshl_add_u32 v5, v34, 8, v39
    v_lshlrev_b32 v28, 7, v33
    s_waitcnt lgkmcnt(0)
    s_mov_b32 s4, s40
    s_mov_b32 s5, s41
    s_mov_b32 s6, 786432
    s_mov_b32 s7, 0x20000
    s_mov_b32 s8, s46
    s_mov_b32 s9, s47
    s_mov_b32 s10, 4194304
    s_mov_b32 s11, 0x20000
    s_mov_b32 s12, s42
    s_mov_b32 s13, s43
    s_mov_b32 s14, 33554432
    s_mov_b32 s15, 0x20000
    s_mov_b32 s16, s44
    s_mov_b32 s17, s45
    s_mov_b32 s18, 33554432
    s_mov_b32 s19, 0x20000
    s_mov_b32 s20, s48
    s_mov_b32 s21, s49
    s_mov_b32 s22, 14680064
    s_mov_b32 s23, 0x20000
    s_load_dwordx2 s[40:41], s[38:39], 32
    s_load_dwordx4 s[44:47], s[0:1], 80
    s_lshr_b32 s61, s34, 3
    s_lshl_b32 s61, s61, 1
    s_add_u32 s61, s61, s3
    s_and_b32 s61, s61, 7
    s_cmp_lg_u32 s61, 0
    s_cbranch_scc1 L_kb_1
    s_add_u32 s60, s94, 0
    buffer_load_dwordx4 v[192:195], v2, s[12:15], s60 offen offset:0 nt
    buffer_load_dwordx4 v[196:199], v3, s[12:15], s60 offen offset:1024 nt
    buffer_load_dwordx4 v[200:203], v4, s[12:15], s60 offen offset:2048 nt
    buffer_load_dwordx4 v[204:207], v5, s[12:15], s60 offen offset:3072 nt
    s_add_u32 s60, s94, 4096
    buffer_load_dwordx4 v[208:211], v2, s[12:15], s60 offen offset:0 nt
    buffer_load_dwordx4 v[212:215], v3, s[12:15], s60 offen offset:1024 nt
    buffer_load_dwordx4 v[216:219], v4, s[12:15], s60 offen offset:2048 nt
    buffer_load_dwordx4 v[220:223], v5, s[12:15], s60 offen offset:3072 nt
    s_add_u32 s60, s95, 0
    buffer_load_dwordx4 v[224:227], v2, s[12:15], s60 offen offset:0 nt
    buffer_load_dwordx4 v[228:231], v3, s[12:15], s60 offen offset:1024 nt
    buffer_load_dwordx4 v[232:235], v4, s[12:15], s60 offen offset:2048 nt
    buffer_load_dwordx4 v[236:239], v5, s[12:15], s60 offen offset:3072 nt
    s_add_u32 s60, s95, 4096
    buffer_load_dwordx4 v[240:243], v2, s[12:15], s60 offen offset:0 nt
    buffer_load_dwordx4 v[244:247], v3, s[12:15], s60 offen offset:1024 nt
    buffer_load_dwordx4 v[248:251], v4, s[12:15], s60 offen offset:2048 nt
    buffer_load_dwordx4 v[252:255], v5, s[12:15], s60 offen offset:3072 nt
    s_add_u32 s60, s96, 0
    buffer_load_dwordx4 a[192:195], v2, s[12:15], s60 offen offset:0 nt
    buffer_load_dwordx4 a[196:199], v3, s[12:15], s60 offen offset:1024 nt
    buffer_load_dwordx4 a[200:203], v4, s[12:15], s60 offen offset:2048 nt
    buffer_load_dwordx4 a[204:207], v5, s[12:15], s60 offen offset:3072 nt
    s_add_u32 s60, s96, 4096
    buffer_load_dwordx4 a[208:211], v2, s[12:15], s60 offen offset:0 nt
    buffer_load_dwordx4 a[212:215], v3, s[12:15], s60 offen offset:1024 nt
    buffer_load_dwordx4 a[216:219], v4, s[12:15], s60 offen offset:2048 nt
    buffer_load_dwordx4 a[220:223], v5, s[12:15], s60 offen offset:3072 nt
L_kb_1:
    s_add_u32 m0, s27, 0
    s_add_u32 s26, s52, 0
    buffer_load_dwordx4 v9, s[4:7], s26 offen lds
    s_add_u32 m0, s27, 4096
    s_add_u32 s26, s52, 16384
    buffer_load_dwordx4 v9, s[4:7], s26 offen lds
    s_add_u32 m0, s27, 8192
    s_add_u32 s26, s52, 32768
    buffer_load_dwordx4 v9, s[4:7], s26 offen lds
    s_add_u32 m0, s27, 12288
    s_add_u32 s26, s52, 49152
    buffer_load_dwordx4 v9, s[4:7], s26 offen lds
    s_add_u32 m0, s27, 16384
    s_add_u32 s26, s52, 65536
    buffer_load_dwordx4 v9, s[4:7], s26 offen lds
    s_add_u32 m0, s27, 20480
    s_add_u32 s26, s52, 81920
    buffer_load_dwordx4 v9, s[4:7], s26 offen lds
    s_add_u32 m0, s32, 0
    s_add_u32 s26, s56, 0
    buffer_load_dwordx4 v8, s[8:11], s26 offen lds
    s_add_u32 m0, s32, 1024
    s_add_u32 s26, s56, 65536
    buffer_load_dwordx4 v8, s[8:11], s26 offen lds
    v_lshlrev_b32 v39, 2, v34
    v_xor_b32 v39, v35, v39
    v_lshlrev_b32 v39, 4, v39
    v_lshl_add_u32 v6, v34, 8, v39
    v_add_u32 v1, s28, v7
    v_add_u32 v39, 0, v36
    v_xor_b32 v39, v35, v39
    v_lshlrev_b32 v39, 4, v39
    v_lshl_add_u32 v39, v37, 8, v39
    v_add_u32 v12, 65536, v39
    v_add_u32 v39, 2, v36
    v_xor_b32 v39, v35, v39
    v_lshlrev_b32 v39, 4, v39
    v_lshl_add_u32 v39, v37, 8, v39
    v_add_u32 v13, 65536, v39
    v_add_u32 v39, 4, v36
    v_xor_b32 v39, v35, v39
    v_lshlrev_b32 v39, 4, v39
    v_lshl_add_u32 v39, v37, 8, v39
    v_add_u32 v14, 65536, v39
    v_add_u32 v39, 6, v36
    v_xor_b32 v39, v35, v39
    v_lshlrev_b32 v39, 4, v39
    v_lshl_add_u32 v39, v37, 8, v39
    v_add_u32 v15, 65536, v39
    v_add_u32 v39, 8, v36
    v_xor_b32 v39, v35, v39
    v_lshlrev_b32 v39, 4, v39
    v_lshl_add_u32 v39, v37, 8, v39
    v_add_u32 v16, 65536, v39
    v_add_u32 v39, 10, v36
    v_xor_b32 v39, v35, v39
    v_lshlrev_b32 v39, 4, v39
    v_lshl_add_u32 v39, v37, 8, v39
    v_add_u32 v17, 65536, v39
    v_add_u32 v39, 12, v36
    v_xor_b32 v39, v35, v39
    v_lshlrev_b32 v39, 4, v39
    v_lshl_add_u32 v39, v37, 8, v39
    v_add_u32 v18, 65536, v39
    v_add_u32 v39, 14, v36
    v_xor_b32 v39, v35, v39
    v_lshlrev_b32 v39, 4, v39
    v_lshl_add_u32 v39, v37, 8, v39
    v_add_u32 v19, 65536, v39
    v_lshrrev_b32 v39, 2, v35
    v_lshl_add_u32 v40, v36, 3, v39
    v_lshlrev_b32 v40, 7, v40
    v_lshrrev_b32 v41, 3, v35
    v_lshl_add_u32 v40, v41, 6, v40
    v_and_b32 v41, 1, v34
    v_lshl_add_u32 v40, v41, 5, v40
    v_and_b32 v42, 3, v35
    v_lshl_add_u32 v40, v42, 3, v40
    v_add_u32 v20, s32, v40
    v_xor_b32 v21, 64, v20
    v_lshl_add_u32 v40, v36, 2, v39
    v_lshlrev_b32 v40, 8, v40
    v_xor_b32 v43, s24, v39
    v_lshl_add_u32 v40, v43, 6, v40
    v_lshl_add_u32 v40, v41, 5, v40
    v_lshl_add_u32 v22, v42, 3, v40
    v_add_u32 v23, 0x10000, v22
    s_mul_i32 s50, s24, 3072
    s_add_u32 s50, s50, 131072
    v_add_u32 v24, s50, v7
    v_add_u32 v25, 131072, v7
    v_lshlrev_b32 v40, 4, v37
    v_add_u32 v27, 155648, v40
    s_lshl_b32 s50, s24, 2
    v_add_u32 v26, s50, v27
    v_lshlrev_b32 v40, 4, v37
    v_lshl_add_u32 v40, v36, 3, v40
    s_mul_i32 s50, s24, 12288
    s_add_u32 s50, s50, 106496
    s_add_u32 s51, s50, 8192
    s_add_u32 s26, s28, 65536
    s_cmp_lt_u32 s24, 2
    s_cselect_b32 s50, s28, s50
    s_cselect_b32 s51, s26, s51
    v_add_u32 v10, s50, v40
    v_add_u32 v11, s51, v40
    v_add_u32 v31, 0x10000, v7
    s_mov_b32 s42, 0x3e0293ee
    s_mov_b32 s43, 0x3e0293ee
    s_waitcnt lgkmcnt(0)
    s_or_b32 s50, s2, s24
    s_cmp_lg_u32 s50, 0
    s_cbranch_scc1 L_nonce_2
    s_memrealtime s[50:51]
    s_waitcnt lgkmcnt(0)
    s_or_b32 s50, s50, 1
    v_mov_b32 v39, 0
    v_mov_b32 v40, s50
    global_store_dword v39, v40, s[46:47] sc1
L_nonce_2:
    s_add_u32 m0, s32, 2048
    s_add_u32 s26, s56, 131072
    buffer_load_dwordx4 v8, s[8:11], s26 offen lds
    s_add_u32 m0, s32, 3072
    s_add_u32 s26, s56, 196608
    buffer_load_dwordx4 v8, s[8:11], s26 offen lds
    s_add_u32 m0, s27, 24576
    s_add_u32 s26, s53, 0
    buffer_load_dwordx4 v9, s[4:7], s26 offen lds
    s_add_u32 m0, s32, 4096
    s_add_u32 s26, s56, 262144
    buffer_load_dwordx4 v8, s[8:11], s26 offen lds
    s_add_u32 m0, s32, 5120
    s_add_u32 s26, s56, 327680
    buffer_load_dwordx4 v8, s[8:11], s26 offen lds
    s_add_u32 m0, s27, 28672
    s_add_u32 s26, s53, 16384
    buffer_load_dwordx4 v9, s[4:7], s26 offen lds
    s_cmp_lg_u32 s61, 1
    s_cbranch_scc1 L_kb_3
    s_add_u32 s60, s94, 0
    buffer_load_dwordx4 v[192:195], v2, s[12:15], s60 offen offset:0 nt
    buffer_load_dwordx4 v[196:199], v3, s[12:15], s60 offen offset:1024 nt
    buffer_load_dwordx4 v[200:203], v4, s[12:15], s60 offen offset:2048 nt
    buffer_load_dwordx4 v[204:207], v5, s[12:15], s60 offen offset:3072 nt
    s_add_u32 s60, s94, 4096
    buffer_load_dwordx4 v[208:211], v2, s[12:15], s60 offen offset:0 nt
    buffer_load_dwordx4 v[212:215], v3, s[12:15], s60 offen offset:1024 nt
    buffer_load_dwordx4 v[216:219], v4, s[12:15], s60 offen offset:2048 nt
    buffer_load_dwordx4 v[220:223], v5, s[12:15], s60 offen offset:3072 nt
    s_add_u32 s60, s95, 0
    buffer_load_dwordx4 v[224:227], v2, s[12:15], s60 offen offset:0 nt
    buffer_load_dwordx4 v[228:231], v3, s[12:15], s60 offen offset:1024 nt
    buffer_load_dwordx4 v[232:235], v4, s[12:15], s60 offen offset:2048 nt
    buffer_load_dwordx4 v[236:239], v5, s[12:15], s60 offen offset:3072 nt
    s_add_u32 s60, s95, 4096
    buffer_load_dwordx4 v[240:243], v2, s[12:15], s60 offen offset:0 nt
    buffer_load_dwordx4 v[244:247], v3, s[12:15], s60 offen offset:1024 nt
    buffer_load_dwordx4 v[248:251], v4, s[12:15], s60 offen offset:2048 nt
    buffer_load_dwordx4 v[252:255], v5, s[12:15], s60 offen offset:3072 nt
    s_add_u32 s60, s96, 0
    buffer_load_dwordx4 a[192:195], v2, s[12:15], s60 offen offset:0 nt
    buffer_load_dwordx4 a[196:199], v3, s[12:15], s60 offen offset:1024 nt
    buffer_load_dwordx4 a[200:203], v4, s[12:15], s60 offen offset:2048 nt
    buffer_load_dwordx4 a[204:207], v5, s[12:15], s60 offen offset:3072 nt
    s_add_u32 s60, s96, 4096
    buffer_load_dwordx4 a[208:211], v2, s[12:15], s60 offen offset:0 nt
    buffer_load_dwordx4 a[212:215], v3, s[12:15], s60 offen offset:1024 nt
    buffer_load_dwordx4 a[216:219], v4, s[12:15], s60 offen offset:2048 nt
    buffer_load_dwordx4 a[220:223], v5, s[12:15], s60 offen offset:3072 nt
L_kb_3:
    s_add_u32 m0, s32, 6144
    s_add_u32 s26, s56, 393216
    buffer_load_dwordx4 v8, s[8:11], s26 offen lds
    s_add_u32 m0, s32, 7168
    s_add_u32 s26, s56, 458752
    buffer_load_dwordx4 v8, s[8:11], s26 offen lds
    s_add_u32 m0, s27, 32768
    s_add_u32 s26, s53, 32768
    buffer_load_dwordx4 v9, s[4:7], s26 offen lds
    s_add_u32 m0, s32, 8192
    s_add_u32 s26, s56, 524288
    buffer_load_dwordx4 v8, s[8:11], s26 offen lds
    s_add_u32 m0, s32, 9216
    s_add_u32 s26, s56, 589824
    buffer_load_dwordx4 v8, s[8:11], s26 offen lds
    s_add_u32 m0, s27, 36864
    s_add_u32 s26, s53, 49152
    buffer_load_dwordx4 v9, s[4:7], s26 offen lds
    s_add_u32 m0, s32, 10240
    s_add_u32 s26, s56, 655360
    buffer_load_dwordx4 v8, s[8:11], s26 offen lds
    s_add_u32 m0, s32, 11264
    s_add_u32 s26, s56, 720896
    buffer_load_dwordx4 v8, s[8:11], s26 offen lds
    s_add_u32 m0, s27, 40960
    s_add_u32 s26, s53, 65536
    buffer_load_dwordx4 v9, s[4:7], s26 offen lds
    s_add_u32 m0, s32, 12288
    s_add_u32 s26, s56, 786432
    buffer_load_dwordx4 v8, s[8:11], s26 offen lds
    s_add_u32 m0, s32, 13312
    s_add_u32 s26, s56, 851968
    buffer_load_dwordx4 v8, s[8:11], s26 offen lds
    s_add_u32 m0, s27, 45056
    s_add_u32 s26, s53, 81920
    buffer_load_dwordx4 v9, s[4:7], s26 offen lds
    s_cmp_lg_u32 s61, 2
    s_cbranch_scc1 L_kb_4
    s_add_u32 s60, s94, 0
    buffer_load_dwordx4 v[192:195], v2, s[12:15], s60 offen offset:0 nt
    buffer_load_dwordx4 v[196:199], v3, s[12:15], s60 offen offset:1024 nt
    buffer_load_dwordx4 v[200:203], v4, s[12:15], s60 offen offset:2048 nt
    buffer_load_dwordx4 v[204:207], v5, s[12:15], s60 offen offset:3072 nt
    s_add_u32 s60, s94, 4096
    buffer_load_dwordx4 v[208:211], v2, s[12:15], s60 offen offset:0 nt
    buffer_load_dwordx4 v[212:215], v3, s[12:15], s60 offen offset:1024 nt
    buffer_load_dwordx4 v[216:219], v4, s[12:15], s60 offen offset:2048 nt
    buffer_load_dwordx4 v[220:223], v5, s[12:15], s60 offen offset:3072 nt
    s_add_u32 s60, s95, 0
    buffer_load_dwordx4 v[224:227], v2, s[12:15], s60 offen offset:0 nt
    buffer_load_dwordx4 v[228:231], v3, s[12:15], s60 offen offset:1024 nt
    buffer_load_dwordx4 v[232:235], v4, s[12:15], s60 offen offset:2048 nt
    buffer_load_dwordx4 v[236:239], v5, s[12:15], s60 offen offset:3072 nt
    s_add_u32 s60, s95, 4096
    buffer_load_dwordx4 v[240:243], v2, s[12:15], s60 offen offset:0 nt
    buffer_load_dwordx4 v[244:247], v3, s[12:15], s60 offen offset:1024 nt
    buffer_load_dwordx4 v[248:251], v4, s[12:15], s60 offen offset:2048 nt
    buffer_load_dwordx4 v[252:255], v5, s[12:15], s60 offen offset:3072 nt
    s_add_u32 s60, s96, 0
    buffer_load_dwordx4 a[192:195], v2, s[12:15], s60 offen offset:0 nt
    buffer_load_dwordx4 a[196:199], v3, s[12:15], s60 offen offset:1024 nt
    buffer_load_dwordx4 a[200:203], v4, s[12:15], s60 offen offset:2048 nt
    buffer_load_dwordx4 a[204:207], v5, s[12:15], s60 offen offset:3072 nt
    s_add_u32 s60, s96, 4096
    buffer_load_dwordx4 a[208:211], v2, s[12:15], s60 offen offset:0 nt
    buffer_load_dwordx4 a[212:215], v3, s[12:15], s60 offen offset:1024 nt
    buffer_load_dwordx4 a[216:219], v4, s[12:15], s60 offen offset:2048 nt
    buffer_load_dwordx4 a[220:223], v5, s[12:15], s60 offen offset:3072 nt
L_kb_4:
    s_waitcnt vmcnt(18)
    s_barrier
    ds_read_b64_tr_b16 v[32:33], v20 offset:0
    ds_read_b64_tr_b16 v[34:35], v20 offset:512
    ds_read_b128 v[40:43], v12 offset:0
    ds_read_b128 v[44:47], v12 offset:8192
    ds_read_b128 v[48:51], v12 offset:16384
    ds_read_b64_tr_b16 v[36:37], v21 offset:0
    ds_read_b64_tr_b16 v[38:39], v21 offset:512
    s_waitcnt lgkmcnt(4)
    v_mfma_f32_32x32x16_bf16 v[96:111], v[32:35], v[40:43], 0
    s_waitcnt vmcnt(16)
    ds_read_b64_tr_b16 v[52:53], v20 offset:2048
    ds_read_b64_tr_b16 v[54:55], v20 offset:2560
    s_waitcnt lgkmcnt(5)
    v_mfma_f32_32x32x16_bf16 v[112:127], v[32:35], v[44:47], 0
    ds_read_b128 v[60:63], v13 offset:0
    s_add_u32 m0, s32, 14336
    s_add_u32 s26, s56, 917504
    buffer_load_dwordx4 v8, s[8:11], s26 offen lds
    s_waitcnt lgkmcnt(5)
    v_mfma_f32_32x32x16_bf16 v[128:143], v[32:35], v[48:51], 0
    ds_read_b128 v[64:67], v13 offset:8192
    s_add_u32 m0, s32, 15360
    s_add_u32 s26, s56, 983040
    buffer_load_dwordx4 v8, s[8:11], s26 offen lds
    s_waitcnt lgkmcnt(4)
    v_mfma_f32_32x32x16_bf16 v[144:159], v[36:39], v[40:43], 0
    ds_read_b128 v[68:71], v13 offset:16384
    v_mfma_f32_32x32x16_bf16 v[160:175], v[36:39], v[44:47], 0
    ds_read_b64_tr_b16 v[56:57], v21 offset:2048
    ds_read_b64_tr_b16 v[58:59], v21 offset:2560
    v_mfma_f32_32x32x16_bf16 v[176:191], v[36:39], v[48:51], 0
    s_waitcnt lgkmcnt(4)
    v_mfma_f32_32x32x16_bf16 v[96:111], v[52:55], v[60:63], v[96:111]
    s_waitcnt vmcnt(15)
    ds_read_b64_tr_b16 v[32:33], v20 offset:4096
    ds_read_b64_tr_b16 v[34:35], v20 offset:4608
    s_waitcnt lgkmcnt(5)
    v_mfma_f32_32x32x16_bf16 v[112:127], v[52:55], v[64:67], v[112:127]
    ds_read_b128 v[40:43], v14 offset:0
    s_add_u32 m0, s32, 0
    s_add_u32 s26, s57, 0
    buffer_load_dwordx4 v8, s[8:11], s26 offen lds
    s_waitcnt lgkmcnt(5)
    v_mfma_f32_32x32x16_bf16 v[128:143], v[52:55], v[68:71], v[128:143]
    ds_read_b128 v[44:47], v14 offset:8192
    s_add_u32 m0, s32, 1024
    s_add_u32 s26, s57, 65536
    buffer_load_dwordx4 v8, s[8:11], s26 offen lds
    s_waitcnt lgkmcnt(4)
    v_mfma_f32_32x32x16_bf16 v[144:159], v[56:59], v[60:63], v[144:159]
    ds_read_b128 v[48:51], v14 offset:16384
    v_mfma_f32_32x32x16_bf16 v[160:175], v[56:59], v[64:67], v[160:175]
    ds_read_b64_tr_b16 v[36:37], v21 offset:4096
    ds_read_b64_tr_b16 v[38:39], v21 offset:4608
    v_mfma_f32_32x32x16_bf16 v[176:191], v[56:59], v[68:71], v[176:191]
    s_waitcnt lgkmcnt(4)
    v_mfma_f32_32x32x16_bf16 v[96:111], v[32:35], v[40:43], v[96:111]
    s_waitcnt vmcnt(14)
    ds_read_b64_tr_b16 v[52:53], v20 offset:6144
    ds_read_b64_tr_b16 v[54:55], v20 offset:6656
    s_waitcnt lgkmcnt(5)
    v_mfma_f32_32x32x16_bf16 v[112:127], v[32:35], v[44:47], v[112:127]
    ds_read_b128 v[60:63], v15 offset:0
    s_add_u32 m0, s32, 2048
    s_add_u32 s26, s57, 131072
    buffer_load_dwordx4 v8, s[8:11], s26 offen lds
    s_waitcnt lgkmcnt(5)
    v_mfma_f32_32x32x16_bf16 v[128:143], v[32:35], v[48:51], v[128:143]
    ds_read_b128 v[64:67], v15 offset:8192
    s_add_u32 m0, s32, 3072
    s_add_u32 s26, s57, 196608
    buffer_load_dwordx4 v8, s[8:11], s26 offen lds
    s_waitcnt lgkmcnt(4)
    v_mfma_f32_32x32x16_bf16 v[144:159], v[36:39], v[40:43], v[144:159]
    ds_read_b128 v[68:71], v15 offset:16384
    s_add_u32 m0, s27, 49152
    s_add_u32 s26, s54, 0
    buffer_load_dwordx4 v9, s[4:7], s26 offen lds
    v_mfma_f32_32x32x16_bf16 v[160:175], v[36:39], v[44:47], v[160:175]
    ds_read_b64_tr_b16 v[56:57], v21 offset:6144
    ds_read_b64_tr_b16 v[58:59], v21 offset:6656
    v_mfma_f32_32x32x16_bf16 v[176:191], v[36:39], v[48:51], v[176:191]
    s_waitcnt lgkmcnt(4)
    v_mfma_f32_32x32x16_bf16 v[96:111], v[52:55], v[60:63], v[96:111]
    s_waitcnt vmcnt(14)
    ds_read_b64_tr_b16 v[32:33], v20 offset:8192
    ds_read_b64_tr_b16 v[34:35], v20 offset:8704
    s_waitcnt lgkmcnt(5)
    v_mfma_f32_32x32x16_bf16 v[112:127], v[52:55], v[64:67], v[112:127]
    ds_read_b128 v[40:43], v16 offset:0
    s_add_u32 m0, s32, 4096
    s_add_u32 s26, s57, 262144
    buffer_load_dwordx4 v8, s[8:11], s26 offen lds
    s_waitcnt lgkmcnt(5)
    v_mfma_f32_32x32x16_bf16 v[128:143], v[52:55], v[68:71], v[128:143]
    ds_read_b128 v[44:47], v16 offset:8192
    s_add_u32 m0, s32, 5120
    s_add_u32 s26, s57, 327680
    buffer_load_dwordx4 v8, s[8:11], s26 offen lds
    s_waitcnt lgkmcnt(4)
    v_mfma_f32_32x32x16_bf16 v[144:159], v[56:59], v[60:63], v[144:159]
    ds_read_b128 v[48:51], v16 offset:16384
    s_add_u32 m0, s27, 53248
    s_add_u32 s26, s54, 16384
    buffer_load_dwordx4 v9, s[4:7], s26 offen lds
    v_mfma_f32_32x32x16_bf16 v[160:175], v[56:59], v[64:67], v[160:175]
    ds_read_b64_tr_b16 v[36:37], v21 offset:8192
    ds_read_b64_tr_b16 v[38:39], v21 offset:8704
    v_mfma_f32_32x32x16_bf16 v[176:191], v[56:59], v[68:71], v[176:191]
    s_cmp_lg_u32 s61, 3
    s_cbranch_scc1 L_kb_5
    s_add_u32 s60, s94, 0
    buffer_load_dwordx4 v[192:195], v2, s[12:15], s60 offen offset:0 nt
    buffer_load_dwordx4 v[196:199], v3, s[12:15], s60 offen offset:1024 nt
    buffer_load_dwordx4 v[200:203], v4, s[12:15], s60 offen offset:2048 nt
    buffer_load_dwordx4 v[204:207], v5, s[12:15], s60 offen offset:3072 nt
    s_add_u32 s60, s94, 4096
    buffer_load_dwordx4 v[208:211], v2, s[12:15], s60 offen offset:0 nt
    buffer_load_dwordx4 v[212:215], v3, s[12:15], s60 offen offset:1024 nt
    buffer_load_dwordx4 v[216:219], v4, s[12:15], s60 offen offset:2048 nt
    buffer_load_dwordx4 v[220:223], v5, s[12:15], s60 offen offset:3072 nt
    s_add_u32 s60, s95, 0
    buffer_load_dwordx4 v[224:227], v2, s[12:15], s60 offen offset:0 nt
    buffer_load_dwordx4 v[228:231], v3, s[12:15], s60 offen offset:1024 nt
    buffer_load_dwordx4 v[232:235], v4, s[12:15], s60 offen offset:2048 nt
    buffer_load_dwordx4 v[236:239], v5, s[12:15], s60 offen offset:3072 nt
    s_add_u32 s60, s95, 4096
    buffer_load_dwordx4 v[240:243], v2, s[12:15], s60 offen offset:0 nt
    buffer_load_dwordx4 v[244:247], v3, s[12:15], s60 offen offset:1024 nt
    buffer_load_dwordx4 v[248:251], v4, s[12:15], s60 offen offset:2048 nt
    buffer_load_dwordx4 v[252:255], v5, s[12:15], s60 offen offset:3072 nt
    s_add_u32 s60, s96, 0
    buffer_load_dwordx4 a[192:195], v2, s[12:15], s60 offen offset:0 nt
    buffer_load_dwordx4 a[196:199], v3, s[12:15], s60 offen offset:1024 nt
    buffer_load_dwordx4 a[200:203], v4, s[12:15], s60 offen offset:2048 nt
    buffer_load_dwordx4 a[204:207], v5, s[12:15], s60 offen offset:3072 nt
    s_add_u32 s60, s96, 4096
    buffer_load_dwordx4 a[208:211], v2, s[12:15], s60 offen offset:0 nt
    buffer_load_dwordx4 a[212:215], v3, s[12:15], s60 offen offset:1024 nt
    buffer_load_dwordx4 a[216:219], v4, s[12:15], s60 offen offset:2048 nt
    buffer_load_dwordx4 a[220:223], v5, s[12:15], s60 offen offset:3072 nt
L_kb_5:
    s_waitcnt lgkmcnt(4)
    v_mfma_f32_32x32x16_bf16 v[96:111], v[32:35], v[40:43], v[96:111]
    s_waitcnt vmcnt(14)
    ds_read_b64_tr_b16 v[52:53], v20 offset:10240
    ds_read_b64_tr_b16 v[54:55], v20 offset:10752
    s_waitcnt lgkmcnt(5)
    v_mfma_f32_32x32x16_bf16 v[112:127], v[32:35], v[44:47], v[112:127]
    ds_read_b128 v[60:63], v17 offset:0
    s_add_u32 m0, s32, 6144
    s_add_u32 s26, s57, 393216
    buffer_load_dwordx4 v8, s[8:11], s26 offen lds
    s_waitcnt lgkmcnt(5)
    v_mfma_f32_32x32x16_bf16 v[128:143], v[32:35], v[48:51], v[128:143]
    ds_read_b128 v[64:67], v17 offset:8192
    s_add_u32 m0, s32, 7168
    s_add_u32 s26, s57, 458752
    buffer_load_dwordx4 v8, s[8:11], s26 offen lds
    s_waitcnt lgkmcnt(4)
    v_mfma_f32_32x32x16_bf16 v[144:159], v[36:39], v[40:43], v[144:159]
    ds_read_b128 v[68:71], v17 offset:16384
    s_add_u32 m0, s27, 57344
    s_add_u32 s26, s54, 32768
    buffer_load_dwordx4 v9, s[4:7], s26 offen lds
    v_mfma_f32_32x32x16_bf16 v[160:175], v[36:39], v[44:47], v[160:175]
    ds_read_b64_tr_b16 v[56:57], v21 offset:10240
    ds_read_b64_tr_b16 v[58:59], v21 offset:10752
    v_mfma_f32_32x32x16_bf16 v[176:191], v[36:39], v[48:51], v[176:191]
    s_waitcnt lgkmcnt(4)
    v_mfma_f32_32x32x16_bf16 v[96:111], v[52:55], v[60:63], v[96:111]
    s_waitcnt vmcnt(14)
    ds_read_b64_tr_b16 v[32:33], v20 offset:12288
    ds_read_b64_tr_b16 v[34:35], v20 offset:12800
    s_waitcnt lgkmcnt(5)
    v_mfma_f32_32x32x16_bf16 v[112:127], v[52:55], v[64:67], v[112:127]
    ds_read_b128 v[40:43], v18 offset:0
    s_add_u32 m0, s32, 8192
    s_add_u32 s26, s57, 524288
    buffer_load_dwordx4 v8, s[8:11], s26 offen lds
    s_waitcnt lgkmcnt(5)
    v_mfma_f32_32x32x16_bf16 v[128:143], v[52:55], v[68:71], v[128:143]
    ds_read_b128 v[44:47], v18 offset:8192
    s_add_u32 m0, s32, 9216
    s_add_u32 s26, s57, 589824
    buffer_load_dwordx4 v8, s[8:11], s26 offen lds
    s_waitcnt lgkmcnt(4)
    v_mfma_f32_32x32x16_bf16 v[144:159], v[56:59], v[60:63], v[144:159]
    ds_read_b128 v[48:51], v18 offset:16384
    s_add_u32 m0, s27, 61440
    s_add_u32 s26, s54, 49152
    buffer_load_dwordx4 v9, s[4:7], s26 offen lds
    v_mfma_f32_32x32x16_bf16 v[160:175], v[56:59], v[64:67], v[160:175]
    ds_read_b64_tr_b16 v[36:37], v21 offset:12288
    ds_read_b64_tr_b16 v[38:39], v21 offset:12800
    v_mfma_f32_32x32x16_bf16 v[176:191], v[56:59], v[68:71], v[176:191]
    s_waitcnt lgkmcnt(4)
    v_mfma_f32_32x32x16_bf16 v[96:111], v[32:35], v[40:43], v[96:111]
    s_waitcnt vmcnt(14)
    ds_read_b64_tr_b16 v[52:53], v20 offset:14336
    ds_read_b64_tr_b16 v[54:55], v20 offset:14848
    s_waitcnt lgkmcnt(5)
    v_mfma_f32_32x32x16_bf16 v[112:127], v[32:35], v[44:47], v[112:127]
    ds_read_b128 v[60:63], v19 offset:0
    s_add_u32 m0, s32, 10240
    s_add_u32 s26, s57, 655360
    buffer_load_dwordx4 v8, s[8:11], s26 offen lds
    s_waitcnt lgkmcnt(5)
    v_mfma_f32_32x32x16_bf16 v[128:143], v[32:35], v[48:51], v[128:143]
    ds_read_b128 v[64:67], v19 offset:8192
    s_add_u32 m0, s32, 11264
    s_add_u32 s26, s57, 720896
    buffer_load_dwordx4 v8, s[8:11], s26 offen lds
    s_waitcnt lgkmcnt(4)
    v_mfma_f32_32x32x16_bf16 v[144:159], v[36:39], v[40:43], v[144:159]
    ds_read_b128 v[68:71], v19 offset:16384
    s_add_u32 m0, s27, 65536
    s_add_u32 s26, s54, 65536
    buffer_load_dwordx4 v9, s[4:7], s26 offen lds
    v_mfma_f32_32x32x16_bf16 v[160:175], v[36:39], v[44:47], v[160:175]
    ds_read_b64_tr_b16 v[56:57], v21 offset:14336
    ds_read_b64_tr_b16 v[58:59], v21 offset:14848
    v_mfma_f32_32x32x16_bf16 v[176:191], v[36:39], v[48:51], v[176:191]
    s_waitcnt lgkmcnt(4)
    v_mfma_f32_32x32x16_bf16 v[96:111], v[52:55], v[60:63], v[96:111]
    s_waitcnt vmcnt(15)
    s_barrier
    ds_read_b64_tr_b16 v[32:33], v20 offset:0
    ds_read_b64_tr_b16 v[34:35], v20 offset:512
    s_waitcnt lgkmcnt(5)
    v_mfma_f32_32x32x16_bf16 v[112:127], v[52:55], v[64:67], v[112:127]
    ds_read_b128 v[40:43], v12 offset:24576
    s_add_u32 m0, s32, 12288
    s_add_u32 s26, s57, 786432
    buffer_load_dwordx4 v8, s[8:11], s26 offen lds
    s_waitcnt lgkmcnt(5)
    v_mfma_f32_32x32x16_bf16 v[128:143], v[52:55], v[68:71], v[128:143]
    ds_read_b128 v[44:47], v12 offset:32768
    s_add_u32 m0, s32, 13312
    s_add_u32 s26, s57, 851968
    buffer_load_dwordx4 v8, s[8:11], s26 offen lds
    s_waitcnt lgkmcnt(4)
    v_mfma_f32_32x32x16_bf16 v[144:159], v[56:59], v[60:63], v[144:159]
    ds_read_b128 v[48:51], v12 offset:40960
    s_add_u32 m0, s27, 69632
    s_add_u32 s26, s54, 81920
    buffer_load_dwordx4 v9, s[4:7], s26 offen lds
    v_mfma_f32_32x32x16_bf16 v[160:175], v[56:59], v[64:67], v[160:175]
    ds_read_b64_tr_b16 v[36:37], v21 offset:0
    ds_read_b64_tr_b16 v[38:39], v21 offset:512
    v_mfma_f32_32x32x16_bf16 v[176:191], v[56:59], v[68:71], v[176:191]
    s_cmp_lg_u32 s61, 4
    s_cbranch_scc1 L_kb_6
    s_add_u32 s60, s94, 0
    buffer_load_dwordx4 v[192:195], v2, s[12:15], s60 offen offset:0 nt
    buffer_load_dwordx4 v[196:199], v3, s[12:15], s60 offen offset:1024 nt
    buffer_load_dwordx4 v[200:203], v4, s[12:15], s60 offen offset:2048 nt
    buffer_load_dwordx4 v[204:207], v5, s[12:15], s60 offen offset:3072 nt
    s_add_u32 s60, s94, 4096
    buffer_load_dwordx4 v[208:211], v2, s[12:15], s60 offen offset:0 nt
    buffer_load_dwordx4 v[212:215], v3, s[12:15], s60 offen offset:1024 nt
    buffer_load_dwordx4 v[216:219], v4, s[12:15], s60 offen offset:2048 nt
    buffer_load_dwordx4 v[220:223], v5, s[12:15], s60 offen offset:3072 nt
    s_add_u32 s60, s95, 0
    buffer_load_dwordx4 v[224:227], v2, s[12:15], s60 offen offset:0 nt
    buffer_load_dwordx4 v[228:231], v3, s[12:15], s60 offen offset:1024 nt
    buffer_load_dwordx4 v[232:235], v4, s[12:15], s60 offen offset:2048 nt
    buffer_load_dwordx4 v[236:239], v5, s[12:15], s60 offen offset:3072 nt
    s_add_u32 s60, s95, 4096
    buffer_load_dwordx4 v[240:243], v2, s[12:15], s60 offen offset:0 nt
    buffer_load_dwordx4 v[244:247], v3, s[12:15], s60 offen offset:1024 nt
    buffer_load_dwordx4 v[248:251], v4, s[12:15], s60 offen offset:2048 nt
    buffer_load_dwordx4 v[252:255], v5, s[12:15], s60 offen offset:3072 nt
    s_add_u32 s60, s96, 0
    buffer_load_dwordx4 a[192:195], v2, s[12:15], s60 offen offset:0 nt
    buffer_load_dwordx4 a[196:199], v3, s[12:15], s60 offen offset:1024 nt
    buffer_load_dwordx4 a[200:203], v4, s[12:15], s60 offen offset:2048 nt
    buffer_load_dwordx4 a[204:207], v5, s[12:15], s60 offen offset:3072 nt
    s_add_u32 s60, s96, 4096
    buffer_load_dwordx4 a[208:211], v2, s[12:15], s60 offen offset:0 nt
    buffer_load_dwordx4 a[212:215], v3, s[12:15], s60 offen offset:1024 nt
    buffer_load_dwordx4 a[216:219], v4, s[12:15], s60 offen offset:2048 nt
    buffer_load_dwordx4 a[220:223], v5, s[12:15], s60 offen offset:3072 nt
L_kb_6:
    s_waitcnt lgkmcnt(4)
    v_mfma_f32_32x32x16_bf16 v[96:111], v[32:35], v[40:43], v[96:111]
    s_waitcnt vmcnt(16)
    ds_read_b64_tr_b16 v[52:53], v20 offset:2048
    ds_read_b64_tr_b16 v[54:55], v20 offset:2560
    s_waitcnt lgkmcnt(5)
    v_mfma_f32_32x32x16_bf16 v[112:127], v[32:35], v[44:47], v[112:127]
    ds_read_b128 v[60:63], v13 offset:24576
    s_add_u32 m0, s32, 14336
    s_add_u32 s26, s57, 917504
    buffer_load_dwordx4 v8, s[8:11], s26 offen lds
    s_waitcnt lgkmcnt(5)
    v_mfma_f32_32x32x16_bf16 v[128:143], v[32:35], v[48:51], v[128:143]
    ds_read_b128 v[64:67], v13 offset:32768
    s_add_u32 m0, s32, 15360
    s_add_u32 s26, s57, 983040
    buffer_load_dwordx4 v8, s[8:11], s26 offen lds
    s_waitcnt lgkmcnt(4)
    v_mfma_f32_32x32x16_bf16 v[144:159], v[36:39], v[40:43], v[144:159]
    ds_read_b128 v[68:71], v13 offset:40960
    v_mfma_f32_32x32x16_bf16 v[160:175], v[36:39], v[44:47], v[160:175]
    ds_read_b64_tr_b16 v[56:57], v21 offset:2048
    ds_read_b64_tr_b16 v[58:59], v21 offset:2560
    v_mfma_f32_32x32x16_bf16 v[176:191], v[36:39], v[48:51], v[176:191]
    s_waitcnt lgkmcnt(4)
    v_mfma_f32_32x32x16_bf16 v[96:111], v[52:55], v[60:63], v[96:111]
    s_waitcnt vmcnt(15)
    ds_read_b64_tr_b16 v[32:33], v20 offset:4096
    ds_read_b64_tr_b16 v[34:35], v20 offset:4608
    s_waitcnt lgkmcnt(5)
    v_mfma_f32_32x32x16_bf16 v[112:127], v[52:55], v[64:67], v[112:127]
    ds_read_b128 v[40:43], v14 offset:24576
    s_add_u32 m0, s32, 0
    s_add_u32 s26, s58, 0
    buffer_load_dwordx4 v8, s[8:11], s26 offen lds
    s_waitcnt lgkmcnt(5)
    v_mfma_f32_32x32x16_bf16 v[128:143], v[52:55], v[68:71], v[128:143]
    ds_read_b128 v[44:47], v14 offset:32768
    s_add_u32 m0, s32, 1024
    s_add_u32 s26, s58, 65536
    buffer_load_dwordx4 v8, s[8:11], s26 offen lds
    s_waitcnt lgkmcnt(4)
    v_mfma_f32_32x32x16_bf16 v[144:159], v[56:59], v[60:63], v[144:159]
    ds_read_b128 v[48:51], v14 offset:40960
    v_mfma_f32_32x32x16_bf16 v[160:175], v[56:59], v[64:67], v[160:175]
    ds_read_b64_tr_b16 v[36:37], v21 offset:4096
    ds_read_b64_tr_b16 v[38:39], v21 offset:4608
    v_mfma_f32_32x32x16_bf16 v[176:191], v[56:59], v[68:71], v[176:191]
    s_waitcnt lgkmcnt(4)
    v_mfma_f32_32x32x16_bf16 v[96:111], v[32:35], v[40:43], v[96:111]
    s_waitcnt vmcnt(14)
    ds_read_b64_tr_b16 v[52:53], v20 offset:6144
    ds_read_b64_tr_b16 v[54:55], v20 offset:6656
    s_waitcnt lgkmcnt(5)
    v_mfma_f32_32x32x16_bf16 v[112:127], v[32:35], v[44:47], v[112:127]
    ds_read_b128 v[60:63], v15 offset:24576
    s_add_u32 m0, s32, 2048
    s_add_u32 s26, s58, 131072
    buffer_load_dwordx4 v8, s[8:11], s26 offen lds
    s_waitcnt lgkmcnt(5)
    v_mfma_f32_32x32x16_bf16 v[128:143], v[32:35], v[48:51], v[128:143]
    ds_read_b128 v[64:67], v15 offset:32768
    s_add_u32 m0, s32, 3072
    s_add_u32 s26, s58, 196608
    buffer_load_dwordx4 v8, s[8:11], s26 offen lds
    s_waitcnt lgkmcnt(4)
    v_mfma_f32_32x32x16_bf16 v[144:159], v[36:39], v[40:43], v[144:159]
    ds_read_b128 v[68:71], v15 offset:40960
    s_add_u32 m0, s27, 73728
    s_add_u32 s26, s55, 0
    buffer_load_dwordx4 v9, s[4:7], s26 offen lds
    v_mfma_f32_32x32x16_bf16 v[160:175], v[36:39], v[44:47], v[160:175]
    ds_read_b64_tr_b16 v[56:57], v21 offset:6144
    ds_read_b64_tr_b16 v[58:59], v21 offset:6656
    v_mfma_f32_32x32x16_bf16 v[176:191], v[36:39], v[48:51], v[176:191]
    s_waitcnt lgkmcnt(4)
    v_mfma_f32_32x32x16_bf16 v[96:111], v[52:55], v[60:63], v[96:111]
    s_waitcnt vmcnt(14)
    ds_read_b64_tr_b16 v[32:33], v20 offset:8192
    ds_read_b64_tr_b16 v[34:35], v20 offset:8704
    s_waitcnt lgkmcnt(5)
    v_mfma_f32_32x32x16_bf16 v[112:127], v[52:55], v[64:67], v[112:127]
    ds_read_b128 v[40:43], v16 offset:24576
    s_add_u32 m0, s32, 4096
    s_add_u32 s26, s58, 262144
    buffer_load_dwordx4 v8, s[8:11], s26 offen lds
    s_waitcnt lgkmcnt(5)
    v_mfma_f32_32x32x16_bf16 v[128:143], v[52:55], v[68:71], v[128:143]
    ds_read_b128 v[44:47], v16 offset:32768
    s_add_u32 m0, s32, 5120
    s_add_u32 s26, s58, 327680
    buffer_load_dwordx4 v8, s[8:11], s26 offen lds
    s_waitcnt lgkmcnt(4)
    v_mfma_f32_32x32x16_bf16 v[144:159], v[56:59], v[60:63], v[144:159]
    ds_read_b128 v[48:51], v16 offset:40960
    s_add_u32 m0, s27, 77824
    s_add_u32 s26, s55, 16384
    buffer_load_dwordx4 v9, s[4:7], s26 offen lds
    v_mfma_f32_32x32x16_bf16 v[160:175], v[56:59], v[64:67], v[160:175]
    ds_read_b64_tr_b16 v[36:37], v21 offset:8192
    ds_read_b64_tr_b16 v[38:39], v21 offset:8704
    v_mfma_f32_32x32x16_bf16 v[176:191], v[56:59], v[68:71], v[176:191]
    s_cmp_lg_u32 s61, 5
    s_cbranch_scc1 L_kb_7
    s_add_u32 s60, s94, 0
    buffer_load_dwordx4 v[192:195], v2, s[12:15], s60 offen offset:0 nt
    buffer_load_dwordx4 v[196:199], v3, s[12:15], s60 offen offset:1024 nt
    buffer_load_dwordx4 v[200:203], v4, s[12:15], s60 offen offset:2048 nt
    buffer_load_dwordx4 v[204:207], v5, s[12:15], s60 offen offset:3072 nt
    s_add_u32 s60, s94, 4096
    buffer_load_dwordx4 v[208:211], v2, s[12:15], s60 offen offset:0 nt
    buffer_load_dwordx4 v[212:215], v3, s[12:15], s60 offen offset:1024 nt
    buffer_load_dwordx4 v[216:219], v4, s[12:15], s60 offen offset:2048 nt
    buffer_load_dwordx4 v[220:223], v5, s[12:15], s60 offen offset:3072 nt
    s_add_u32 s60, s95, 0
    buffer_load_dwordx4 v[224:227], v2, s[12:15], s60 offen offset:0 nt
    buffer_load_dwordx4 v[228:231], v3, s[12:15], s60 offen offset:1024 nt
    buffer_load_dwordx4 v[232:235], v4, s[12:15], s60 offen offset:2048 nt
    buffer_load_dwordx4 v[236:239], v5, s[12:15], s60 offen offset:3072 nt
    s_add_u32 s60, s95, 4096
    buffer_load_dwordx4 v[240:243], v2, s[12:15], s60 offen offset:0 nt
    buffer_load_dwordx4 v[244:247], v3, s[12:15], s60 offen offset:1024 nt
    buffer_load_dwordx4 v[248:251], v4, s[12:15], s60 offen offset:2048 nt
    buffer_load_dwordx4 v[252:255], v5, s[12:15], s60 offen offset:3072 nt
    s_add_u32 s60, s96, 0
    buffer_load_dwordx4 a[192:195], v2, s[12:15], s60 offen offset:0 nt
    buffer_load_dwordx4 a[196:199], v3, s[12:15], s60 offen offset:1024 nt
    buffer_load_dwordx4 a[200:203], v4, s[12:15], s60 offen offset:2048 nt
    buffer_load_dwordx4 a[204:207], v5, s[12:15], s60 offen offset:3072 nt
    s_add_u32 s60, s96, 4096
    buffer_load_dwordx4 a[208:211], v2, s[12:15], s60 offen offset:0 nt
    buffer_load_dwordx4 a[212:215], v3, s[12:15], s60 offen offset:1024 nt
    buffer_load_dwordx4 a[216:219], v4, s[12:15], s60 offen offset:2048 nt
    buffer_load_dwordx4 a[220:223], v5, s[12:15], s60 offen offset:3072 nt
L_kb_7:
    s_waitcnt lgkmcnt(4)
    v_mfma_f32_32x32x16_bf16 v[96:111], v[32:35], v[40:43], v[96:111]
    s_waitcnt vmcnt(14)
    ds_read_b64_tr_b16 v[52:53], v20 offset:10240
    ds_read_b64_tr_b16 v[54:55], v20 offset:10752
    s_waitcnt lgkmcnt(5)
    v_mfma_f32_32x32x16_bf16 v[112:127], v[32:35], v[44:47], v[112:127]
    ds_read_b128 v[60:63], v17 offset:24576
    s_add_u32 m0, s32, 6144
    s_add_u32 s26, s58, 393216
    buffer_load_dwordx4 v8, s[8:11], s26 offen lds
    s_waitcnt lgkmcnt(5)
    v_mfma_f32_32x32x16_bf16 v[128:143], v[32:35], v[48:51], v[128:143]
    ds_read_b128 v[64:67], v17 offset:32768
    s_add_u32 m0, s32, 7168
    s_add_u32 s26, s58, 458752
    buffer_load_dwordx4 v8, s[8:11], s26 offen lds
    s_waitcnt lgkmcnt(4)
    v_mfma_f32_32x32x16_bf16 v[144:159], v[36:39], v[40:43], v[144:159]
    ds_read_b128 v[68:71], v17 offset:40960
    s_add_u32 m0, s27, 81920
    s_add_u32 s26, s55, 32768
    buffer_load_dwordx4 v9, s[4:7], s26 offen lds
    v_mfma_f32_32x32x16_bf16 v[160:175], v[36:39], v[44:47], v[160:175]
    ds_read_b64_tr_b16 v[56:57], v21 offset:10240
    ds_read_b64_tr_b16 v[58:59], v21 offset:10752
    v_mfma_f32_32x32x16_bf16 v[176:191], v[36:39], v[48:51], v[176:191]
    s_waitcnt lgkmcnt(4)
    v_mfma_f32_32x32x16_bf16 v[96:111], v[52:55], v[60:63], v[96:111]
    s_waitcnt vmcnt(14)
    ds_read_b64_tr_b16 v[32:33], v20 offset:12288
    ds_read_b64_tr_b16 v[34:35], v20 offset:12800
    s_waitcnt lgkmcnt(5)
    v_mfma_f32_32x32x16_bf16 v[112:127], v[52:55], v[64:67], v[112:127]
    ds_read_b128 v[40:43], v18 offset:24576
    s_add_u32 m0, s32, 8192
    s_add_u32 s26, s58, 524288
    buffer_load_dwordx4 v8, s[8:11], s26 offen lds
    s_waitcnt lgkmcnt(5)
    v_mfma_f32_32x32x16_bf16 v[128:143], v[52:55], v[68:71], v[128:143]
    ds_read_b128 v[44:47], v18 offset:32768
    s_add_u32 m0, s32, 9216
    s_add_u32 s26, s58, 589824
    buffer_load_dwordx4 v8, s[8:11], s26 offen lds
    s_waitcnt lgkmcnt(4)
    v_mfma_f32_32x32x16_bf16 v[144:159], v[56:59], v[60:63], v[144:159]
    ds_read_b128 v[48:51], v18 offset:40960
    s_add_u32 m0, s27, 86016
    s_add_u32 s26, s55, 49152
    buffer_load_dwordx4 v9, s[4:7], s26 offen lds
    v_mfma_f32_32x32x16_bf16 v[160:175], v[56:59], v[64:67], v[160:175]
    ds_read_b64_tr_b16 v[36:37], v21 offset:12288
    ds_read_b64_tr_b16 v[38:39], v21 offset:12800
    v_mfma_f32_32x32x16_bf16 v[176:191], v[56:59], v[68:71], v[176:191]
    s_waitcnt lgkmcnt(4)
    v_mfma_f32_32x32x16_bf16 v[96:111], v[32:35], v[40:43], v[96:111]
    s_waitcnt vmcnt(14)
    ds_read_b64_tr_b16 v[52:53], v20 offset:14336
    ds_read_b64_tr_b16 v[54:55], v20 offset:14848
    s_waitcnt lgkmcnt(5)
    v_mfma_f32_32x32x16_bf16 v[112:127], v[32:35], v[44:47], v[112:127]
    ds_read_b128 v[60:63], v19 offset:24576
    s_add_u32 m0, s32, 10240
    s_add_u32 s26, s58, 655360
    buffer_load_dwordx4 v8, s[8:11], s26 offen lds
    s_waitcnt lgkmcnt(5)
    v_mfma_f32_32x32x16_bf16 v[128:143], v[32:35], v[48:51], v[128:143]
    ds_read_b128 v[64:67], v19 offset:32768
    s_add_u32 m0, s32, 11264
    s_add_u32 s26, s58, 720896
    buffer_load_dwordx4 v8, s[8:11], s26 offen lds
    s_waitcnt lgkmcnt(4)
    v_mfma_f32_32x32x16_bf16 v[144:159], v[36:39], v[40:43], v[144:159]
    ds_read_b128 v[68:71], v19 offset:40960
    s_add_u32 m0, s27, 90112
    s_add_u32 s26, s55, 65536
    buffer_load_dwordx4 v9, s[4:7], s26 offen lds
    v_mfma_f32_32x32x16_bf16 v[160:175], v[36:39], v[44:47], v[160:175]
    ds_read_b64_tr_b16 v[56:57], v21 offset:14336
    ds_read_b64_tr_b16 v[58:59], v21 offset:14848
    v_mfma_f32_32x32x16_bf16 v[176:191], v[36:39], v[48:51], v[176:191]
    s_waitcnt lgkmcnt(4)
    v_mfma_f32_32x32x16_bf16 v[96:111], v[52:55], v[60:63], v[96:111]
    s_waitcnt vmcnt(15)
    s_barrier
    v_add_u32 v12, 49152, v12
    v_add_u32 v13, 49152, v13
    v_add_u32 v14, 49152, v14
    v_add_u32 v15, 49152, v15
    v_add_u32 v16, 49152, v16
    v_add_u32 v17, 49152, v17
    v_add_u32 v18, 49152, v18
    v_add_u32 v19, 49152, v19
    ds_read_b64_tr_b16 v[32:33], v20 offset:0
    ds_read_b64_tr_b16 v[34:35], v20 offset:512
    s_waitcnt lgkmcnt(5)
    v_mfma_f32_32x32x16_bf16 v[112:127], v[52:55], v[64:67], v[112:127]
    ds_read_b128 v[40:43], v12 offset:0
    s_add_u32 m0, s32, 12288
    s_add_u32 s26, s58, 786432
    buffer_load_dwordx4 v8, s[8:11], s26 offen lds
    s_waitcnt lgkmcnt(5)
    v_mfma_f32_32x32x16_bf16 v[128:143], v[52:55], v[68:71], v[128:143]
    ds_read_b128 v[44:47], v12 offset:8192
    s_add_u32 m0, s32, 13312
    s_add_u32 s26, s58, 851968
    buffer_load_dwordx4 v8, s[8:11], s26 offen lds
    s_waitcnt lgkmcnt(4)
    v_mfma_f32_32x32x16_bf16 v[144:159], v[56:59], v[60:63], v[144:159]
    ds_read_b128 v[48:51], v12 offset:16384
    s_add_u32 m0, s27, 94208
    s_add_u32 s26, s55, 81920
    buffer_load_dwordx4 v9, s[4:7], s26 offen lds
    v_mfma_f32_32x32x16_bf16 v[160:175], v[56:59], v[64:67], v[160:175]
    ds_read_b64_tr_b16 v[36:37], v21 offset:0
    ds_read_b64_tr_b16 v[38:39], v21 offset:512
    v_mfma_f32_32x32x16_bf16 v[176:191], v[56:59], v[68:71], v[176:191]
    s_cmp_lg_u32 s61, 6
    s_cbranch_scc1 L_kb_8
    s_add_u32 s60, s94, 0
    buffer_load_dwordx4 v[192:195], v2, s[12:15], s60 offen offset:0 nt
    buffer_load_dwordx4 v[196:199], v3, s[12:15], s60 offen offset:1024 nt
    buffer_load_dwordx4 v[200:203], v4, s[12:15], s60 offen offset:2048 nt
    buffer_load_dwordx4 v[204:207], v5, s[12:15], s60 offen offset:3072 nt
    s_add_u32 s60, s94, 4096
    buffer_load_dwordx4 v[208:211], v2, s[12:15], s60 offen offset:0 nt
    buffer_load_dwordx4 v[212:215], v3, s[12:15], s60 offen offset:1024 nt
    buffer_load_dwordx4 v[216:219], v4, s[12:15], s60 offen offset:2048 nt
    buffer_load_dwordx4 v[220:223], v5, s[12:15], s60 offen offset:3072 nt
    s_add_u32 s60, s95, 0
    buffer_load_dwordx4 v[224:227], v2, s[12:15], s60 offen offset:0 nt
    buffer_load_dwordx4 v[228:231], v3, s[12:15], s60 offen offset:1024 nt
    buffer_load_dwordx4 v[232:235], v4, s[12:15], s60 offen offset:2048 nt
    buffer_load_dwordx4 v[236:239], v5, s[12:15], s60 offen offset:3072 nt
    s_add_u32 s60, s95, 4096
    buffer_load_dwordx4 v[240:243], v2, s[12:15], s60 offen offset:0 nt
    buffer_load_dwordx4 v[244:247], v3, s[12:15], s60 offen offset:1024 nt
    buffer_load_dwordx4 v[248:251], v4, s[12:15], s60 offen offset:2048 nt
    buffer_load_dwordx4 v[252:255], v5, s[12:15], s60 offen offset:3072 nt
    s_add_u32 s60, s96, 0
    buffer_load_dwordx4 a[192:195], v2, s[12:15], s60 offen offset:0 nt
    buffer_load_dwordx4 a[196:199], v3, s[12:15], s60 offen offset:1024 nt
    buffer_load_dwordx4 a[200:203], v4, s[12:15], s60 offen offset:2048 nt
    buffer_load_dwordx4 a[204:207], v5, s[12:15], s60 offen offset:3072 nt
    s_add_u32 s60, s96, 4096
    buffer_load_dwordx4 a[208:211], v2, s[12:15], s60 offen offset:0 nt
    buffer_load_dwordx4 a[212:215], v3, s[12:15], s60 offen offset:1024 nt
    buffer_load_dwordx4 a[216:219], v4, s[12:15], s60 offen offset:2048 nt
    buffer_load_dwordx4 a[220:223], v5, s[12:15], s60 offen offset:3072 nt
L_kb_8:
    s_waitcnt lgkmcnt(4)
    v_mfma_f32_32x32x16_bf16 v[96:111], v[32:35], v[40:43], v[96:111]
    s_waitcnt vmcnt(16)
    ds_read_b64_tr_b16 v[52:53], v20 offset:2048
    ds_read_b64_tr_b16 v[54:55], v20 offset:2560
    s_waitcnt lgkmcnt(5)
    v_mfma_f32_32x32x16_bf16 v[112:127], v[32:35], v[44:47], v[112:127]
    ds_read_b128 v[60:63], v13 offset:0
    s_add_u32 m0, s32, 14336
    s_add_u32 s26, s58, 917504
    buffer_load_dwordx4 v8, s[8:11], s26 offen lds
    s_waitcnt lgkmcnt(5)
    v_mfma_f32_32x32x16_bf16 v[128:143], v[32:35], v[48:51], v[128:143]
    ds_read_b128 v[64:67], v13 offset:8192
    s_add_u32 m0, s32, 15360
    s_add_u32 s26, s58, 983040
    buffer_load_dwordx4 v8, s[8:11], s26 offen lds
    s_waitcnt lgkmcnt(4)
    v_mfma_f32_32x32x16_bf16 v[144:159], v[36:39], v[40:43], v[144:159]
    ds_read_b128 v[68:71], v13 offset:16384
    v_mfma_f32_32x32x16_bf16 v[160:175], v[36:39], v[44:47], v[160:175]
    ds_read_b64_tr_b16 v[56:57], v21 offset:2048
    ds_read_b64_tr_b16 v[58:59], v21 offset:2560
    v_mfma_f32_32x32x16_bf16 v[176:191], v[36:39], v[48:51], v[176:191]
    v_mov_b32 v73, 0
    global_load_dword v72, v73, s[46:47] sc1
    s_waitcnt lgkmcnt(4)
    v_mfma_f32_32x32x16_bf16 v[96:111], v[52:55], v[60:63], v[96:111]
    s_waitcnt vmcnt(16)
    ds_read_b64_tr_b16 v[32:33], v20 offset:4096
    ds_read_b64_tr_b16 v[34:35], v20 offset:4608
    s_waitcnt lgkmcnt(5)
    v_mfma_f32_32x32x16_bf16 v[112:127], v[52:55], v[64:67], v[112:127]
    ds_read_b128 v[40:43], v14 offset:0
    s_add_u32 m0, s32, 0
    s_add_u32 s26, s59, 0
    buffer_load_dwordx4 v8, s[8:11], s26 offen lds
    s_waitcnt lgkmcnt(5)
    v_mfma_f32_32x32x16_bf16 v[128:143], v[52:55], v[68:71], v[128:143]
    ds_read_b128 v[44:47], v14 offset:8192
    s_add_u32 m0, s32, 1024
    s_add_u32 s26, s59, 65536
    buffer_load_dwordx4 v8, s[8:11], s26 offen lds
    s_waitcnt lgkmcnt(4)
    v_mfma_f32_32x32x16_bf16 v[144:159], v[56:59], v[60:63], v[144:159]
    ds_read_b128 v[48:51], v14 offset:16384
    v_mfma_f32_32x32x16_bf16 v[160:175], v[56:59], v[64:67], v[160:175]
    ds_read_b64_tr_b16 v[36:37], v21 offset:4096
    ds_read_b64_tr_b16 v[38:39], v21 offset:4608
    v_mfma_f32_32x32x16_bf16 v[176:191], v[56:59], v[68:71], v[176:191]
    s_waitcnt lgkmcnt(4)
    v_mfma_f32_32x32x16_bf16 v[96:111], v[32:35], v[40:43], v[96:111]
    s_waitcnt vmcnt(15)
    ds_read_b64_tr_b16 v[52:53], v20 offset:6144
    ds_read_b64_tr_b16 v[54:55], v20 offset:6656
    s_waitcnt lgkmcnt(5)
    v_mfma_f32_32x32x16_bf16 v[112:127], v[32:35], v[44:47], v[112:127]
    ds_read_b128 v[60:63], v15 offset:0
    s_add_u32 m0, s32, 2048
    s_add_u32 s26, s59, 131072
    buffer_load_dwordx4 v8, s[8:11], s26 offen lds
    s_waitcnt lgkmcnt(5)
    v_mfma_f32_32x32x16_bf16 v[128:143], v[32:35], v[48:51], v[128:143]
    ds_read_b128 v[64:67], v15 offset:8192
    s_add_u32 m0, s32, 3072
    s_add_u32 s26, s59, 196608
    buffer_load_dwordx4 v8, s[8:11], s26 offen lds
    s_waitcnt lgkmcnt(4)
    v_mfma_f32_32x32x16_bf16 v[144:159], v[36:39], v[40:43], v[144:159]
    ds_read_b128 v[68:71], v15 offset:16384
    v_mfma_f32_32x32x16_bf16 v[160:175], v[36:39], v[44:47], v[160:175]
    ds_read_b64_tr_b16 v[56:57], v21 offset:6144
    ds_read_b64_tr_b16 v[58:59], v21 offset:6656
    v_mfma_f32_32x32x16_bf16 v[176:191], v[36:39], v[48:51], v[176:191]
    s_waitcnt lgkmcnt(4)
    v_mfma_f32_32x32x16_bf16 v[96:111], v[52:55], v[60:63], v[96:111]
    s_waitcnt vmcnt(14)
    ds_read_b64_tr_b16 v[32:33], v20 offset:8192
    ds_read_b64_tr_b16 v[34:35], v20 offset:8704
    s_waitcnt lgkmcnt(5)
    v_mfma_f32_32x32x16_bf16 v[112:127], v[52:55], v[64:67], v[112:127]
    ds_read_b128 v[40:43], v16 offset:0
    s_add_u32 m0, s32, 4096
    s_add_u32 s26, s59, 262144
    buffer_load_dwordx4 v8, s[8:11], s26 offen lds
    s_waitcnt lgkmcnt(5)
    v_mfma_f32_32x32x16_bf16 v[128:143], v[52:55], v[68:71], v[128:143]
    ds_read_b128 v[44:47], v16 offset:8192
    s_add_u32 m0, s32, 5120
    s_add_u32 s26, s59, 327680
    buffer_load_dwordx4 v8, s[8:11], s26 offen lds
    s_waitcnt lgkmcnt(4)
    v_mfma_f32_32x32x16_bf16 v[144:159], v[56:59], v[60:63], v[144:159]
    ds_read_b128 v[48:51], v16 offset:16384
    s_cmp_lg_u32 s61, 7
    s_cbranch_scc1 L_kb_9
    s_add_u32 s60, s94, 0
    buffer_load_dwordx4 v[192:195], v2, s[12:15], s60 offen offset:0 nt
    buffer_load_dwordx4 v[196:199], v3, s[12:15], s60 offen offset:1024 nt
    buffer_load_dwordx4 v[200:203], v4, s[12:15], s60 offen offset:2048 nt
    buffer_load_dwordx4 v[204:207], v5, s[12:15], s60 offen offset:3072 nt
    s_add_u32 s60, s94, 4096
    buffer_load_dwordx4 v[208:211], v2, s[12:15], s60 offen offset:0 nt
    buffer_load_dwordx4 v[212:215], v3, s[12:15], s60 offen offset:1024 nt
    buffer_load_dwordx4 v[216:219], v4, s[12:15], s60 offen offset:2048 nt
    buffer_load_dwordx4 v[220:223], v5, s[12:15], s60 offen offset:3072 nt
    s_add_u32 s60, s95, 0
    buffer_load_dwordx4 v[224:227], v2, s[12:15], s60 offen offset:0 nt
    buffer_load_dwordx4 v[228:231], v3, s[12:15], s60 offen offset:1024 nt
    buffer_load_dwordx4 v[232:235], v4, s[12:15], s60 offen offset:2048 nt
    buffer_load_dwordx4 v[236:239], v5, s[12:15], s60 offen offset:3072 nt
    s_add_u32 s60, s95, 4096
    buffer_load_dwordx4 v[240:243], v2, s[12:15], s60 offen offset:0 nt
    buffer_load_dwordx4 v[244:247], v3, s[12:15], s60 offen offset:1024 nt
    buffer_load_dwordx4 v[248:251], v4, s[12:15], s60 offen offset:2048 nt
    buffer_load_dwordx4 v[252:255], v5, s[12:15], s60 offen offset:3072 nt
    s_add_u32 s60, s96, 0
    buffer_load_dwordx4 a[192:195], v2, s[12:15], s60 offen offset:0 nt
    buffer_load_dwordx4 a[196:199], v3, s[12:15], s60 offen offset:1024 nt
    buffer_load_dwordx4 a[200:203], v4, s[12:15], s60 offen offset:2048 nt
    buffer_load_dwordx4 a[204:207], v5, s[12:15], s60 offen offset:3072 nt
    s_add_u32 s60, s96, 4096
    buffer_load_dwordx4 a[208:211], v2, s[12:15], s60 offen offset:0 nt
    buffer_load_dwordx4 a[212:215], v3, s[12:15], s60 offen offset:1024 nt
    buffer_load_dwordx4 a[216:219], v4, s[12:15], s60 offen offset:2048 nt
    buffer_load_dwordx4 a[220:223], v5, s[12:15], s60 offen offset:3072 nt
L_kb_9:
    v_mfma_f32_32x32x16_bf16 v[160:175], v[56:59], v[64:67], v[160:175]
    ds_read_b64_tr_b16 v[36:37], v21 offset:8192
    ds_read_b64_tr_b16 v[38:39], v21 offset:8704
    v_mfma_f32_32x32x16_bf16 v[176:191], v[56:59], v[68:71], v[176:191]
    s_waitcnt lgkmcnt(4)
    v_mfma_f32_32x32x16_bf16 v[96:111], v[32:35], v[40:43], v[96:111]
    s_waitcnt vmcnt(13)
    ds_read_b64_tr_b16 v[52:53], v20 offset:10240
    ds_read_b64_tr_b16 v[54:55], v20 offset:10752
    s_waitcnt lgkmcnt(5)
    v_mfma_f32_32x32x16_bf16 v[112:127], v[32:35], v[44:47], v[112:127]
    ds_read_b128 v[60:63], v17 offset:0
    s_add_u32 m0, s32, 6144
    s_add_u32 s26, s59, 393216
    buffer_load_dwordx4 v8, s[8:11], s26 offen lds
    s_waitcnt lgkmcnt(5)
    v_mfma_f32_32x32x16_bf16 v[128:143], v[32:35], v[48:51], v[128:143]
    ds_read_b128 v[64:67], v17 offset:8192
    s_add_u32 m0, s32, 7168
    s_add_u32 s26, s59, 458752
    buffer_load_dwordx4 v8, s[8:11], s26 offen lds
    s_waitcnt lgkmcnt(4)
    v_mfma_f32_32x32x16_bf16 v[144:159], v[36:39], v[40:43], v[144:159]
    ds_read_b128 v[68:71], v17 offset:16384
    v_mfma_f32_32x32x16_bf16 v[160:175], v[36:39], v[44:47], v[160:175]
    ds_read_b64_tr_b16 v[56:57], v21 offset:10240
    ds_read_b64_tr_b16 v[58:59], v21 offset:10752
    v_mfma_f32_32x32x16_bf16 v[176:191], v[36:39], v[48:51], v[176:191]
    s_waitcnt lgkmcnt(4)
    v_mfma_f32_32x32x16_bf16 v[96:111], v[52:55], v[60:63], v[96:111]
    s_waitcnt vmcnt(12)
    ds_read_b64_tr_b16 v[32:33], v20 offset:12288
    ds_read_b64_tr_b16 v[34:35], v20 offset:12800
    s_waitcnt lgkmcnt(5)
    v_mfma_f32_32x32x16_bf16 v[112:127], v[52:55], v[64:67], v[112:127]
    ds_read_b128 v[40:43], v18 offset:0
    s_add_u32 m0, s32, 8192
    s_add_u32 s26, s59, 524288
    buffer_load_dwordx4 v8, s[8:11], s26 offen lds
    s_waitcnt lgkmcnt(5)
    v_mfma_f32_32x32x16_bf16 v[128:143], v[52:55], v[68:71], v[128:143]
    ds_read_b128 v[44:47], v18 offset:8192
    s_add_u32 m0, s32, 9216
    s_add_u32 s26, s59, 589824
    buffer_load_dwordx4 v8, s[8:11], s26 offen lds
    s_waitcnt lgkmcnt(4)
    v_mfma_f32_32x32x16_bf16 v[144:159], v[56:59], v[60:63], v[144:159]
    ds_read_b128 v[48:51], v18 offset:16384
    v_mfma_f32_32x32x16_bf16 v[160:175], v[56:59], v[64:67], v[160:175]
    ds_read_b64_tr_b16 v[36:37], v21 offset:12288
    ds_read_b64_tr_b16 v[38:39], v21 offset:12800
    v_mfma_f32_32x32x16_bf16 v[176:191], v[56:59], v[68:71], v[176:191]
    s_waitcnt lgkmcnt(4)
    v_mfma_f32_32x32x16_bf16 v[96:111], v[32:35], v[40:43], v[96:111]
    s_waitcnt vmcnt(11)
    ds_read_b64_tr_b16 v[52:53], v20 offset:14336
    ds_read_b64_tr_b16 v[54:55], v20 offset:14848
    s_waitcnt lgkmcnt(5)
    v_mfma_f32_32x32x16_bf16 v[112:127], v[32:35], v[44:47], v[112:127]
    ds_read_b128 v[60:63], v19 offset:0
    s_add_u32 m0, s32, 10240
    s_add_u32 s26, s59, 655360
    buffer_load_dwordx4 v8, s[8:11], s26 offen lds
    s_waitcnt lgkmcnt(5)
    v_mfma_f32_32x32x16_bf16 v[128:143], v[32:35], v[48:51], v[128:143]
    ds_read_b128 v[64:67], v19 offset:8192
    s_add_u32 m0, s32, 11264
    s_add_u32 s26, s59, 720896
    buffer_load_dwordx4 v8, s[8:11], s26 offen lds
    s_waitcnt lgkmcnt(4)
    v_mfma_f32_32x32x16_bf16 v[144:159], v[36:39], v[40:43], v[144:159]
    ds_read_b128 v[68:71], v19 offset:16384
    v_mfma_f32_32x32x16_bf16 v[160:175], v[36:39], v[44:47], v[160:175]
    ds_read_b64_tr_b16 v[56:57], v21 offset:14336
    ds_read_b64_tr_b16 v[58:59], v21 offset:14848
    v_mfma_f32_32x32x16_bf16 v[176:191], v[36:39], v[48:51], v[176:191]
    s_waitcnt lgkmcnt(4)
    v_mfma_f32_32x32x16_bf16 v[96:111], v[52:55], v[60:63], v[96:111]
    s_waitcnt vmcnt(10)
    s_barrier
    ds_read_b64_tr_b16 v[32:33], v20 offset:0
    ds_read_b64_tr_b16 v[34:35], v20 offset:512
    s_waitcnt lgkmcnt(5)
    v_mfma_f32_32x32x16_bf16 v[112:127], v[52:55], v[64:67], v[112:127]
    ds_read_b128 v[40:43], v12 offset:24576
    s_add_u32 m0, s32, 12288
    s_add_u32 s26, s59, 786432
    buffer_load_dwordx4 v8, s[8:11], s26 offen lds
    s_waitcnt lgkmcnt(5)
    v_mfma_f32_32x32x16_bf16 v[128:143], v[52:55], v[68:71], v[128:143]
    ds_read_b128 v[44:47], v12 offset:32768
    s_add_u32 m0, s32, 13312
    s_add_u32 s26, s59, 851968
    buffer_load_dwordx4 v8, s[8:11], s26 offen lds
    s_waitcnt lgkmcnt(4)
    v_mfma_f32_32x32x16_bf16 v[144:159], v[56:59], v[60:63], v[144:159]
    ds_read_b128 v[48:51], v12 offset:40960
    s_add_u32 s60, s97, 0
    buffer_load_dwordx4 a[224:227], v2, s[12:15], s60 offen offset:0 nt
    v_mfma_f32_32x32x16_bf16 v[160:175], v[56:59], v[64:67], v[160:175]
    ds_read_b64_tr_b16 v[36:37], v21 offset:0
    ds_read_b64_tr_b16 v[38:39], v21 offset:512
    v_mfma_f32_32x32x16_bf16 v[176:191], v[56:59], v[68:71], v[176:191]
    s_waitcnt lgkmcnt(4)
    v_mfma_f32_32x32x16_bf16 v[96:111], v[32:35], v[40:43], v[96:111]
    s_waitcnt vmcnt(11)
    ds_read_b64_tr_b16 v[52:53], v20 offset:2048
    ds_read_b64_tr_b16 v[54:55], v20 offset:2560
    s_waitcnt lgkmcnt(5)
    v_mfma_f32_32x32x16_bf16 v[112:127], v[32:35], v[44:47], v[112:127]
    ds_read_b128 v[60:63], v13 offset:24576
    s_add_u32 m0, s32, 14336
    s_add_u32 s26, s59, 917504
    buffer_load_dwordx4 v8, s[8:11], s26 offen lds
    s_waitcnt lgkmcnt(5)
    v_mfma_f32_32x32x16_bf16 v[128:143], v[32:35], v[48:51], v[128:143]
    ds_read_b128 v[64:67], v13 offset:32768
    s_add_u32 m0, s32, 15360
    s_add_u32 s26, s59, 983040
    buffer_load_dwordx4 v8, s[8:11], s26 offen lds
    s_waitcnt lgkmcnt(4)
    v_mfma_f32_32x32x16_bf16 v[144:159], v[36:39], v[40:43], v[144:159]
    ds_read_b128 v[68:71], v13 offset:40960
    buffer_load_dwordx4 a[228:231], v3, s[12:15], s60 offen offset:1024 nt
    v_mfma_f32_32x32x16_bf16 v[160:175], v[36:39], v[44:47], v[160:175]
    ds_read_b64_tr_b16 v[56:57], v21 offset:2048
    ds_read_b64_tr_b16 v[58:59], v21 offset:2560
    v_mfma_f32_32x32x16_bf16 v[176:191], v[36:39], v[48:51], v[176:191]
    s_waitcnt lgkmcnt(4)
    v_mfma_f32_32x32x16_bf16 v[96:111], v[52:55], v[60:63], v[96:111]
    s_waitcnt vmcnt(12)
    ds_read_b64_tr_b16 v[32:33], v20 offset:4096
    ds_read_b64_tr_b16 v[34:35], v20 offset:4608
    s_waitcnt lgkmcnt(5)
    v_mfma_f32_32x32x16_bf16 v[112:127], v[52:55], v[64:67], v[112:127]
    ds_read_b128 v[40:43], v14 offset:24576
    buffer_load_dwordx4 a[232:235], v4, s[12:15], s60 offen offset:2048 nt
    s_waitcnt lgkmcnt(5)
    v_mfma_f32_32x32x16_bf16 v[128:143], v[52:55], v[68:71], v[128:143]
    ds_read_b128 v[44:47], v14 offset:32768
    s_waitcnt lgkmcnt(4)
    v_mfma_f32_32x32x16_bf16 v[144:159], v[56:59], v[60:63], v[144:159]
    ds_read_b128 v[48:51], v14 offset:40960
    v_mfma_f32_32x32x16_bf16 v[160:175], v[56:59], v[64:67], v[160:175]
    ds_read_b64_tr_b16 v[36:37], v21 offset:4096
    ds_read_b64_tr_b16 v[38:39], v21 offset:4608
    v_mfma_f32_32x32x16_bf16 v[176:191], v[56:59], v[68:71], v[176:191]
    s_waitcnt lgkmcnt(4)
    v_mfma_f32_32x32x16_bf16 v[96:111], v[32:35], v[40:43], v[96:111]
    s_waitcnt vmcnt(11)
    ds_read_b64_tr_b16 v[52:53], v20 offset:6144
    ds_read_b64_tr_b16 v[54:55], v20 offset:6656
    s_waitcnt lgkmcnt(5)
    v_mfma_f32_32x32x16_bf16 v[112:127], v[32:35], v[44:47], v[112:127]
    ds_read_b128 v[60:63], v15 offset:24576
    buffer_load_dwordx4 a[236:239], v5, s[12:15], s60 offen offset:3072 nt
    s_waitcnt lgkmcnt(5)
    v_mfma_f32_32x32x16_bf16 v[128:143], v[32:35], v[48:51], v[128:143]
    ds_read_b128 v[64:67], v15 offset:32768
    s_waitcnt lgkmcnt(4)
    v_mfma_f32_32x32x16_bf16 v[144:159], v[36:39], v[40:43], v[144:159]
    ds_read_b128 v[68:71], v15 offset:40960
    v_mfma_f32_32x32x16_bf16 v[160:175], v[36:39], v[44:47], v[160:175]
    ds_read_b64_tr_b16 v[56:57], v21 offset:6144
    ds_read_b64_tr_b16 v[58:59], v21 offset:6656
    v_mfma_f32_32x32x16_bf16 v[176:191], v[36:39], v[48:51], v[176:191]
    s_waitcnt lgkmcnt(4)
    v_mfma_f32_32x32x16_bf16 v[96:111], v[52:55], v[60:63], v[96:111]
    s_waitcnt vmcnt(10)
    ds_read_b64_tr_b16 v[32:33], v20 offset:8192
    ds_read_b64_tr_b16 v[34:35], v20 offset:8704
    s_waitcnt lgkmcnt(5)
    v_mfma_f32_32x32x16_bf16 v[112:127], v[52:55], v[64:67], v[112:127]
    ds_read_b128 v[40:43], v16 offset:24576
    s_add_u32 s60, s97, 4096
    buffer_load_dwordx4 a[240:243], v2, s[12:15], s60 offen offset:0 nt
    s_waitcnt lgkmcnt(5)
    v_mfma_f32_32x32x16_bf16 v[128:143], v[52:55], v[68:71], v[128:143]
    ds_read_b128 v[44:47], v16 offset:32768
    s_waitcnt lgkmcnt(4)
    v_mfma_f32_32x32x16_bf16 v[144:159], v[56:59], v[60:63], v[144:159]
    ds_read_b128 v[48:51], v16 offset:40960
    v_mfma_f32_32x32x16_bf16 v[160:175], v[56:59], v[64:67], v[160:175]
    ds_read_b64_tr_b16 v[36:37], v21 offset:8192
    ds_read_b64_tr_b16 v[38:39], v21 offset:8704
    v_mfma_f32_32x32x16_bf16 v[176:191], v[56:59], v[68:71], v[176:191]
    s_waitcnt lgkmcnt(4)
    v_mfma_f32_32x32x16_bf16 v[96:111], v[32:35], v[40:43], v[96:111]
    s_waitcnt vmcnt(9)
    ds_read_b64_tr_b16 v[52:53], v20 offset:10240
    ds_read_b64_tr_b16 v[54:55], v20 offset:10752
    s_waitcnt lgkmcnt(5)
    v_mfma_f32_32x32x16_bf16 v[112:127], v[32:35], v[44:47], v[112:127]
    ds_read_b128 v[60:63], v17 offset:24576
    buffer_load_dwordx4 a[244:247], v3, s[12:15], s60 offen offset:1024 nt
    s_waitcnt lgkmcnt(5)
    v_mfma_f32_32x32x16_bf16 v[128:143], v[32:35], v[48:51], v[128:143]
    ds_read_b128 v[64:67], v17 offset:32768
    s_waitcnt lgkmcnt(4)
    v_mfma_f32_32x32x16_bf16 v[144:159], v[36:39], v[40:43], v[144:159]
    ds_read_b128 v[68:71], v17 offset:40960
    v_mfma_f32_32x32x16_bf16 v[160:175], v[36:39], v[44:47], v[160:175]
    ds_read_b64_tr_b16 v[56:57], v21 offset:10240
    ds_read_b64_tr_b16 v[58:59], v21 offset:10752
    v_mfma_f32_32x32x16_bf16 v[176:191], v[36:39], v[48:51], v[176:191]
    s_waitcnt lgkmcnt(4)
    v_mfma_f32_32x32x16_bf16 v[96:111], v[52:55], v[60:63], v[96:111]
    s_waitcnt vmcnt(8)
    ds_read_b64_tr_b16 v[32:33], v20 offset:12288
    ds_read_b64_tr_b16 v[34:35], v20 offset:12800
    s_waitcnt lgkmcnt(5)
    v_mfma_f32_32x32x16_bf16 v[112:127], v[52:55], v[64:67], v[112:127]
    ds_read_b128 v[40:43], v18 offset:24576
    buffer_load_dwordx4 a[248:251], v4, s[12:15], s60 offen offset:2048 nt
    s_waitcnt lgkmcnt(5)
    v_mfma_f32_32x32x16_bf16 v[128:143], v[52:55], v[68:71], v[128:143]
    ds_read_b128 v[44:47], v18 offset:32768
    s_waitcnt lgkmcnt(4)
    v_mfma_f32_32x32x16_bf16 v[144:159], v[56:59], v[60:63], v[144:159]
    ds_read_b128 v[48:51], v18 offset:40960
    v_mfma_f32_32x32x16_bf16 v[160:175], v[56:59], v[64:67], v[160:175]
    ds_read_b64_tr_b16 v[36:37], v21 offset:12288
    ds_read_b64_tr_b16 v[38:39], v21 offset:12800
    v_mfma_f32_32x32x16_bf16 v[176:191], v[56:59], v[68:71], v[176:191]
    s_waitcnt lgkmcnt(4)
    v_mfma_f32_32x32x16_bf16 v[96:111], v[32:35], v[40:43], v[96:111]
    s_waitcnt vmcnt(6)
    ds_read_b64_tr_b16 v[52:53], v20 offset:14336
    ds_read_b64_tr_b16 v[54:55], v20 offset:14848
    s_waitcnt lgkmcnt(5)
    v_mfma_f32_32x32x16_bf16 v[112:127], v[32:35], v[44:47], v[112:127]
    ds_read_b128 v[60:63], v19 offset:24576
    buffer_load_dwordx4 a[252:255], v5, s[12:15], s60 offen offset:3072 nt
    s_waitcnt lgkmcnt(5)
    v_mfma_f32_32x32x16_bf16 v[128:143], v[32:35], v[48:51], v[128:143]
    ds_read_b128 v[64:67], v19 offset:32768
    s_waitcnt lgkmcnt(4)
    v_mfma_f32_32x32x16_bf16 v[144:159], v[36:39], v[40:43], v[144:159]
    ds_read_b128 v[68:71], v19 offset:40960
    v_mfma_f32_32x32x16_bf16 v[160:175], v[36:39], v[44:47], v[160:175]
    ds_read_b64_tr_b16 v[56:57], v21 offset:14336
    ds_read_b64_tr_b16 v[58:59], v21 offset:14848
    v_mfma_f32_32x32x16_bf16 v[176:191], v[36:39], v[48:51], v[176:191]
    s_waitcnt lgkmcnt(4)
    v_mfma_f32_32x32x16_bf16 v[96:111], v[52:55], v[60:63], v[96:111]
    s_waitcnt lgkmcnt(3)
    v_mfma_f32_32x32x16_bf16 v[112:127], v[52:55], v[64:67], v[112:127]
    s_waitcnt lgkmcnt(2)
    v_mfma_f32_32x32x16_bf16 v[128:143], v[52:55], v[68:71], v[128:143]
    s_waitcnt lgkmcnt(0)
    v_mfma_f32_32x32x16_bf16 v[144:159], v[56:59], v[60:63], v[144:159]
    v_mfma_f32_32x32x16_bf16 v[160:175], v[56:59], v[64:67], v[160:175]
    v_mfma_f32_32x32x16_bf16 v[176:191], v[56:59], v[68:71], v[176:191]
    s_sub_u32 s50, s28, 114688
    v_add_u32 v12, s50, v12
    v_add_u32 v13, s50, v13
    v_add_u32 v14, s50, v14
    v_add_u32 v15, s50, v15
    v_add_u32 v16, s50, v16
    v_add_u32 v17, s50, v17
    v_add_u32 v18, s50, v18
    v_add_u32 v19, s50, v19
    v_readfirstlane_b32 s62, v72
    s_barrier
    s_add_u32 m0, s28, 8192
    s_add_u32 s29, s94, 0
    buffer_load_dwordx4 v6, s[16:19], s29 offen offset:0 nt lds
    v_pk_mul_f32 v[96:97], v[96:97], s[42:43]
    v_pk_mul_f32 v[98:99], v[98:99], s[42:43]
    v_pk_mul_f32 v[100:101], v[100:101], s[42:43]
    v_pk_mul_f32 v[102:103], v[102:103], s[42:43]
    v_pk_mul_f32 v[104:105], v[104:105], s[42:43]
    v_pk_mul_f32 v[106:107], v[106:107], s[42:43]
    v_pk_mul_f32 v[108:109], v[108:109], s[42:43]
    v_pk_mul_f32 v[110:111], v[110:111], s[42:43]
    v_cvt_pk_bf16_f32 v96, v96, v97
    v_cvt_pk_bf16_f32 v97, v98, v99
    v_cvt_pk_bf16_f32 v98, v100, v101
    v_cvt_pk_bf16_f32 v99, v102, v103
    v_cvt_pk_bf16_f32 v100, v104, v105
    v_cvt_pk_bf16_f32 v101, v106, v107
    v_cvt_pk_bf16_f32 v102, v108, v109
    v_cvt_pk_bf16_f32 v103, v110, v111
    ds_write_b64 v10, v[96:97] offset:0
    ds_write_b64 v10, v[98:99] offset:512
    ds_write_b64 v10, v[100:101] offset:3072
    ds_write_b64 v10, v[102:103] offset:3584
    buffer_load_dwordx4 v6, s[16:19], s29 offen offset:1024 nt lds
    v_pk_mul_f32 v[112:113], v[112:113], s[42:43]
    v_pk_mul_f32 v[114:115], v[114:115], s[42:43]
    v_pk_mul_f32 v[116:117], v[116:117], s[42:43]
    v_pk_mul_f32 v[118:119], v[118:119], s[42:43]
    v_pk_mul_f32 v[120:121], v[120:121], s[42:43]
    v_pk_mul_f32 v[122:123], v[122:123], s[42:43]
    v_pk_mul_f32 v[124:125], v[124:125], s[42:43]
    v_pk_mul_f32 v[126:127], v[126:127], s[42:43]
    v_cvt_pk_bf16_f32 v112, v112, v113
    v_cvt_pk_bf16_f32 v113, v114, v115
    v_cvt_pk_bf16_f32 v114, v116, v117
    v_cvt_pk_bf16_f32 v115, v118, v119
    v_cvt_pk_bf16_f32 v116, v120, v121
    v_cvt_pk_bf16_f32 v117, v122, v123
    v_cvt_pk_bf16_f32 v118, v124, v125
    v_cvt_pk_bf16_f32 v119, v126, v127
    ds_write_b64 v10, v[112:113] offset:1024
    ds_write_b64 v10, v[114:115] offset:1536
    ds_write_b64 v10, v[116:117] offset:4096
    ds_write_b64 v10, v[118:119] offset:4608
    v_pk_mul_f32 v[128:129], v[128:129], s[42:43]
    v_pk_mul_f32 v[130:131], v[130:131], s[42:43]
    v_pk_mul_f32 v[132:133], v[132:133], s[42:43]
    v_pk_mul_f32 v[134:135], v[134:135], s[42:43]
    v_pk_mul_f32 v[136:137], v[136:137], s[42:43]
    v_pk_mul_f32 v[138:139], v[138:139], s[42:43]
    v_pk_mul_f32 v[140:141], v[140:141], s[42:43]
    v_pk_mul_f32 v[142:143], v[142:143], s[42:43]
    v_cvt_pk_bf16_f32 v128, v128, v129
    v_cvt_pk_bf16_f32 v129, v130, v131
    v_cvt_pk_bf16_f32 v130, v132, v133
    v_cvt_pk_bf16_f32 v131, v134, v135
    v_cvt_pk_bf16_f32 v132, v136, v137
    v_cvt_pk_bf16_f32 v133, v138, v139
    v_cvt_pk_bf16_f32 v134, v140, v141
    v_cvt_pk_bf16_f32 v135, v142, v143
    ds_write_b64 v10, v[128:129] offset:2048
    ds_write_b64 v10, v[130:131] offset:2560
    ds_write_b64 v10, v[132:133] offset:5120
    ds_write_b64 v10, v[134:135] offset:5632
    buffer_load_dwordx4 v6, s[16:19], s29 offen offset:2048 nt lds
    v_pk_mul_f32 v[144:145], v[144:145], s[42:43]
    v_pk_mul_f32 v[146:147], v[146:147], s[42:43]
    v_pk_mul_f32 v[148:149], v[148:149], s[42:43]
    v_pk_mul_f32 v[150:151], v[150:151], s[42:43]
    v_pk_mul_f32 v[152:153], v[152:153], s[42:43]
    v_pk_mul_f32 v[154:155], v[154:155], s[42:43]
    v_pk_mul_f32 v[156:157], v[156:157], s[42:43]
    v_pk_mul_f32 v[158:159], v[158:159], s[42:43]
    v_cvt_pk_bf16_f32 v144, v144, v145
    v_cvt_pk_bf16_f32 v145, v146, v147
    v_cvt_pk_bf16_f32 v146, v148, v149
    v_cvt_pk_bf16_f32 v147, v150, v151
    v_cvt_pk_bf16_f32 v148, v152, v153
    v_cvt_pk_bf16_f32 v149, v154, v155
    v_cvt_pk_bf16_f32 v150, v156, v157
    v_cvt_pk_bf16_f32 v151, v158, v159
    ds_write_b64 v10, v[144:145] offset:6144
    ds_write_b64 v10, v[146:147] offset:6656
    ds_write_b64 v11, v[148:149] offset:1024
    ds_write_b64 v11, v[150:151] offset:1536
    v_pk_mul_f32 v[160:161], v[160:161], s[42:43]
    v_pk_mul_f32 v[162:163], v[162:163], s[42:43]
    v_pk_mul_f32 v[164:165], v[164:165], s[42:43]
    v_pk_mul_f32 v[166:167], v[166:167], s[42:43]
    v_pk_mul_f32 v[168:169], v[168:169], s[42:43]
    v_pk_mul_f32 v[170:171], v[170:171], s[42:43]
    v_pk_mul_f32 v[172:173], v[172:173], s[42:43]
    v_pk_mul_f32 v[174:175], v[174:175], s[42:43]
    v_cvt_pk_bf16_f32 v160, v160, v161
    v_cvt_pk_bf16_f32 v161, v162, v163
    v_cvt_pk_bf16_f32 v162, v164, v165
    v_cvt_pk_bf16_f32 v163, v166, v167
    v_cvt_pk_bf16_f32 v164, v168, v169
    v_cvt_pk_bf16_f32 v165, v170, v171
    v_cvt_pk_bf16_f32 v166, v172, v173
    v_cvt_pk_bf16_f32 v167, v174, v175
    ds_write_b64 v10, v[160:161] offset:7168
    ds_write_b64 v10, v[162:163] offset:7680
    ds_write_b64 v11, v[164:165] offset:2048
    ds_write_b64 v11, v[166:167] offset:2560
    buffer_load_dwordx4 v6, s[16:19], s29 offen offset:3072 nt lds
    v_pk_mul_f32 v[176:177], v[176:177], s[42:43]
    v_pk_mul_f32 v[178:179], v[178:179], s[42:43]
    v_pk_mul_f32 v[180:181], v[180:181], s[42:43]
    v_pk_mul_f32 v[182:183], v[182:183], s[42:43]
    v_pk_mul_f32 v[184:185], v[184:185], s[42:43]
    v_pk_mul_f32 v[186:187], v[186:187], s[42:43]
    v_pk_mul_f32 v[188:189], v[188:189], s[42:43]
    v_pk_mul_f32 v[190:191], v[190:191], s[42:43]
    v_cvt_pk_bf16_f32 v176, v176, v177
    v_cvt_pk_bf16_f32 v177, v178, v179
    v_cvt_pk_bf16_f32 v178, v180, v181
    v_cvt_pk_bf16_f32 v179, v182, v183
    v_cvt_pk_bf16_f32 v180, v184, v185
    v_cvt_pk_bf16_f32 v181, v186, v187
    v_cvt_pk_bf16_f32 v182, v188, v189
    v_cvt_pk_bf16_f32 v183, v190, v191
    ds_write_b64 v11, v[176:177] offset:0
    ds_write_b64 v11, v[178:179] offset:512
    ds_write_b64 v11, v[180:181] offset:3072
    ds_write_b64 v11, v[182:183] offset:3584
    s_waitcnt lgkmcnt(0)
    s_barrier
    v_mov_b32 v8, 0x3f803f80
    v_mov_b32 v9, 0x3f803f80
    v_mov_b32 v10, 0x3f803f80
    v_mov_b32 v11, 0x3f803f80
    s_mov_b32 s4, s40
    s_mov_b32 s5, s41
    s_mov_b32 s6, 4194304
    s_lshr_b32 s50, s37, 1
    s_and_b32 s51, s3, 3
    s_lshl_b32 s50, s50, 3
    s_lshl_b32 s51, s51, 1
    s_add_u32 s50, s50, s51
    s_and_b32 s51, s37, 1
    s_add_u32 s50, s50, s51
    s_lshl_b32 s32, s50, 17
    s_lshl_b32 s50, s24, 15
    s_add_u32 s32, s32, s50
    s_lshr_b32 s50, s34, 3
    s_lshl_b32 s50, s50, 8
    s_add_u32 s32, s32, s50
    s_mov_b32 s63, 0
    s_cmp_lg_u32 s62, 0
    s_cbranch_scc1 L_nok_11
L_np_10:
    v_mov_b32 v20, 0
    global_load_dword v21, v20, s[46:47] sc1
    s_waitcnt vmcnt(0)
    v_readfirstlane_b32 s62, v21
    s_add_u32 s63, s63, 1
    s_cmp_ge_u32 s63, 65536
    s_cbranch_scc1 L_nok_11
    s_cmp_eq_u32 s62, 0
    s_cbranch_scc1 L_np_10
L_nok_11:
    s_lshl_b32 s31, s35, 3
    s_add_u32 s31, s31, s37
    s_lshl_b32 s31, s31, 2
    s_and_b32 s60, s3, 3
    s_add_u32 s31, s31, s60
    s_lshl_b32 s31, s31, 2
    s_add_u32 s31, s31, s24
    s_lshl_b32 s31, s31, 2
    s_lshr_b32 s60, s34, 3
    s_add_u32 s31, s31, s60
    s_lshl_b32 s31, s31, 2
    s_add_u32 s31, s31, 16777216
    ds_read_b128 a[0:3], v7 offset:0
    ds_read_b128 a[4:7], v7 offset:1024
    ds_read_b128 a[8:11], v7 offset:2048
    s_add_u32 m0, s28, 12288
    s_add_u32 s29, s94, 4096
    buffer_load_dwordx4 v6, s[16:19], s29 offen offset:0 nt lds
    ds_read_b128 a[12:15], v7 offset:3072
    ds_read_b128 a[16:19], v7 offset:4096
    ds_read_b128 a[20:23], v7 offset:5120
    ds_read_b128 a[24:27], v7 offset:6144
    ds_read_b128 a[28:31], v7 offset:7168
    ds_read_b128 a[32:35], v31 offset:0
    buffer_load_dwordx4 v6, s[16:19], s29 offen offset:1024 nt lds
    ds_read_b128 a[36:39], v31 offset:1024
    ds_read_b128 a[40:43], v31 offset:2048
    ds_read_b128 a[44:47], v31 offset:3072
    ds_read_b128 a[48:51], v7 offset:32768
    ds_read_b128 a[52:55], v7 offset:33792
    ds_read_b128 a[56:59], v7 offset:34816
    buffer_load_dwordx4 v6, s[16:19], s29 offen offset:2048 nt lds
    ds_read_b128 a[60:63], v7 offset:35840
    ds_read_b128 a[64:67], v7 offset:36864
    ds_read_b128 a[68:71], v7 offset:37888
    ds_read_b128 a[72:75], v7 offset:38912
    ds_read_b128 a[76:79], v7 offset:39936
    ds_read_b128 a[80:83], v31 offset:32768
    buffer_load_dwordx4 v6, s[16:19], s29 offen offset:3072 nt lds
    ds_read_b128 a[84:87], v31 offset:33792
    ds_read_b128 a[88:91], v31 offset:34816
    ds_read_b128 a[92:95], v31 offset:35840
    s_waitcnt lgkmcnt(0)
    s_barrier
    s_mov_b64 s[38:39], -1
    s_waitcnt vmcnt(31)
    ds_write_b128 v1, v[192:195] offset:0
    ds_write_b128 v1, v[196:199] offset:1024
    ds_write_b128 v1, v[200:203] offset:2048
    ds_write_b128 v1, v[204:207] offset:3072
    ds_write_b128 v1, v[208:211] offset:4096
    ds_write_b128 v1, v[212:215] offset:5120
    ds_write_b128 v1, v[216:219] offset:6144
    ds_write_b128 v1, v[220:223] offset:7168
    ds_read_b128 v[32:35], v12 offset:0
    ds_read_b128 v[36:39], v13 offset:0
    ds_read_b128 v[40:43], v14 offset:0
    ds_read_b128 v[44:47], v15 offset:0
    s_waitcnt lgkmcnt(3)
    v_mfma_f32_32x32x16_bf16 v[64:79], v[32:35], a[0:3], 0
    ds_read_b128 v[48:51], v16 offset:0
    ds_read_b128 a[96:99], v25 offset:0
    v_mfma_f32_32x32x16_bf16 v[80:95], v[32:35], a[4:7], 0
    ds_read_b128 v[52:55], v17 offset:0
    ds_read_b128 a[100:103], v25 offset:1024
    v_mfma_f32_32x32x16_bf16 v[96:111], v[32:35], a[8:11], 0
    ds_read_b128 v[56:59], v18 offset:0
    ds_read_b128 a[104:107], v25 offset:2048
    s_waitcnt lgkmcnt(8)
    v_mfma_f32_32x32x16_bf16 v[64:79], v[36:39], a[12:15], v[64:79]
    ds_read_b128 v[60:63], v19 offset:0
    s_add_u32 m0, s28, 16384
    s_add_u32 s29, s95, 0
    buffer_load_dwordx4 v6, s[16:19], s29 offen offset:0 nt lds
    ds_read_b128 a[108:111], v25 offset:3072
    v_mfma_f32_32x32x16_bf16 v[80:95], v[36:39], a[16:19], v[80:95]
    s_waitcnt vmcnt(24)
    ds_write_b128 v1, v[224:227] offset:0
    ds_read_b128 a[112:115], v25 offset:4096
    v_mfma_f32_32x32x16_bf16 v[96:111], v[36:39], a[20:23], v[96:111]
    ds_write_b128 v1, v[228:231] offset:1024
    ds_read_b128 a[116:119], v25 offset:5120
    s_waitcnt lgkmcnt(13)
    v_mfma_f32_32x32x16_bf16 v[64:79], v[40:43], a[24:27], v[64:79]
    ds_write_b128 v1, v[232:235] offset:2048
    ds_read_b128 a[120:123], v25 offset:6144
    v_mfma_f32_32x32x16_bf16 v[80:95], v[40:43], a[28:31], v[80:95]
    ds_write_b128 v1, v[236:239] offset:3072
    ds_read_b128 a[124:127], v25 offset:7168
    v_mfma_f32_32x32x16_bf16 v[96:111], v[40:43], a[32:35], v[96:111]
    ds_write_b128 v1, v[240:243] offset:4096
    ds_read_b128 a[128:131], v25 offset:8192
    s_waitcnt lgkmcnt(15)
    v_mfma_f32_32x32x16_bf16 v[64:79], v[44:47], a[36:39], v[64:79]
    ds_write_b128 v1, v[244:247] offset:5120
    buffer_load_dwordx4 v6, s[16:19], s29 offen offset:1024 nt lds
    ds_read_b128 a[132:135], v25 offset:9216
    v_mfma_f32_32x32x16_bf16 v[80:95], v[44:47], a[40:43], v[80:95]
    ds_write_b128 v1, v[248:251] offset:6144
    ds_read_b128 a[136:139], v25 offset:10240
    v_mfma_f32_32x32x16_bf16 v[96:111], v[44:47], a[44:47], v[96:111]
    ds_write_b128 v1, v[252:255] offset:7168
    ds_read_b128 a[140:143], v25 offset:11264
    v_mfma_f32_32x32x16_bf16 v[64:79], v[48:51], a[48:51], v[64:79]
    ds_read_b128 a[144:147], v25 offset:12288
    v_mfma_f32_32x32x16_bf16 v[80:95], v[48:51], a[52:55], v[80:95]
    ds_read_b128 v[32:35], v12 offset:0
    ds_read_b128 a[148:151], v25 offset:13312
    v_mfma_f32_32x32x16_bf16 v[96:111], v[48:51], a[56:59], v[96:111]
    buffer_load_dwordx4 v6, s[16:19], s29 offen offset:2048 nt lds
    ds_read_b128 a[152:155], v25 offset:14336
    v_mfma_f32_32x32x16_bf16 v[64:79], v[52:55], a[60:63], v[64:79]
    ds_read_b128 a[156:159], v25 offset:15360
    v_mfma_f32_32x32x16_bf16 v[80:95], v[52:55], a[64:67], v[80:95]
    ds_read_b128 v[36:39], v13 offset:0
    ds_read_b128 a[160:163], v25 offset:16384
    v_mfma_f32_32x32x16_bf16 v[96:111], v[52:55], a[68:71], v[96:111]
    ds_read_b128 a[164:167], v25 offset:17408
    s_waitcnt lgkmcnt(15)
    v_mfma_f32_32x32x16_bf16 v[64:79], v[56:59], a[72:75], v[64:79]
    buffer_load_dwordx4 v6, s[16:19], s29 offen offset:3072 nt lds
    ds_read_b128 a[168:171], v25 offset:18432
    v_mfma_f32_32x32x16_bf16 v[80:95], v[56:59], a[76:79], v[80:95]
    ds_read_b128 v[40:43], v14 offset:0
    ds_read_b128 a[172:175], v25 offset:19456
    v_mfma_f32_32x32x16_bf16 v[96:111], v[56:59], a[80:83], v[96:111]
    ds_read_b128 a[176:179], v25 offset:20480
    v_mfma_f32_32x32x16_bf16 v[64:79], v[60:63], a[84:87], v[64:79]
    ds_read_b128 a[180:183], v25 offset:21504
    v_mfma_f32_32x32x16_bf16 v[80:95], v[60:63], a[88:91], v[80:95]
    ds_read_b128 v[44:47], v15 offset:0
    s_add_u32 m0, s28, 20480
    s_add_u32 s29, s95, 4096
    buffer_load_dwordx4 v6, s[16:19], s29 offen offset:0 nt lds
    ds_read_b128 a[184:187], v25 offset:22528
    v_mfma_f32_32x32x16_bf16 v[96:111], v[60:63], a[92:95], v[96:111]
    ds_read_b128 a[188:191], v25 offset:23552
    s_waitcnt lgkmcnt(14)
    v_mfma_f32_32x32x16_bf16 v[112:127], v[32:35], a[0:3], 0
    ds_read_b128 v[48:51], v16 offset:0
    v_mfma_f32_32x32x16_bf16 v[128:143], v[32:35], a[4:7], 0
    ds_read_b128 v[52:55], v17 offset:0
    v_mfma_f32_32x32x16_bf16 v[144:159], v[32:35], a[8:11], 0
    ds_read_b128 v[56:59], v18 offset:0
    buffer_load_dwordx4 v6, s[16:19], s29 offen offset:1024 nt lds
    s_waitcnt lgkmcnt(13)
    v_mfma_f32_32x32x16_bf16 v[112:127], v[36:39], a[12:15], v[112:127]
    ds_read_b128 v[60:63], v19 offset:0
    v_exp_f32 v64, v64
    v_exp_f32 v65, v65
    v_exp_f32 v66, v66
    v_mfma_f32_32x32x16_bf16 v[128:143], v[36:39], a[16:19], v[128:143]
    s_waitcnt vmcnt(21)
    ds_write_b128 v1, a[192:195] offset:0
    v_exp_f32 v67, v67
    v_exp_f32 v68, v68
    v_exp_f32 v69, v69
    v_mfma_f32_32x32x16_bf16 v[144:159], v[36:39], a[20:23], v[144:159]
    ds_write_b128 v1, a[196:199] offset:1024
    v_exp_f32 v70, v70
    v_exp_f32 v71, v71
    v_cvt_pk_bf16_f32 v160, v64, v65
    s_waitcnt lgkmcnt(12)
    v_mfma_f32_32x32x16_bf16 v[112:127], v[40:43], a[24:27], v[112:127]
    v_cvt_pk_bf16_f32 v161, v66, v67
    ds_write_b128 v1, a[200:203] offset:2048
    v_cvt_pk_bf16_f32 v162, v68, v69
    buffer_load_dwordx4 v6, s[16:19], s29 offen offset:2048 nt lds
    v_cvt_pk_bf16_f32 v163, v70, v71
    v_exp_f32 v80, v80
    v_mfma_f32_32x32x16_bf16 v[128:143], v[40:43], a[28:31], v[128:143]
    v_exp_f32 v81, v81
    ds_write_b128 v1, a[204:207] offset:3072
    v_exp_f32 v82, v82
    v_exp_f32 v83, v83
    v_mfma_f32_32x32x16_bf16 v[144:159], v[40:43], a[32:35], v[144:159]
    v_exp_f32 v84, v84
    ds_write_b128 v1, a[208:211] offset:4096
    v_exp_f32 v85, v85
    v_exp_f32 v86, v86
    s_waitcnt lgkmcnt(11)
    v_mfma_f32_32x32x16_bf16 v[112:127], v[44:47], a[36:39], v[112:127]
    ds_write_b128 v1, a[212:215] offset:5120
    v_exp_f32 v87, v87
    v_cvt_pk_bf16_f32 v168, v80, v81
    v_cvt_pk_bf16_f32 v169, v82, v83
    v_cvt_pk_bf16_f32 v170, v84, v85
    v_cvt_pk_bf16_f32 v171, v86, v87
    v_mfma_f32_32x32x16_bf16 v[128:143], v[44:47], a[40:43], v[128:143]
    buffer_load_dwordx4 v6, s[16:19], s29 offen offset:3072 nt lds
    ds_write_b128 v1, a[216:219] offset:6144
    v_exp_f32 v96, v96
    v_exp_f32 v97, v97
    v_exp_f32 v98, v98
    v_mfma_f32_32x32x16_bf16 v[144:159], v[44:47], a[44:47], v[144:159]
    ds_write_b128 v1, a[220:223] offset:7168
    v_exp_f32 v99, v99
    v_exp_f32 v100, v100
    v_exp_f32 v101, v101
    s_waitcnt lgkmcnt(11)
    v_mfma_f32_32x32x16_bf16 v[112:127], v[48:51], a[48:51], v[112:127]
    v_exp_f32 v102, v102
    v_exp_f32 v103, v103
    v_cvt_pk_bf16_f32 v176, v96, v97
    v_mfma_f32_32x32x16_bf16 v[128:143], v[48:51], a[52:55], v[128:143]
    ds_read_b128 v[32:35], v12 offset:0
    v_cvt_pk_bf16_f32 v177, v98, v99
    v_cvt_pk_bf16_f32 v178, v100, v101
    v_cvt_pk_bf16_f32 v179, v102, v103
    v_exp_f32 v72, v72
    v_mfma_f32_32x32x16_bf16 v[144:159], v[48:51], a[56:59], v[144:159]
    v_exp_f32 v73, v73
    v_exp_f32 v74, v74
    v_exp_f32 v75, v75
    s_waitcnt lgkmcnt(11)
    v_mfma_f32_32x32x16_bf16 v[112:127], v[52:55], a[60:63], v[112:127]
    v_exp_f32 v76, v76
    s_add_u32 m0, s28, 24576
    s_add_u32 s29, s96, 0
    buffer_load_dwordx4 v6, s[16:19], s29 offen offset:0 nt lds
    v_exp_f32 v77, v77
    v_exp_f32 v78, v78
    v_mfma_f32_32x32x16_bf16 v[128:143], v[52:55], a[64:67], v[128:143]
    ds_read_b128 v[36:39], v13 offset:0
    v_exp_f32 v79, v79
    v_cvt_pk_bf16_f32 v164, v72, v73
    v_cvt_pk_bf16_f32 v165, v74, v75
    v_cvt_pk_bf16_f32 v166, v76, v77
    v_cvt_pk_bf16_f32 v167, v78, v79
    v_mfma_f32_32x32x16_bf16 v[144:159], v[52:55], a[68:71], v[144:159]
    v_exp_f32 v88, v88
    v_exp_f32 v89, v89
    v_exp_f32 v90, v90
    s_waitcnt lgkmcnt(11)
    v_mfma_f32_32x32x16_bf16 v[112:127], v[56:59], a[72:75], v[112:127]
    v_exp_f32 v91, v91
    v_exp_f32 v92, v92
    v_exp_f32 v93, v93
    v_mfma_f32_32x32x16_bf16 v[128:143], v[56:59], a[76:79], v[128:143]
    ds_read_b128 v[40:43], v14 offset:0
    v_exp_f32 v94, v94
    v_exp_f32 v95, v95
    v_cvt_pk_bf16_f32 v172, v88, v89
    v_mfma_f32_32x32x16_bf16 v[144:159], v[56:59], a[80:83], v[144:159]
    v_cvt_pk_bf16_f32 v173, v90, v91
    v_cvt_pk_bf16_f32 v174, v92, v93
    v_cvt_pk_bf16_f32 v175, v94, v95
    v_exp_f32 v104, v104
    s_waitcnt lgkmcnt(11)
    v_mfma_f32_32x32x16_bf16 v[112:127], v[60:63], a[84:87], v[112:127]
    v_exp_f32 v105, v105
    buffer_load_dwordx4 v6, s[16:19], s29 offen offset:1024 nt lds
    v_exp_f32 v106, v106
    v_exp_f32 v107, v107
    v_mfma_f32_32x32x16_bf16 v[128:143], v[60:63], a[88:91], v[128:143]
    ds_read_b128 v[44:47], v15 offset:0
    v_exp_f32 v108, v108
    v_exp_f32 v109, v109
    v_exp_f32 v110, v110
    v_mfma_f32_32x32x16_bf16 v[144:159], v[60:63], a[92:95], v[144:159]
    v_exp_f32 v111, v111
    v_cvt_pk_bf16_f32 v180, v104, v105
    v_cvt_pk_bf16_f32 v181, v106, v107
    v_cvt_pk_bf16_f32 v182, v108, v109
    v_cvt_pk_bf16_f32 v183, v110, v111
    s_barrier
    s_waitcnt lgkmcnt(3)
    v_mfma_f32_32x32x16_bf16 v[64:79], v[32:35], a[0:3], 0
    ds_read_b128 v[48:51], v16 offset:0
    v_mfma_f32_32x32x16_bf16 v[80:95], v[32:35], a[4:7], 0
    ds_read_b128 v[52:55], v17 offset:0
    v_mfma_f32_32x32x16_bf16 v[96:111], v[32:35], a[8:11], 0
    ds_read_b128 v[56:59], v18 offset:0
    buffer_load_dwordx4 v6, s[16:19], s29 offen offset:2048 nt lds
    s_waitcnt lgkmcnt(5)
    v_mfma_f32_32x32x16_bf16 v[64:79], v[36:39], a[12:15], v[64:79]
    ds_read_b128 v[60:63], v19 offset:0
    v_exp_f32 v112, v112
    v_exp_f32 v113, v113
    v_exp_f32 v114, v114
    v_mfma_f32_32x32x16_bf16 v[80:95], v[36:39], a[16:19], v[80:95]
    s_waitcnt vmcnt(19)
    ds_write_b128 v1, a[224:227] offset:0
    v_exp_f32 v115, v115
    v_exp_f32 v116, v116
    v_exp_f32 v117, v117
    v_mfma_f32_32x32x16_bf16 v[96:111], v[36:39], a[20:23], v[96:111]
    ds_write_b128 v1, a[228:231] offset:1024
    v_exp_f32 v118, v118
    v_exp_f32 v119, v119
    v_cvt_pk_bf16_f32 v184, v112, v113
    s_waitcnt lgkmcnt(7)
    v_mfma_f32_32x32x16_bf16 v[64:79], v[40:43], a[24:27], v[64:79]
    v_cvt_pk_bf16_f32 v185, v114, v115
    ds_write_b128 v1, a[232:235] offset:2048
    v_cvt_pk_bf16_f32 v186, v116, v117
    buffer_load_dwordx4 v6, s[16:19], s29 offen offset:3072 nt lds
    v_cvt_pk_bf16_f32 v187, v118, v119
    v_exp_f32 v128, v128
    v_mfma_f32_32x32x16_bf16 v[80:95], v[40:43], a[28:31], v[80:95]
    v_exp_f32 v129, v129
    ds_write_b128 v1, a[236:239] offset:3072
    v_exp_f32 v130, v130
    v_exp_f32 v131, v131
    v_mfma_f32_32x32x16_bf16 v[96:111], v[40:43], a[32:35], v[96:111]
    v_exp_f32 v132, v132
    ds_write_b128 v1, a[240:243] offset:4096
    v_exp_f32 v133, v133
    v_exp_f32 v134, v134
    s_waitcnt lgkmcnt(9)
    v_mfma_f32_32x32x16_bf16 v[64:79], v[44:47], a[36:39], v[64:79]
    ds_write_b128 v1, a[244:247] offset:5120
    v_exp_f32 v135, v135
    v_cvt_pk_bf16_f32 v192, v128, v129
    v_cvt_pk_bf16_f32 v193, v130, v131
    v_cvt_pk_bf16_f32 v194, v132, v133
    v_cvt_pk_bf16_f32 v195, v134, v135
    v_mfma_f32_32x32x16_bf16 v[80:95], v[44:47], a[40:43], v[80:95]
    s_add_u32 m0, s28, 28672
    s_add_u32 s29, s96, 4096
    buffer_load_dwordx4 v6, s[16:19], s29 offen offset:0 nt lds
    ds_write_b128 v1, a[248:251] offset:6144
    v_exp_f32 v144, v144
    v_exp_f32 v145, v145
    v_exp_f32 v146, v146
    v_mfma_f32_32x32x16_bf16 v[96:111], v[44:47], a[44:47], v[96:111]
    ds_write_b128 v1, a[252:255] offset:7168
    v_exp_f32 v147, v147
    v_exp_f32 v148, v148
    v_exp_f32 v149, v149
    s_waitcnt lgkmcnt(11)
    v_mfma_f32_32x32x16_bf16 v[64:79], v[48:51], a[48:51], v[64:79]
    v_exp_f32 v150, v150
    v_exp_f32 v151, v151
    v_cvt_pk_bf16_f32 v200, v144, v145
    v_mfma_f32_32x32x16_bf16 v[80:95], v[48:51], a[52:55], v[80:95]
    ds_read_b128 v[32:35], v12 offset:0
    v_cvt_pk_bf16_f32 v201, v146, v147
    v_cvt_pk_bf16_f32 v202, v148, v149
    v_cvt_pk_bf16_f32 v203, v150, v151
    v_exp_f32 v120, v120
    v_mfma_f32_32x32x16_bf16 v[96:111], v[48:51], a[56:59], v[96:111]
    v_exp_f32 v121, v121
    v_exp_f32 v122, v122
    buffer_load_dwordx4 v6, s[16:19], s29 offen offset:1024 nt lds
    v_exp_f32 v123, v123
    s_waitcnt lgkmcnt(11)
    v_mfma_f32_32x32x16_bf16 v[64:79], v[52:55], a[60:63], v[64:79]
    v_exp_f32 v124, v124
    v_exp_f32 v125, v125
    v_exp_f32 v126, v126
    v_mfma_f32_32x32x16_bf16 v[80:95], v[52:55], a[64:67], v[80:95]
    ds_read_b128 v[36:39], v13 offset:0
    v_exp_f32 v127, v127
    v_cvt_pk_bf16_f32 v188, v120, v121
    v_cvt_pk_bf16_f32 v189, v122, v123
    v_cvt_pk_bf16_f32 v190, v124, v125
    v_cvt_pk_bf16_f32 v191, v126, v127
    v_mfma_f32_32x32x16_bf16 v[96:111], v[52:55], a[68:71], v[96:111]
    v_exp_f32 v136, v136
    v_exp_f32 v137, v137
    v_exp_f32 v138, v138
    s_waitcnt lgkmcnt(11)
    v_mfma_f32_32x32x16_bf16 v[64:79], v[56:59], a[72:75], v[64:79]
    v_exp_f32 v139, v139
    buffer_load_dwordx4 v6, s[16:19], s29 offen offset:2048 nt lds
    v_exp_f32 v140, v140
    v_exp_f32 v141, v141
    v_mfma_f32_32x32x16_bf16 v[80:95], v[56:59], a[76:79], v[80:95]
    ds_read_b128 v[40:43], v14 offset:0
    v_exp_f32 v142, v142
    v_exp_f32 v143, v143
    v_cvt_pk_bf16_f32 v196, v136, v137
    v_mfma_f32_32x32x16_bf16 v[96:111], v[56:59], a[80:83], v[96:111]
    v_cvt_pk_bf16_f32 v197, v138, v139
    v_cvt_pk_bf16_f32 v198, v140, v141
    v_cvt_pk_bf16_f32 v199, v142, v143
    v_exp_f32 v152, v152
    s_waitcnt lgkmcnt(11)
    v_mfma_f32_32x32x16_bf16 v[64:79], v[60:63], a[84:87], v[64:79]
    v_exp_f32 v153, v153
    v_exp_f32 v154, v154
    v_exp_f32 v155, v155
    v_mfma_f32_32x32x16_bf16 v[80:95], v[60:63], a[88:91], v[80:95]
    ds_read_b128 v[44:47], v15 offset:0
    v_exp_f32 v156, v156
    buffer_load_dwordx4 v6, s[16:19], s29 offen offset:3072 nt lds
    v_exp_f32 v157, v157
    v_exp_f32 v158, v158
    v_mfma_f32_32x32x16_bf16 v[96:111], v[60:63], a[92:95], v[96:111]
    v_exp_f32 v159, v159
    v_cvt_pk_bf16_f32 v204, v152, v153
    v_cvt_pk_bf16_f32 v205, v154, v155
    v_cvt_pk_bf16_f32 v206, v156, v157
    v_cvt_pk_bf16_f32 v207, v158, v159
    s_waitcnt lgkmcnt(3)
    v_mfma_f32_32x32x16_bf16 v[112:127], v[32:35], a[0:3], 0
    ds_read_b128 v[48:51], v16 offset:0
    v_mfma_f32_32x32x16_bf16 v[128:143], v[32:35], a[4:7], 0
    ds_read_b128 v[52:55], v17 offset:0
    v_mfma_f32_32x32x16_bf16 v[144:159], v[32:35], a[8:11], 0
    ds_read_b128 v[56:59], v18 offset:0
    s_waitcnt lgkmcnt(5)
    v_mfma_f32_32x32x16_bf16 v[112:127], v[36:39], a[12:15], v[112:127]
    ds_read_b128 v[60:63], v19 offset:0
    v_exp_f32 v64, v64
    v_exp_f32 v65, v65
    v_exp_f32 v66, v66
    v_mfma_f32_32x32x16_bf16 v[128:143], v[36:39], a[16:19], v[128:143]
    v_exp_f32 v67, v67
    ds_write_b128 v24, v[160:163] offset:0
    v_exp_f32 v68, v68
    v_exp_f32 v69, v69
    v_mfma_f32_32x32x16_bf16 v[144:159], v[36:39], a[20:23], v[144:159]
    v_exp_f32 v70, v70
    v_exp_f32 v71, v71
    v_cvt_pk_bf16_f32 v208, v64, v65
    s_waitcnt lgkmcnt(6)
    v_mfma_f32_32x32x16_bf16 v[112:127], v[40:43], a[24:27], v[112:127]
    v_cvt_pk_bf16_f32 v209, v66, v67
    v_cvt_pk_bf16_f32 v210, v68, v69
    v_cvt_pk_bf16_f32 v211, v70, v71
    v_exp_f32 v80, v80
    v_mfma_f32_32x32x16_bf16 v[128:143], v[40:43], a[28:31], v[128:143]
    v_exp_f32 v81, v81
    v_exp_f32 v82, v82
    v_exp_f32 v83, v83
    v_mfma_f32_32x32x16_bf16 v[144:159], v[40:43], a[32:35], v[144:159]
    v_exp_f32 v84, v84
    v_exp_f32 v85, v85
    v_exp_f32 v86, v86
    s_waitcnt lgkmcnt(5)
    v_mfma_f32_32x32x16_bf16 v[112:127], v[44:47], a[36:39], v[112:127]
    v_exp_f32 v87, v87
    v_cvt_pk_bf16_f32 v216, v80, v81
    v_cvt_pk_bf16_f32 v217, v82, v83
    v_cvt_pk_bf16_f32 v218, v84, v85
    v_cvt_pk_bf16_f32 v219, v86, v87
    v_mfma_f32_32x32x16_bf16 v[128:143], v[44:47], a[40:43], v[128:143]
    v_exp_f32 v96, v96
    v_exp_f32 v97, v97
    v_exp_f32 v98, v98
    v_mfma_f32_32x32x16_bf16 v[144:159], v[44:47], a[44:47], v[144:159]
    v_exp_f32 v99, v99
    v_exp_f32 v100, v100
    v_exp_f32 v101, v101
    s_waitcnt lgkmcnt(4)
    v_mfma_f32_32x32x16_bf16 v[112:127], v[48:51], a[48:51], v[112:127]
    ds_write_b128 v24, v[168:171] offset:1024
    v_exp_f32 v102, v102
    v_exp_f32 v103, v103
    v_cvt_pk_bf16_f32 v224, v96, v97
    v_mfma_f32_32x32x16_bf16 v[128:143], v[48:51], a[52:55], v[128:143]
    v_cvt_pk_bf16_f32 v225, v98, v99
    v_cvt_pk_bf16_f32 v226, v100, v101
    v_cvt_pk_bf16_f32 v227, v102, v103
    v_exp_f32 v72, v72
    v_mfma_f32_32x32x16_bf16 v[144:159], v[48:51], a[56:59], v[144:159]
    v_exp_f32 v73, v73
    v_exp_f32 v74, v74
    v_exp_f32 v75, v75
    s_waitcnt lgkmcnt(4)
    v_mfma_f32_32x32x16_bf16 v[112:127], v[52:55], a[60:63], v[112:127]
    v_exp_f32 v76, v76
    v_exp_f32 v77, v77
    v_exp_f32 v78, v78
    v_mfma_f32_32x32x16_bf16 v[128:143], v[52:55], a[64:67], v[128:143]
    v_exp_f32 v79, v79
    v_cvt_pk_bf16_f32 v212, v72, v73
    v_cvt_pk_bf16_f32 v213, v74, v75
    v_cvt_pk_bf16_f32 v214, v76, v77
    v_cvt_pk_bf16_f32 v215, v78, v79
    v_mfma_f32_32x32x16_bf16 v[144:159], v[52:55], a[68:71], v[144:159]
    v_exp_f32 v88, v88
    v_exp_f32 v89, v89
    v_exp_f32 v90, v90
    s_waitcnt lgkmcnt(3)
    v_mfma_f32_32x32x16_bf16 v[112:127], v[56:59], a[72:75], v[112:127]
    v_exp_f32 v91, v91
    v_exp_f32 v92, v92
    v_exp_f32 v93, v93
    v_mfma_f32_32x32x16_bf16 v[128:143], v[56:59], a[76:79], v[128:143]
    v_exp_f32 v94, v94
    v_exp_f32 v95, v95
    v_cvt_pk_bf16_f32 v220, v88, v89
    v_mfma_f32_32x32x16_bf16 v[144:159], v[56:59], a[80:83], v[144:159]
    v_cvt_pk_bf16_f32 v221, v90, v91
    ds_write_b128 v24, v[176:179] offset:2048
    v_cvt_pk_bf16_f32 v222, v92, v93
    v_cvt_pk_bf16_f32 v223, v94, v95
    v_exp_f32 v104, v104
    s_waitcnt lgkmcnt(3)
    v_mfma_f32_32x32x16_bf16 v[112:127], v[60:63], a[84:87], v[112:127]
    v_exp_f32 v105, v105
    v_exp_f32 v106, v106
    v_exp_f32 v107, v107
    v_mfma_f32_32x32x16_bf16 v[128:143], v[60:63], a[88:91], v[128:143]
    v_exp_f32 v108, v108
    v_exp_f32 v109, v109
    v_exp_f32 v110, v110
    v_mfma_f32_32x32x16_bf16 v[144:159], v[60:63], a[92:95], v[144:159]
    v_exp_f32 v111, v111
    v_cvt_pk_bf16_f32 v228, v104, v105
    v_cvt_pk_bf16_f32 v229, v106, v107
    v_cvt_pk_bf16_f32 v230, v108, v109
    v_cvt_pk_bf16_f32 v231, v110, v111
    s_waitcnt vmcnt(20) lgkmcnt(0)
    s_barrier
    ds_read_b64_tr_b16 v[32:33], v22 offset:8192
    ds_read_b64_tr_b16 v[34:35], v22 offset:10240
    ds_read_b128 v[36:39], v25 offset:0
    ds_read_b128 v[40:43], v25 offset:1024
    ds_read_b128 v[44:47], v25 offset:2048
    ds_read_b64_tr_b16 v[48:49], v22 offset:40960
    ds_read_b64_tr_b16 v[50:51], v22 offset:43008
    ds_read_b128 v[52:55], v25 offset:3072
    ds_read_b128 v[56:59], v25 offset:4096
    ds_read_b128 v[60:63], v25 offset:5120
    v_mfma_f32_32x32x16_bf16 v[64:79], v[8:11], v[160:163], 0
    v_exp_f32 v112, v112
    v_mfma_f32_32x32x16_bf16 v[80:95], v[8:11], v[168:171], 0
    ds_write_b128 v24, v[164:167] offset:12288
    v_exp_f32 v113, v113
    s_add_u32 m0, s28, 0
    s_add_u32 s29, s97, 0
    buffer_load_dwordx4 v6, s[16:19], s29 offen offset:0 nt lds
    v_mfma_f32_32x32x16_bf16 v[96:111], v[8:11], v[176:179], 0
    v_exp_f32 v114, v114
    v_exp_f32 v115, v115
    v_mfma_f32_32x32x16_bf16 v[64:79], v[8:11], v[164:167], v[64:79]
    ds_write_b128 v24, v[172:175] offset:13312
    v_exp_f32 v116, v116
    v_mfma_f32_32x32x16_bf16 v[80:95], v[8:11], v[172:175], v[80:95]
    v_exp_f32 v117, v117
    buffer_load_dwordx4 v6, s[16:19], s29 offen offset:1024 nt lds
    v_mfma_f32_32x32x16_bf16 v[96:111], v[8:11], v[180:183], v[96:111]
    v_exp_f32 v118, v118
    ds_write_b128 v24, v[180:183] offset:14336
    v_exp_f32 v119, v119
    s_waitcnt lgkmcnt(10)
    v_mfma_f32_32x32x16_bf16 a[192:207], v[32:35], v[36:39], 0
    ds_read_b64_tr_b16 a[240:241], v23 offset:8192
    ds_read_b64_tr_b16 a[242:243], v23 offset:10240
    ds_read_b128 a[244:247], v25 offset:6144
    v_cvt_pk_bf16_f32 v232, v112, v113
    v_cvt_pk_bf16_f32 v233, v114, v115
    s_waitcnt lgkmcnt(12)
    v_mfma_f32_32x32x16_bf16 a[208:223], v[32:35], v[40:43], 0
    v_cvt_pk_bf16_f32 v234, v116, v117
    ds_read_b128 a[248:251], v25 offset:7168
    v_cvt_pk_bf16_f32 v235, v118, v119
    buffer_load_dwordx4 v6, s[16:19], s29 offen offset:2048 nt lds
    v_exp_f32 v128, v128
    s_waitcnt lgkmcnt(12)
    v_mfma_f32_32x32x16_bf16 a[224:239], v[32:35], v[44:47], 0
    ds_read_b128 a[252:255], v25 offset:8192
    v_exp_f32 v129, v129
    s_waitcnt lgkmcnt(10)
    v_mfma_f32_32x32x16_bf16 a[192:207], v[48:51], v[52:55], a[192:207]
    ds_read_b64_tr_b16 v[32:33], v23 offset:40960
    ds_read_b64_tr_b16 v[34:35], v23 offset:43008
    ds_read_b128 v[36:39], v25 offset:9216
    v_exp_f32 v130, v130
    s_waitcnt lgkmcnt(12)
    v_mfma_f32_32x32x16_bf16 a[208:223], v[48:51], v[56:59], a[208:223]
    v_exp_f32 v131, v131
    ds_read_b128 v[40:43], v25 offset:10240
    buffer_load_dwordx4 v6, s[16:19], s29 offen offset:3072 nt lds
    v_exp_f32 v132, v132
    s_waitcnt lgkmcnt(12)
    v_mfma_f32_32x32x16_bf16 a[224:239], v[48:51], v[60:63], a[224:239]
    ds_read_b128 v[44:47], v25 offset:11264
    v_exp_f32 v133, v133
    s_waitcnt vmcnt(20) lgkmcnt(0)
    s_barrier
    ds_read_b64_tr_b16 v[48:49], v22 offset:12288
    ds_read_b64_tr_b16 v[50:51], v22 offset:14336
    ds_read_b128 v[52:55], v25 offset:12288
    v_mfma_f32_32x32x16_bf16 a[192:207], a[240:243], a[244:247], a[192:207]
    ds_read_b128 v[56:59], v25 offset:13312
    v_mfma_f32_32x32x16_bf16 a[208:223], a[240:243], a[248:251], a[208:223]
    v_exp_f32 v134, v134
    ds_read_b128 v[60:63], v25 offset:14336
    ds_write_b128 v24, v[184:187] offset:0
    v_mfma_f32_32x32x16_bf16 a[224:239], a[240:243], a[252:255], a[224:239]
    v_exp_f32 v135, v135
    s_add_u32 m0, s28, 4096
    s_add_u32 s29, s97, 4096
    buffer_load_dwordx4 v6, s[16:19], s29 offen offset:0 nt lds
    v_mfma_f32_32x32x16_bf16 a[192:207], v[32:35], v[36:39], a[192:207]
    ds_read_b64_tr_b16 a[240:241], v22 offset:45056
    ds_read_b64_tr_b16 a[242:243], v22 offset:47104
    v_cvt_pk_bf16_f32 v240, v128, v129
    ds_read_b128 a[244:247], v25 offset:15360
    ds_write_b128 v24, v[192:195] offset:1024
    v_cvt_pk_bf16_f32 v241, v130, v131
    v_mfma_f32_32x32x16_bf16 a[208:223], v[32:35], v[40:43], a[208:223]
    ds_read_b128 a[248:251], v25 offset:16384
    v_cvt_pk_bf16_f32 v242, v132, v133
    v_mfma_f32_32x32x16_bf16 a[224:239], v[32:35], v[44:47], a[224:239]
    ds_read_b128 a[252:255], v25 offset:17408
    v_cvt_pk_bf16_f32 v243, v134, v135
    ds_write_b128 v24, v[200:203] offset:2048
    s_waitcnt lgkmcnt(10)
    v_mfma_f32_32x32x16_bf16 a[192:207], v[48:51], v[52:55], a[192:207]
    v_exp_f32 v144, v144
    ds_read_b64_tr_b16 v[32:33], v23 offset:12288
    ds_read_b64_tr_b16 v[34:35], v23 offset:14336
    ds_read_b128 v[36:39], v25 offset:18432
    buffer_load_dwordx4 v6, s[16:19], s29 offen offset:1024 nt lds
    s_waitcnt lgkmcnt(12)
    v_mfma_f32_32x32x16_bf16 a[208:223], v[48:51], v[56:59], a[208:223]
    ds_read_b128 v[40:43], v25 offset:19456
    v_exp_f32 v145, v145
    s_waitcnt lgkmcnt(12)
    v_mfma_f32_32x32x16_bf16 a[224:239], v[48:51], v[60:63], a[224:239]
    ds_read_b128 v[44:47], v25 offset:20480
    v_exp_f32 v146, v146
    v_mfma_f32_32x32x16_bf16 v[64:79], v[8:11], v[184:187], v[64:79]
    v_exp_f32 v147, v147
    v_mfma_f32_32x32x16_bf16 v[80:95], v[8:11], v[192:195], v[80:95]
    v_mfma_f32_32x32x16_bf16 v[96:111], v[8:11], v[200:203], v[96:111]
    v_exp_f32 v148, v148
    buffer_load_dwordx4 v6, s[16:19], s29 offen offset:2048 nt lds
    v_mfma_f32_32x32x16_bf16 v[64:79], v[8:11], v[188:191], v[64:79]
    v_exp_f32 v149, v149
    v_mfma_f32_32x32x16_bf16 v[80:95], v[8:11], v[196:199], v[80:95]
    v_exp_f32 v150, v150
    v_mfma_f32_32x32x16_bf16 v[96:111], v[8:11], v[204:207], v[96:111]
    v_exp_f32 v151, v151
    s_waitcnt lgkmcnt(9)
    v_mfma_f32_32x32x16_bf16 a[192:207], a[240:243], a[244:247], a[192:207]
    ds_read_b64_tr_b16 v[48:49], v23 offset:45056
    ds_read_b64_tr_b16 v[50:51], v23 offset:47104
    ds_read_b128 v[52:55], v25 offset:21504
    buffer_load_dwordx4 v6, s[16:19], s29 offen offset:3072 nt lds
    v_cvt_pk_bf16_f32 v248, v144, v145
    s_waitcnt lgkmcnt(10)
    v_mfma_f32_32x32x16_bf16 a[208:223], a[240:243], a[248:251], a[208:223]
    ds_read_b128 v[56:59], v25 offset:22528
    v_cvt_pk_bf16_f32 v249, v146, v147
    v_cvt_pk_bf16_f32 v250, v148, v149
    s_waitcnt lgkmcnt(10)
    v_mfma_f32_32x32x16_bf16 a[224:239], a[240:243], a[252:255], a[224:239]
    ds_read_b128 v[60:63], v25 offset:23552
    v_cvt_pk_bf16_f32 v251, v150, v151
    s_waitcnt vmcnt(20) lgkmcnt(0)
    s_barrier
    ds_read_b64_tr_b16 a[240:241], v22 offset:16384
    ds_read_b64_tr_b16 a[242:243], v22 offset:18432
    ds_read_b128 a[244:247], v25 offset:0
    v_mfma_f32_32x32x16_bf16 a[192:207], v[32:35], v[36:39], a[192:207]
    ds_read_b128 a[248:251], v25 offset:1024
    v_exp_f32 v120, v120
    v_mfma_f32_32x32x16_bf16 a[208:223], v[32:35], v[40:43], a[208:223]
    ds_read_b128 a[252:255], v25 offset:2048
    ds_write_b128 v24, v[188:191] offset:12288
    v_exp_f32 v121, v121
    v_mfma_f32_32x32x16_bf16 a[224:239], v[32:35], v[44:47], a[224:239]
    s_add_u32 m0, s28, 8192
    s_add_u32 s29, s94, 131072
    buffer_load_dwordx4 v2, s[12:15], s29 offen offset:0 nt lds
    v_exp_f32 v122, v122
    v_mfma_f32_32x32x16_bf16 a[192:207], v[48:51], v[52:55], a[192:207]
    ds_read_b64_tr_b16 v[32:33], v22 offset:49152
    ds_read_b64_tr_b16 v[34:35], v22 offset:51200
    ds_read_b128 v[36:39], v25 offset:3072
    ds_write_b128 v24, v[196:199] offset:13312
    v_exp_f32 v123, v123
    v_mfma_f32_32x32x16_bf16 a[208:223], v[48:51], v[56:59], a[208:223]
    ds_read_b128 v[40:43], v25 offset:4096
    v_exp_f32 v124, v124
    v_mfma_f32_32x32x16_bf16 a[224:239], v[48:51], v[60:63], a[224:239]
    ds_read_b128 v[44:47], v25 offset:5120
    v_exp_f32 v125, v125
    ds_write_b128 v24, v[204:207] offset:14336
    buffer_load_dwordx4 v3, s[12:15], s29 offen offset:1024 nt lds
    s_waitcnt lgkmcnt(10)
    v_mfma_f32_32x32x16_bf16 a[192:207], a[240:243], a[244:247], a[192:207]
    ds_read_b64_tr_b16 v[48:49], v23 offset:16384
    ds_read_b64_tr_b16 v[50:51], v23 offset:18432
    ds_read_b128 v[52:55], v25 offset:6144
    v_exp_f32 v126, v126
    s_waitcnt lgkmcnt(12)
    v_mfma_f32_32x32x16_bf16 a[208:223], a[240:243], a[248:251], a[208:223]
    ds_read_b128 v[56:59], v25 offset:7168
    v_exp_f32 v127, v127
    v_cvt_pk_bf16_f32 v236, v120, v121
    s_waitcnt lgkmcnt(12)
    v_mfma_f32_32x32x16_bf16 a[224:239], a[240:243], a[252:255], a[224:239]
    ds_read_b128 v[60:63], v25 offset:8192
    v_cvt_pk_bf16_f32 v237, v122, v123
    v_cvt_pk_bf16_f32 v238, v124, v125
    v_mfma_f32_32x32x16_bf16 v[64:79], v[8:11], v[208:211], v[64:79]
    v_cvt_pk_bf16_f32 v239, v126, v127
    buffer_load_dwordx4 v4, s[12:15], s29 offen offset:2048 nt lds
    v_exp_f32 v136, v136
    v_mfma_f32_32x32x16_bf16 v[80:95], v[8:11], v[216:219], v[80:95]
    v_exp_f32 v137, v137
    v_mfma_f32_32x32x16_bf16 v[96:111], v[8:11], v[224:227], v[96:111]
    v_exp_f32 v138, v138
    s_waitcnt lgkmcnt(9)
    v_mfma_f32_32x32x16_bf16 a[192:207], v[32:35], v[36:39], a[192:207]
    ds_read_b64_tr_b16 a[240:241], v23 offset:49152
    ds_read_b64_tr_b16 a[242:243], v23 offset:51200
    ds_read_b128 a[244:247], v25 offset:9216
    v_exp_f32 v139, v139
    s_waitcnt lgkmcnt(10)
    v_mfma_f32_32x32x16_bf16 a[208:223], v[32:35], v[40:43], a[208:223]
    buffer_load_dwordx4 v5, s[12:15], s29 offen offset:3072 nt lds
    ds_read_b128 a[248:251], v25 offset:10240
    v_exp_f32 v140, v140
    s_waitcnt lgkmcnt(10)
    v_mfma_f32_32x32x16_bf16 a[224:239], v[32:35], v[44:47], a[224:239]
    ds_read_b128 a[252:255], v25 offset:11264
    v_exp_f32 v141, v141
    s_waitcnt vmcnt(20) lgkmcnt(0)
    s_barrier
    ds_read_b64_tr_b16 v[32:33], v22 offset:20480
    ds_read_b64_tr_b16 v[34:35], v22 offset:22528
    ds_read_b128 v[36:39], v25 offset:12288
    v_mfma_f32_32x32x16_bf16 a[192:207], v[48:51], v[52:55], a[192:207]
    ds_read_b128 v[40:43], v25 offset:13312
    v_exp_f32 v142, v142
    v_mfma_f32_32x32x16_bf16 a[208:223], v[48:51], v[56:59], a[208:223]
    ds_read_b128 v[44:47], v25 offset:14336
    ds_write_b128 v24, v[208:211] offset:0
    v_exp_f32 v143, v143
    v_mfma_f32_32x32x16_bf16 a[224:239], v[48:51], v[60:63], a[224:239]
    s_add_u32 m0, s28, 12288
    s_add_u32 s29, s94, 135168
    buffer_load_dwordx4 v2, s[12:15], s29 offen offset:0 nt lds
    v_cvt_pk_bf16_f32 v244, v136, v137
    v_mfma_f32_32x32x16_bf16 a[192:207], a[240:243], a[244:247], a[192:207]
    ds_read_b64_tr_b16 v[48:49], v22 offset:53248
    ds_read_b64_tr_b16 v[50:51], v22 offset:55296
    v_cvt_pk_bf16_f32 v245, v138, v139
    ds_read_b128 v[52:55], v25 offset:15360
    ds_write_b128 v24, v[216:219] offset:1024
    v_cvt_pk_bf16_f32 v246, v140, v141
    v_mfma_f32_32x32x16_bf16 a[208:223], a[240:243], a[248:251], a[208:223]
    ds_read_b128 v[56:59], v25 offset:16384
    v_cvt_pk_bf16_f32 v247, v142, v143
    v_mfma_f32_32x32x16_bf16 a[224:239], a[240:243], a[252:255], a[224:239]
    v_exp_f32 v152, v152
    ds_read_b128 v[60:63], v25 offset:17408
    ds_write_b128 v24, v[224:227] offset:2048
    buffer_load_dwordx4 v3, s[12:15], s29 offen offset:1024 nt lds
    s_waitcnt lgkmcnt(10)
    v_mfma_f32_32x32x16_bf16 a[192:207], v[32:35], v[36:39], a[192:207]
    ds_read_b64_tr_b16 a[240:241], v23 offset:20480
    v_exp_f32 v153, v153
    ds_read_b64_tr_b16 a[242:243], v23 offset:22528
    ds_read_b128 a[244:247], v25 offset:18432
    s_waitcnt lgkmcnt(12)
    v_mfma_f32_32x32x16_bf16 a[208:223], v[32:35], v[40:43], a[208:223]
    ds_read_b128 a[248:251], v25 offset:19456
    v_exp_f32 v154, v154
    s_waitcnt lgkmcnt(12)
    v_mfma_f32_32x32x16_bf16 a[224:239], v[32:35], v[44:47], a[224:239]
    ds_read_b128 a[252:255], v25 offset:20480
    v_exp_f32 v155, v155
    v_mfma_f32_32x32x16_bf16 v[64:79], v[8:11], v[212:215], v[64:79]
    v_exp_f32 v156, v156
    buffer_load_dwordx4 v4, s[12:15], s29 offen offset:2048 nt lds
    v_mfma_f32_32x32x16_bf16 v[80:95], v[8:11], v[220:223], v[80:95]
    v_exp_f32 v157, v157
    v_mfma_f32_32x32x16_bf16 v[96:111], v[8:11], v[228:231], v[96:111]
    v_exp_f32 v158, v158
    s_waitcnt lgkmcnt(9)
    v_mfma_f32_32x32x16_bf16 a[192:207], v[48:51], v[52:55], a[192:207]
    ds_read_b64_tr_b16 v[32:33], v23 offset:53248
    ds_read_b64_tr_b16 v[34:35], v23 offset:55296
    v_exp_f32 v159, v159
    ds_read_b128 v[36:39], v25 offset:21504
    s_waitcnt lgkmcnt(10)
    v_mfma_f32_32x32x16_bf16 a[208:223], v[48:51], v[56:59], a[208:223]
    v_cvt_pk_bf16_f32 v252, v152, v153
    buffer_load_dwordx4 v5, s[12:15], s29 offen offset:3072 nt lds
    ds_read_b128 v[40:43], v25 offset:22528
    v_cvt_pk_bf16_f32 v253, v154, v155
    s_waitcnt lgkmcnt(10)
    v_mfma_f32_32x32x16_bf16 a[224:239], v[48:51], v[60:63], a[224:239]
    v_cvt_pk_bf16_f32 v254, v156, v157
    ds_read_b128 v[44:47], v25 offset:23552
    v_cvt_pk_bf16_f32 v255, v158, v159
    s_waitcnt vmcnt(20) lgkmcnt(0)
    s_barrier
    ds_read_b64_tr_b16 v[48:49], v22 offset:24576
    ds_read_b64_tr_b16 v[50:51], v22 offset:26624
    ds_read_b128 v[52:55], v25 offset:0
    v_mfma_f32_32x32x16_bf16 a[192:207], a[240:243], a[244:247], a[192:207]
    ds_read_b128 v[56:59], v25 offset:1024
    v_mfma_f32_32x32x16_bf16 a[208:223], a[240:243], a[248:251], a[208:223]
    ds_read_b128 v[60:63], v25 offset:2048
    ds_write_b128 v24, v[212:215] offset:12288
    v_mfma_f32_32x32x16_bf16 a[224:239], a[240:243], a[252:255], a[224:239]
    s_add_u32 m0, s28, 16384
    s_add_u32 s29, s95, 131072
    buffer_load_dwordx4 v2, s[12:15], s29 offen offset:0 nt lds
    v_mfma_f32_32x32x16_bf16 a[192:207], v[32:35], v[36:39], a[192:207]
    ds_read_b64_tr_b16 a[240:241], v22 offset:57344
    ds_read_b64_tr_b16 a[242:243], v22 offset:59392
    ds_read_b128 a[244:247], v25 offset:3072
    ds_write_b128 v24, v[220:223] offset:13312
    v_mfma_f32_32x32x16_bf16 a[208:223], v[32:35], v[40:43], a[208:223]
    ds_read_b128 a[248:251], v25 offset:4096
    v_mfma_f32_32x32x16_bf16 a[224:239], v[32:35], v[44:47], a[224:239]
    ds_read_b128 a[252:255], v25 offset:5120
    ds_write_b128 v24, v[228:231] offset:14336
    buffer_load_dwordx4 v3, s[12:15], s29 offen offset:1024 nt lds
    s_waitcnt lgkmcnt(10)
    v_mfma_f32_32x32x16_bf16 a[192:207], v[48:51], v[52:55], a[192:207]
    ds_read_b64_tr_b16 v[32:33], v23 offset:24576
    ds_read_b64_tr_b16 v[34:35], v23 offset:26624
    ds_read_b128 v[36:39], v25 offset:6144
    s_waitcnt lgkmcnt(12)
    v_mfma_f32_32x32x16_bf16 a[208:223], v[48:51], v[56:59], a[208:223]
    ds_read_b128 v[40:43], v25 offset:7168
    s_waitcnt lgkmcnt(12)
    v_mfma_f32_32x32x16_bf16 a[224:239], v[48:51], v[60:63], a[224:239]
    ds_read_b128 v[44:47], v25 offset:8192
    v_mfma_f32_32x32x16_bf16 v[64:79], v[8:11], v[232:235], v[64:79]
    buffer_load_dwordx4 v4, s[12:15], s29 offen offset:2048 nt lds
    v_mfma_f32_32x32x16_bf16 v[80:95], v[8:11], v[240:243], v[80:95]
    v_mfma_f32_32x32x16_bf16 v[96:111], v[8:11], v[248:251], v[96:111]
    s_waitcnt lgkmcnt(9)
    v_mfma_f32_32x32x16_bf16 a[192:207], a[240:243], a[244:247], a[192:207]
    ds_read_b64_tr_b16 v[48:49], v23 offset:57344
    ds_read_b64_tr_b16 v[50:51], v23 offset:59392
    ds_read_b128 v[52:55], v25 offset:9216
    s_waitcnt lgkmcnt(10)
    v_mfma_f32_32x32x16_bf16 a[208:223], a[240:243], a[248:251], a[208:223]
    buffer_load_dwordx4 v5, s[12:15], s29 offen offset:3072 nt lds
    ds_read_b128 v[56:59], v25 offset:10240
    s_waitcnt lgkmcnt(10)
    v_mfma_f32_32x32x16_bf16 a[224:239], a[240:243], a[252:255], a[224:239]
    ds_read_b128 v[60:63], v25 offset:11264
    s_waitcnt vmcnt(20) lgkmcnt(0)
    s_barrier
    ds_read_b64_tr_b16 a[240:241], v22 offset:28672
    ds_read_b64_tr_b16 a[242:243], v22 offset:30720
    ds_read_b128 a[244:247], v25 offset:12288
    v_mfma_f32_32x32x16_bf16 a[192:207], v[32:35], v[36:39], a[192:207]
    ds_read_b128 a[248:251], v25 offset:13312
    v_mfma_f32_32x32x16_bf16 a[208:223], v[32:35], v[40:43], a[208:223]
    ds_read_b128 a[252:255], v25 offset:14336
    ds_write_b128 v24, v[232:235] offset:0
    v_mfma_f32_32x32x16_bf16 a[224:239], v[32:35], v[44:47], a[224:239]
    s_add_u32 m0, s28, 20480
    s_add_u32 s29, s95, 135168
    buffer_load_dwordx4 v2, s[12:15], s29 offen offset:0 nt lds
    v_mfma_f32_32x32x16_bf16 a[192:207], v[48:51], v[52:55], a[192:207]
    ds_read_b64_tr_b16 v[32:33], v22 offset:61440
    ds_read_b64_tr_b16 v[34:35], v22 offset:63488
    ds_read_b128 v[36:39], v25 offset:15360
    ds_write_b128 v24, v[240:243] offset:1024
    v_mfma_f32_32x32x16_bf16 a[208:223], v[48:51], v[56:59], a[208:223]
    ds_read_b128 v[40:43], v25 offset:16384
    v_mfma_f32_32x32x16_bf16 a[224:239], v[48:51], v[60:63], a[224:239]
    ds_read_b128 v[44:47], v25 offset:17408
    ds_write_b128 v24, v[248:251] offset:2048
    buffer_load_dwordx4 v3, s[12:15], s29 offen offset:1024 nt lds
    s_waitcnt lgkmcnt(10)
    v_mfma_f32_32x32x16_bf16 a[192:207], a[240:243], a[244:247], a[192:207]
    ds_read_b64_tr_b16 v[48:49], v23 offset:28672
    ds_read_b64_tr_b16 v[50:51], v23 offset:30720
    ds_read_b128 v[52:55], v25 offset:18432
    s_waitcnt lgkmcnt(12)
    v_mfma_f32_32x32x16_bf16 a[208:223], a[240:243], a[248:251], a[208:223]
    ds_read_b128 v[56:59], v25 offset:19456
    s_waitcnt lgkmcnt(12)
    v_mfma_f32_32x32x16_bf16 a[224:239], a[240:243], a[252:255], a[224:239]
    ds_read_b128 v[60:63], v25 offset:20480
    v_mfma_f32_32x32x16_bf16 v[64:79], v[8:11], v[236:239], v[64:79]
    buffer_load_dwordx4 v4, s[12:15], s29 offen offset:2048 nt lds
    v_mfma_f32_32x32x16_bf16 v[80:95], v[8:11], v[244:247], v[80:95]
    v_mfma_f32_32x32x16_bf16 v[96:111], v[8:11], v[252:255], v[96:111]
    s_waitcnt lgkmcnt(9)
    v_mfma_f32_32x32x16_bf16 a[192:207], v[32:35], v[36:39], a[192:207]
    ds_read_b64_tr_b16 a[240:241], v23 offset:61440
    ds_read_b64_tr_b16 a[242:243], v23 offset:63488
    ds_read_b128 a[244:247], v25 offset:21504
    s_waitcnt lgkmcnt(10)
    v_mfma_f32_32x32x16_bf16 a[208:223], v[32:35], v[40:43], a[208:223]
    buffer_load_dwordx4 v5, s[12:15], s29 offen offset:3072 nt lds
    ds_read_b128 a[248:251], v25 offset:22528
    s_waitcnt lgkmcnt(10)
    v_mfma_f32_32x32x16_bf16 a[224:239], v[32:35], v[44:47], a[224:239]
    ds_read_b128 a[252:255], v25 offset:23552
    s_waitcnt vmcnt(20) lgkmcnt(0)
    s_barrier
    ds_read_b64_tr_b16 v[32:33], v22 offset:0
    ds_read_b64_tr_b16 v[34:35], v22 offset:2048
    ds_read_b128 v[36:39], v25 offset:0
    v_mfma_f32_32x32x16_bf16 a[192:207], v[48:51], v[52:55], a[192:207]
    ds_read_b128 v[40:43], v25 offset:1024
    v_mfma_f32_32x32x16_bf16 a[208:223], v[48:51], v[56:59], a[208:223]
    ds_read_b128 v[44:47], v25 offset:2048
    ds_write_b128 v24, v[236:239] offset:12288
    s_add_u32 m0, s28, 24576
    s_add_u32 s29, s96, 131072
    buffer_load_dwordx4 v2, s[12:15], s29 offen offset:0 nt lds
    v_mfma_f32_32x32x16_bf16 a[224:239], v[48:51], v[60:63], a[224:239]
    v_mfma_f32_32x32x16_bf16 a[192:207], a[240:243], a[244:247], a[192:207]
    ds_read_b64_tr_b16 v[48:49], v22 offset:32768
    ds_read_b64_tr_b16 v[50:51], v22 offset:34816
    ds_read_b128 v[52:55], v25 offset:3072
    ds_write_b128 v24, v[244:247] offset:13312
    v_mfma_f32_32x32x16_bf16 a[208:223], a[240:243], a[248:251], a[208:223]
    ds_read_b128 v[56:59], v25 offset:4096
    buffer_load_dwordx4 v3, s[12:15], s29 offen offset:1024 nt lds
    v_mfma_f32_32x32x16_bf16 a[224:239], a[240:243], a[252:255], a[224:239]
    ds_read_b128 v[60:63], v25 offset:5120
    ds_write_b128 v24, v[252:255] offset:14336
    s_waitcnt lgkmcnt(10)
    v_mfma_f32_32x32x16_bf16 a[192:207], v[32:35], v[36:39], a[192:207]
    ds_read_b64_tr_b16 a[240:241], v23 offset:0
    ds_read_b64_tr_b16 a[242:243], v23 offset:2048
    ds_read_b128 a[244:247], v25 offset:6144
    s_waitcnt lgkmcnt(12)
    v_mfma_f32_32x32x16_bf16 a[208:223], v[32:35], v[40:43], a[208:223]
    ds_read_b128 a[248:251], v25 offset:7168
    buffer_load_dwordx4 v4, s[12:15], s29 offen offset:2048 nt lds
    ds_write_b32 v26, v64 offset:1536
    ds_write_b32 v26, v80 offset:2048
    ds_write_b32 v26, v96 offset:2560
    s_waitcnt lgkmcnt(15)
    v_mfma_f32_32x32x16_bf16 a[224:239], v[32:35], v[44:47], a[224:239]
    ds_read_b128 a[252:255], v25 offset:8192
    s_waitcnt lgkmcnt(12)
    v_mfma_f32_32x32x16_bf16 a[192:207], v[48:51], v[52:55], a[192:207]
    ds_read_b64_tr_b16 v[32:33], v23 offset:32768
    ds_read_b64_tr_b16 v[34:35], v23 offset:34816
    ds_read_b128 v[36:39], v25 offset:9216
    s_waitcnt lgkmcnt(13)
    v_mfma_f32_32x32x16_bf16 a[208:223], v[48:51], v[56:59], a[208:223]
    ds_read_b128 v[40:43], v25 offset:10240
    buffer_load_dwordx4 v5, s[12:15], s29 offen offset:3072 nt lds
    s_waitcnt lgkmcnt(13)
    v_mfma_f32_32x32x16_bf16 a[224:239], v[48:51], v[60:63], a[224:239]
    ds_read_b128 v[44:47], v25 offset:11264
    s_waitcnt vmcnt(20) lgkmcnt(0)
    s_barrier
    ds_read_b64_tr_b16 v[48:49], v22 offset:4096
    ds_read_b64_tr_b16 v[50:51], v22 offset:6144
    ds_read_b128 v[52:55], v25 offset:12288
    v_mfma_f32_32x32x16_bf16 a[192:207], a[240:243], a[244:247], a[192:207]
    ds_read_b128 v[56:59], v25 offset:13312
    v_mfma_f32_32x32x16_bf16 a[208:223], a[240:243], a[248:251], a[208:223]
    ds_read_b128 v[60:63], v25 offset:14336
    v_mfma_f32_32x32x16_bf16 a[224:239], a[240:243], a[252:255], a[224:239]
    s_add_u32 m0, s28, 28672
    s_add_u32 s29, s96, 135168
    buffer_load_dwordx4 v2, s[12:15], s29 offen offset:0 nt lds
    v_mfma_f32_32x32x16_bf16 a[192:207], v[32:35], v[36:39], a[192:207]
    ds_read_b64_tr_b16 a[240:241], v22 offset:36864
    ds_read_b64_tr_b16 a[242:243], v22 offset:38912
    ds_read_b128 v[112:115], v27 offset:1536
    ds_read_b128 v[116:119], v27 offset:2048
    ds_read_b128 v[120:123], v27 offset:2560
    ds_read_b128 a[244:247], v25 offset:15360
    v_mfma_f32_32x32x16_bf16 a[208:223], v[32:35], v[40:43], a[208:223]
    ds_read_b128 a[248:251], v25 offset:16384
    v_mfma_f32_32x32x16_bf16 a[224:239], v[32:35], v[44:47], a[224:239]
    ds_read_b128 a[252:255], v25 offset:17408
    s_waitcnt lgkmcnt(10)
    v_mfma_f32_32x32x16_bf16 a[192:207], v[48:51], v[52:55], a[192:207]
    ds_read_b64_tr_b16 v[32:33], v23 offset:4096
    ds_read_b64_tr_b16 v[34:35], v23 offset:6144
    ds_read_b128 v[36:39], v25 offset:18432
    buffer_load_dwordx4 v3, s[12:15], s29 offen offset:1024 nt lds
    s_waitcnt lgkmcnt(12)
    v_mfma_f32_32x32x16_bf16 a[208:223], v[48:51], v[56:59], a[208:223]
    ds_read_b128 v[40:43], v25 offset:19456
    s_waitcnt lgkmcnt(12)
    v_mfma_f32_32x32x16_bf16 a[224:239], v[48:51], v[60:63], a[224:239]
    ds_read_b128 v[44:47], v25 offset:20480
    s_waitcnt lgkmcnt(7)
    v_mfma_f32_32x32x16_bf16 a[192:207], a[240:243], a[244:247], a[192:207]
    ds_read_b64_tr_b16 v[48:49], v23 offset:36864
    ds_read_b64_tr_b16 v[50:51], v23 offset:38912
    s_mov_b32 s50, 0x30800000
    s_mov_b32 s51, 0x4e800000
    v_add_f32 v112, v112, v113
    v_add_f32 v114, v114, v115
    v_add_f32 v112, v112, v114
    v_add_f32 v116, v116, v117
    v_add_f32 v118, v118, v119
    v_add_f32 v116, v116, v118
    v_add_f32 v120, v120, v121
    v_add_f32 v122, v122, v123
    v_add_f32 v120, v120, v122
    v_min3_f32 v113, v112, v116, v120
    v_max3_f32 v114, v112, v116, v120
    v_cmp_u_f32 vcc, v112, v116
    v_cmp_u_f32 s[0:1], v120, v120
    s_or_b64 s[0:1], vcc, s[0:1]
    v_cmp_nle_f32 vcc, s50, v113
    s_or_b64 s[0:1], vcc, s[0:1]
    v_cmp_nge_f32 vcc, s51, v114
    s_or_b64 s[0:1], vcc, s[0:1]
    v_rcp_f32 v124, v112
    v_rcp_f32 v125, v112
    v_rcp_f32 v126, v116
    v_rcp_f32 v127, v116
    v_rcp_f32 v128, v120
    v_rcp_f32 v129, v120
    ds_read_b128 v[52:55], v25 offset:21504
    s_waitcnt lgkmcnt(9)
    v_mfma_f32_32x32x16_bf16 a[208:223], a[240:243], a[248:251], a[208:223]
    ds_read_b128 v[56:59], v25 offset:22528
    s_waitcnt lgkmcnt(9)
    v_mfma_f32_32x32x16_bf16 a[224:239], a[240:243], a[252:255], a[224:239]
    ds_read_b128 v[60:63], v25 offset:23552
    buffer_load_dwordx4 v4, s[12:15], s29 offen offset:2048 nt lds
    s_waitcnt lgkmcnt(7)
    v_mfma_f32_32x32x16_bf16 a[192:207], v[32:35], v[36:39], a[192:207]
    s_waitcnt lgkmcnt(6)
    v_mfma_f32_32x32x16_bf16 a[208:223], v[32:35], v[40:43], a[208:223]
    s_waitcnt lgkmcnt(5)
    v_mfma_f32_32x32x16_bf16 a[224:239], v[32:35], v[44:47], a[224:239]
    s_waitcnt lgkmcnt(2)
    v_mfma_f32_32x32x16_bf16 a[192:207], v[48:51], v[52:55], a[192:207]
    buffer_load_dwordx4 v5, s[12:15], s29 offen offset:3072 nt lds
    s_waitcnt lgkmcnt(1)
    v_mfma_f32_32x32x16_bf16 a[208:223], v[48:51], v[56:59], a[208:223]
    s_waitcnt lgkmcnt(0)
    v_mfma_f32_32x32x16_bf16 a[224:239], v[48:51], v[60:63], a[224:239]
    s_barrier
    s_mov_b64 vcc, s[0:1]
    s_and_b64 vcc, vcc, s[38:39]
    s_cbranch_vccnz L_slow0
L_epi0:
    s_mov_b64 s[38:39], -1
    s_add_u32 m0, s28, 0
    s_add_u32 s29, s97, 131072
    buffer_load_dwordx4 v2, s[12:15], s29 offen offset:0 nt lds
    v_accvgpr_read_b32 v160, a192
    v_accvgpr_read_b32 v161, a193
    v_accvgpr_read_b32 v162, a194
    v_accvgpr_read_b32 v163, a195
    v_accvgpr_read_b32 v164, a196
    v_accvgpr_read_b32 v165, a197
    v_accvgpr_read_b32 v166, a198
    v_accvgpr_read_b32 v167, a199
    v_accvgpr_read_b32 v168, a200
    v_accvgpr_read_b32 v169, a201
    v_accvgpr_read_b32 v170, a202
    v_accvgpr_read_b32 v171, a203
    v_accvgpr_read_b32 v172, a204
    v_accvgpr_read_b32 v173, a205
    v_accvgpr_read_b32 v174, a206
    v_accvgpr_read_b32 v175, a207
    v_pk_mul_f32 v[160:161], v[160:161], v[124:125]
    v_pk_mul_f32 v[162:163], v[162:163], v[124:125]
    v_pk_mul_f32 v[164:165], v[164:165], v[124:125]
    v_pk_mul_f32 v[166:167], v[166:167], v[124:125]
    v_pk_mul_f32 v[168:169], v[168:169], v[124:125]
    v_pk_mul_f32 v[170:171], v[170:171], v[124:125]
    v_pk_mul_f32 v[172:173], v[172:173], v[124:125]
    v_pk_mul_f32 v[174:175], v[174:175], v[124:125]
    v_cvt_pk_bf16_f32 v176, v160, v161
    v_cvt_pk_bf16_f32 v177, v162, v163
    v_cvt_pk_bf16_f32 v178, v164, v165
    v_cvt_pk_bf16_f32 v179, v166, v167
    v_cvt_pk_bf16_f32 v180, v168, v169
    v_cvt_pk_bf16_f32 v181, v170, v171
    v_cvt_pk_bf16_f32 v182, v172, v173
    v_cvt_pk_bf16_f32 v183, v174, v175
    v_accvgpr_write_b32 a0, v176
    v_accvgpr_write_b32 a1, v177
    v_accvgpr_write_b32 a2, v178
    v_accvgpr_write_b32 a3, v179
    v_accvgpr_write_b32 a12, v180
    v_accvgpr_write_b32 a13, v181
    v_accvgpr_write_b32 a14, v182
    v_accvgpr_write_b32 a15, v183
    buffer_load_dwordx4 v3, s[12:15], s29 offen offset:1024 nt lds
    v_accvgpr_read_b32 v184, a208
    v_accvgpr_read_b32 v185, a209
    v_accvgpr_read_b32 v186, a210
    v_accvgpr_read_b32 v187, a211
    v_accvgpr_read_b32 v188, a212
    v_accvgpr_read_b32 v189, a213
    v_accvgpr_read_b32 v190, a214
    v_accvgpr_read_b32 v191, a215
    v_accvgpr_read_b32 v192, a216
    v_accvgpr_read_b32 v193, a217
    v_accvgpr_read_b32 v194, a218
    v_accvgpr_read_b32 v195, a219
    v_accvgpr_read_b32 v196, a220
    v_accvgpr_read_b32 v197, a221
    v_accvgpr_read_b32 v198, a222
    v_accvgpr_read_b32 v199, a223
    v_pk_mul_f32 v[184:185], v[184:185], v[126:127]
    v_pk_mul_f32 v[186:187], v[186:187], v[126:127]
    v_pk_mul_f32 v[188:189], v[188:189], v[126:127]
    v_pk_mul_f32 v[190:191], v[190:191], v[126:127]
    v_pk_mul_f32 v[192:193], v[192:193], v[126:127]
    v_pk_mul_f32 v[194:195], v[194:195], v[126:127]
    v_pk_mul_f32 v[196:197], v[196:197], v[126:127]
    v_pk_mul_f32 v[198:199], v[198:199], v[126:127]
    v_cvt_pk_bf16_f32 v200, v184, v185
    v_cvt_pk_bf16_f32 v201, v186, v187
    v_cvt_pk_bf16_f32 v202, v188, v189
    v_cvt_pk_bf16_f32 v203, v190, v191
    v_cvt_pk_bf16_f32 v204, v192, v193
    v_cvt_pk_bf16_f32 v205, v194, v195
    v_cvt_pk_bf16_f32 v206, v196, v197
    v_cvt_pk_bf16_f32 v207, v198, v199
    v_accvgpr_write_b32 a4, v200
    v_accvgpr_write_b32 a5, v201
    v_accvgpr_write_b32 a6, v202
    v_accvgpr_write_b32 a7, v203
    v_accvgpr_write_b32 a16, v204
    v_accvgpr_write_b32 a17, v205
    v_accvgpr_write_b32 a18, v206
    v_accvgpr_write_b32 a19, v207
    buffer_load_dwordx4 v4, s[12:15], s29 offen offset:2048 nt lds
    buffer_load_dwordx4 v5, s[12:15], s29 offen offset:3072 nt lds
    v_accvgpr_read_b32 v208, a224
    v_accvgpr_read_b32 v209, a225
    v_accvgpr_read_b32 v210, a226
    v_accvgpr_read_b32 v211, a227
    v_accvgpr_read_b32 v212, a228
    v_accvgpr_read_b32 v213, a229
    v_accvgpr_read_b32 v214, a230
    v_accvgpr_read_b32 v215, a231
    v_accvgpr_read_b32 v216, a232
    v_accvgpr_read_b32 v217, a233
    v_accvgpr_read_b32 v218, a234
    v_accvgpr_read_b32 v219, a235
    v_accvgpr_read_b32 v220, a236
    v_accvgpr_read_b32 v221, a237
    v_accvgpr_read_b32 v222, a238
    v_accvgpr_read_b32 v223, a239
    v_pk_mul_f32 v[208:209], v[208:209], v[128:129]
    v_pk_mul_f32 v[210:211], v[210:211], v[128:129]
    v_pk_mul_f32 v[212:213], v[212:213], v[128:129]
    v_pk_mul_f32 v[214:215], v[214:215], v[128:129]
    v_pk_mul_f32 v[216:217], v[216:217], v[128:129]
    v_pk_mul_f32 v[218:219], v[218:219], v[128:129]
    v_pk_mul_f32 v[220:221], v[220:221], v[128:129]
    v_pk_mul_f32 v[222:223], v[222:223], v[128:129]
    v_cvt_pk_bf16_f32 v224, v208, v209
    v_cvt_pk_bf16_f32 v225, v210, v211
    v_cvt_pk_bf16_f32 v226, v212, v213
    v_cvt_pk_bf16_f32 v227, v214, v215
    v_cvt_pk_bf16_f32 v228, v216, v217
    v_cvt_pk_bf16_f32 v229, v218, v219
    v_cvt_pk_bf16_f32 v230, v220, v221
    v_cvt_pk_bf16_f32 v231, v222, v223
    v_accvgpr_write_b32 a8, v224
    v_accvgpr_write_b32 a9, v225
    v_accvgpr_write_b32 a10, v226
    v_accvgpr_write_b32 a11, v227
    v_accvgpr_write_b32 a20, v228
    v_accvgpr_write_b32 a21, v229
    v_accvgpr_write_b32 a22, v230
    v_accvgpr_write_b32 a23, v231
    s_add_u32 s26, s33, 0
    s_add_u32 s50, s26, 4096
    buffer_store_dwordx4 v[176:179], v7, s[20:23], s26 offen offset:0 sc1
    buffer_store_dwordx4 v[200:203], v7, s[20:23], s26 offen offset:1024 sc1
    buffer_store_dwordx4 v[224:227], v7, s[20:23], s26 offen offset:2048 sc1
    buffer_store_dwordx4 v[180:183], v7, s[20:23], s26 offen offset:3072 sc1
    buffer_store_dwordx4 v[204:207], v7, s[20:23], s50 offen offset:0 sc1
    buffer_store_dwordx4 v[228:231], v7, s[20:23], s50 offen offset:1024 sc1
    s_waitcnt vmcnt(26)
    ds_read_b128 v[32:35], v12 offset:8192
    ds_read_b128 v[36:39], v13 offset:8192
    ds_read_b128 v[40:43], v14 offset:8192
    ds_read_b128 v[44:47], v15 offset:8192
    s_waitcnt lgkmcnt(3)
    v_mfma_f32_32x32x16_bf16 v[64:79], v[32:35], a[96:99], 0
    ds_read_b128 v[48:51], v16 offset:8192
    v_mfma_f32_32x32x16_bf16 v[80:95], v[32:35], a[100:103], 0
    ds_read_b128 v[52:55], v17 offset:8192
    s_add_u32 m0, s28, 4096
    s_add_u32 s29, s97, 135168
    buffer_load_dwordx4 v2, s[12:15], s29 offen offset:0 nt lds
    v_mfma_f32_32x32x16_bf16 v[96:111], v[32:35], a[104:107], 0
    ds_read_b128 v[56:59], v18 offset:8192
    s_waitcnt lgkmcnt(5)
    v_mfma_f32_32x32x16_bf16 v[64:79], v[36:39], a[108:111], v[64:79]
    ds_read_b128 v[60:63], v19 offset:8192
    v_mfma_f32_32x32x16_bf16 v[80:95], v[36:39], a[112:115], v[80:95]
    buffer_load_dwordx4 v3, s[12:15], s29 offen offset:1024 nt lds
    v_mfma_f32_32x32x16_bf16 v[96:111], v[36:39], a[116:119], v[96:111]
    s_waitcnt lgkmcnt(5)
    v_mfma_f32_32x32x16_bf16 v[64:79], v[40:43], a[120:123], v[64:79]
    v_mfma_f32_32x32x16_bf16 v[80:95], v[40:43], a[124:127], v[80:95]
    buffer_load_dwordx4 v4, s[12:15], s29 offen offset:2048 nt lds
    v_mfma_f32_32x32x16_bf16 v[96:111], v[40:43], a[128:131], v[96:111]
    s_waitcnt lgkmcnt(4)
    v_mfma_f32_32x32x16_bf16 v[64:79], v[44:47], a[132:135], v[64:79]
    v_mfma_f32_32x32x16_bf16 v[80:95], v[44:47], a[136:139], v[80:95]
    buffer_load_dwordx4 v5, s[12:15], s29 offen offset:3072 nt lds
    v_mfma_f32_32x32x16_bf16 v[96:111], v[44:47], a[140:143], v[96:111]
    s_waitcnt lgkmcnt(3)
    v_mfma_f32_32x32x16_bf16 v[64:79], v[48:51], a[144:147], v[64:79]
    s_waitcnt vmcnt(22)
    v_mfma_f32_32x32x16_bf16 v[80:95], v[48:51], a[148:151], v[80:95]
    ds_read_b128 v[32:35], v12 offset:16384
    v_mfma_f32_32x32x16_bf16 v[96:111], v[48:51], a[152:155], v[96:111]
    s_waitcnt lgkmcnt(3)
    v_mfma_f32_32x32x16_bf16 v[64:79], v[52:55], a[156:159], v[64:79]
    v_mfma_f32_32x32x16_bf16 v[80:95], v[52:55], a[160:163], v[80:95]
    ds_read_b128 v[36:39], v13 offset:16384
    v_mfma_f32_32x32x16_bf16 v[96:111], v[52:55], a[164:167], v[96:111]
    s_waitcnt lgkmcnt(3)
    v_mfma_f32_32x32x16_bf16 v[64:79], v[56:59], a[168:171], v[64:79]
    v_mfma_f32_32x32x16_bf16 v[80:95], v[56:59], a[172:175], v[80:95]
    ds_read_b128 v[40:43], v14 offset:16384
    v_mfma_f32_32x32x16_bf16 v[96:111], v[56:59], a[176:179], v[96:111]
    s_waitcnt lgkmcnt(3)
    v_mfma_f32_32x32x16_bf16 v[64:79], v[60:63], a[180:183], v[64:79]
    v_mfma_f32_32x32x16_bf16 v[80:95], v[60:63], a[184:187], v[80:95]
    ds_read_b128 v[44:47], v15 offset:16384
    v_mfma_f32_32x32x16_bf16 v[96:111], v[60:63], a[188:191], v[96:111]
    s_waitcnt lgkmcnt(3)
    v_mfma_f32_32x32x16_bf16 v[112:127], v[32:35], a[96:99], 0
    ds_read_b128 v[48:51], v16 offset:16384
    v_mfma_f32_32x32x16_bf16 v[128:143], v[32:35], a[100:103], 0
    ds_read_b128 v[52:55], v17 offset:16384
    v_mfma_f32_32x32x16_bf16 v[144:159], v[32:35], a[104:107], 0
    ds_read_b128 v[56:59], v18 offset:16384
    s_waitcnt lgkmcnt(5)
    v_mfma_f32_32x32x16_bf16 v[112:127], v[36:39], a[108:111], v[112:127]
    ds_read_b128 v[60:63], v19 offset:16384
    v_exp_f32 v64, v64
    s_add_u32 m0, s28, 8192
    s_add_u32 s29, s94, 131072
    buffer_load_dwordx4 v6, s[16:19], s29 offen offset:0 nt lds
    v_exp_f32 v65, v65
    v_exp_f32 v66, v66
    v_mfma_f32_32x32x16_bf16 v[128:143], v[36:39], a[112:115], v[128:143]
    v_exp_f32 v67, v67
    v_exp_f32 v68, v68
    v_exp_f32 v69, v69
    v_mfma_f32_32x32x16_bf16 v[144:159], v[36:39], a[116:119], v[144:159]
    v_exp_f32 v70, v70
    v_exp_f32 v71, v71
    v_cvt_pk_bf16_f32 v160, v64, v65
    s_waitcnt lgkmcnt(5)
    v_mfma_f32_32x32x16_bf16 v[112:127], v[40:43], a[120:123], v[112:127]
    v_cvt_pk_bf16_f32 v161, v66, v67
    v_cvt_pk_bf16_f32 v162, v68, v69
    v_cvt_pk_bf16_f32 v163, v70, v71
    v_exp_f32 v80, v80
    v_mfma_f32_32x32x16_bf16 v[128:143], v[40:43], a[124:127], v[128:143]
    v_exp_f32 v81, v81
    v_exp_f32 v82, v82
    v_exp_f32 v83, v83
    v_mfma_f32_32x32x16_bf16 v[144:159], v[40:43], a[128:131], v[144:159]
    v_exp_f32 v84, v84
    v_exp_f32 v85, v85
    v_exp_f32 v86, v86
    s_waitcnt lgkmcnt(4)
    v_mfma_f32_32x32x16_bf16 v[112:127], v[44:47], a[132:135], v[112:127]
    v_exp_f32 v87, v87
    buffer_load_dwordx4 v6, s[16:19], s29 offen offset:1024 nt lds
    v_cvt_pk_bf16_f32 v168, v80, v81
    v_cvt_pk_bf16_f32 v169, v82, v83
    v_cvt_pk_bf16_f32 v170, v84, v85
    v_cvt_pk_bf16_f32 v171, v86, v87
    v_mfma_f32_32x32x16_bf16 v[128:143], v[44:47], a[136:139], v[128:143]
    v_exp_f32 v96, v96
    v_exp_f32 v97, v97
    v_exp_f32 v98, v98
    v_mfma_f32_32x32x16_bf16 v[144:159], v[44:47], a[140:143], v[144:159]
    v_exp_f32 v99, v99
    v_exp_f32 v100, v100
    v_exp_f32 v101, v101
    s_waitcnt lgkmcnt(3)
    v_mfma_f32_32x32x16_bf16 v[112:127], v[48:51], a[144:147], v[112:127]
    s_waitcnt vmcnt(16)
    s_waitcnt vmcnt(6)
    s_add_u32 s26, s31, 0
    v_mov_b32 v20, s26
    v_mov_b32 v21, s62
    global_store_dword v20, v21, s[48:49] sc1
    v_exp_f32 v102, v102
    v_exp_f32 v103, v103
    v_cvt_pk_bf16_f32 v176, v96, v97
    v_mfma_f32_32x32x16_bf16 v[128:143], v[48:51], a[148:151], v[128:143]
    ds_read_b128 v[32:35], v12 offset:24576
    v_cvt_pk_bf16_f32 v177, v98, v99
    v_cvt_pk_bf16_f32 v178, v100, v101
    v_cvt_pk_bf16_f32 v179, v102, v103
    v_exp_f32 v72, v72
    v_mfma_f32_32x32x16_bf16 v[144:159], v[48:51], a[152:155], v[144:159]
    v_exp_f32 v73, v73
    v_exp_f32 v74, v74
    buffer_load_dwordx4 v6, s[16:19], s29 offen offset:2048 nt lds
    v_exp_f32 v75, v75
    s_waitcnt lgkmcnt(3)
    v_mfma_f32_32x32x16_bf16 v[112:127], v[52:55], a[156:159], v[112:127]
    v_exp_f32 v76, v76
    v_exp_f32 v77, v77
    v_exp_f32 v78, v78
    v_mfma_f32_32x32x16_bf16 v[128:143], v[52:55], a[160:163], v[128:143]
    ds_read_b128 v[36:39], v13 offset:24576
    v_exp_f32 v79, v79
    v_cvt_pk_bf16_f32 v164, v72, v73
    v_cvt_pk_bf16_f32 v165, v74, v75
    v_cvt_pk_bf16_f32 v166, v76, v77
    v_cvt_pk_bf16_f32 v167, v78, v79
    v_mfma_f32_32x32x16_bf16 v[144:159], v[52:55], a[164:167], v[144:159]
    v_exp_f32 v88, v88
    v_exp_f32 v89, v89
    v_exp_f32 v90, v90
    s_waitcnt lgkmcnt(3)
    v_mfma_f32_32x32x16_bf16 v[112:127], v[56:59], a[168:171], v[112:127]
    v_exp_f32 v91, v91
    buffer_load_dwordx4 v6, s[16:19], s29 offen offset:3072 nt lds
    v_exp_f32 v92, v92
    v_exp_f32 v93, v93
    v_mfma_f32_32x32x16_bf16 v[128:143], v[56:59], a[172:175], v[128:143]
    ds_read_b128 v[40:43], v14 offset:24576
    v_exp_f32 v94, v94
    v_exp_f32 v95, v95
    v_cvt_pk_bf16_f32 v172, v88, v89
    v_mfma_f32_32x32x16_bf16 v[144:159], v[56:59], a[176:179], v[144:159]
    v_cvt_pk_bf16_f32 v173, v90, v91
    v_cvt_pk_bf16_f32 v174, v92, v93
    v_cvt_pk_bf16_f32 v175, v94, v95
    v_exp_f32 v104, v104
    s_waitcnt lgkmcnt(3)
    v_mfma_f32_32x32x16_bf16 v[112:127], v[60:63], a[180:183], v[112:127]
    v_exp_f32 v105, v105
    v_exp_f32 v106, v106
    v_exp_f32 v107, v107
    v_mfma_f32_32x32x16_bf16 v[128:143], v[60:63], a[184:187], v[128:143]
    ds_read_b128 v[44:47], v15 offset:24576
    v_exp_f32 v108, v108
    s_add_u32 m0, s28, 12288
    s_add_u32 s29, s94, 135168
    buffer_load_dwordx4 v6, s[16:19], s29 offen offset:0 nt lds
    v_exp_f32 v109, v109
    v_exp_f32 v110, v110
    v_mfma_f32_32x32x16_bf16 v[144:159], v[60:63], a[188:191], v[144:159]
    v_exp_f32 v111, v111
    v_cvt_pk_bf16_f32 v180, v104, v105
    v_cvt_pk_bf16_f32 v181, v106, v107
    v_cvt_pk_bf16_f32 v182, v108, v109
    v_cvt_pk_bf16_f32 v183, v110, v111
    s_waitcnt lgkmcnt(3)
    v_mfma_f32_32x32x16_bf16 v[64:79], v[32:35], a[96:99], 0
    ds_read_b128 v[48:51], v16 offset:24576
    v_mfma_f32_32x32x16_bf16 v[80:95], v[32:35], a[100:103], 0
    ds_read_b128 v[52:55], v17 offset:24576
    v_mfma_f32_32x32x16_bf16 v[96:111], v[32:35], a[104:107], 0
    ds_read_b128 v[56:59], v18 offset:24576
    buffer_load_dwordx4 v6, s[16:19], s29 offen offset:1024 nt lds
    s_waitcnt lgkmcnt(5)
    v_mfma_f32_32x32x16_bf16 v[64:79], v[36:39], a[108:111], v[64:79]
    ds_read_b128 v[60:63], v19 offset:24576
    v_exp_f32 v112, v112
    v_exp_f32 v113, v113
    v_exp_f32 v114, v114
    v_mfma_f32_32x32x16_bf16 v[80:95], v[36:39], a[112:115], v[80:95]
    v_exp_f32 v115, v115
    v_exp_f32 v116, v116
    v_exp_f32 v117, v117
    v_mfma_f32_32x32x16_bf16 v[96:111], v[36:39], a[116:119], v[96:111]
    v_exp_f32 v118, v118
    v_exp_f32 v119, v119
    v_cvt_pk_bf16_f32 v184, v112, v113
    s_waitcnt lgkmcnt(5)
    v_mfma_f32_32x32x16_bf16 v[64:79], v[40:43], a[120:123], v[64:79]
    v_cvt_pk_bf16_f32 v185, v114, v115
    v_cvt_pk_bf16_f32 v186, v116, v117
    buffer_load_dwordx4 v6, s[16:19], s29 offen offset:2048 nt lds
    v_cvt_pk_bf16_f32 v187, v118, v119
    v_exp_f32 v128, v128
    v_mfma_f32_32x32x16_bf16 v[80:95], v[40:43], a[124:127], v[80:95]
    v_exp_f32 v129, v129
    v_exp_f32 v130, v130
    v_exp_f32 v131, v131
    v_mfma_f32_32x32x16_bf16 v[96:111], v[40:43], a[128:131], v[96:111]
    v_exp_f32 v132, v132
    v_exp_f32 v133, v133
    v_exp_f32 v134, v134
    s_waitcnt lgkmcnt(4)
    v_mfma_f32_32x32x16_bf16 v[64:79], v[44:47], a[132:135], v[64:79]
    v_exp_f32 v135, v135
    v_cvt_pk_bf16_f32 v192, v128, v129
    v_cvt_pk_bf16_f32 v193, v130, v131
    v_cvt_pk_bf16_f32 v194, v132, v133
    v_cvt_pk_bf16_f32 v195, v134, v135
    v_mfma_f32_32x32x16_bf16 v[80:95], v[44:47], a[136:139], v[80:95]
    buffer_load_dwordx4 v6, s[16:19], s29 offen offset:3072 nt lds
    v_exp_f32 v144, v144
    v_exp_f32 v145, v145
    v_exp_f32 v146, v146
    v_mfma_f32_32x32x16_bf16 v[96:111], v[44:47], a[140:143], v[96:111]
    v_exp_f32 v147, v147
    v_exp_f32 v148, v148
    v_exp_f32 v149, v149
    s_waitcnt lgkmcnt(3)
    v_mfma_f32_32x32x16_bf16 v[64:79], v[48:51], a[144:147], v[64:79]
    s_waitcnt vmcnt(9)
    v_exp_f32 v150, v150
    v_exp_f32 v151, v151
    v_cvt_pk_bf16_f32 v200, v144, v145
    v_mfma_f32_32x32x16_bf16 v[80:95], v[48:51], a[148:151], v[80:95]
    ds_read_b128 v[32:35], v12 offset:0
    v_cvt_pk_bf16_f32 v201, v146, v147
    v_cvt_pk_bf16_f32 v202, v148, v149
    v_cvt_pk_bf16_f32 v203, v150, v151
    v_exp_f32 v120, v120
    v_mfma_f32_32x32x16_bf16 v[96:111], v[48:51], a[152:155], v[96:111]
    v_exp_f32 v121, v121
    v_exp_f32 v122, v122
    v_exp_f32 v123, v123
    s_waitcnt lgkmcnt(3)
    v_mfma_f32_32x32x16_bf16 v[64:79], v[52:55], a[156:159], v[64:79]
    v_exp_f32 v124, v124
    s_add_u32 m0, s28, 16384
    s_add_u32 s29, s95, 131072
    buffer_load_dwordx4 v6, s[16:19], s29 offen offset:0 nt lds
    v_exp_f32 v125, v125
    v_exp_f32 v126, v126
    v_mfma_f32_32x32x16_bf16 v[80:95], v[52:55], a[160:163], v[80:95]
    ds_read_b128 v[36:39], v13 offset:0
    v_exp_f32 v127, v127
    v_cvt_pk_bf16_f32 v188, v120, v121
    v_cvt_pk_bf16_f32 v189, v122, v123
    v_cvt_pk_bf16_f32 v190, v124, v125
    v_cvt_pk_bf16_f32 v191, v126, v127
    v_mfma_f32_32x32x16_bf16 v[96:111], v[52:55], a[164:167], v[96:111]
    v_exp_f32 v136, v136
    v_exp_f32 v137, v137
    v_exp_f32 v138, v138
    s_waitcnt lgkmcnt(3)
    v_mfma_f32_32x32x16_bf16 v[64:79], v[56:59], a[168:171], v[64:79]
    v_exp_f32 v139, v139
    v_exp_f32 v140, v140
    v_exp_f32 v141, v141
    v_mfma_f32_32x32x16_bf16 v[80:95], v[56:59], a[172:175], v[80:95]
    ds_read_b128 v[40:43], v14 offset:0
    v_exp_f32 v142, v142
    v_exp_f32 v143, v143
    v_cvt_pk_bf16_f32 v196, v136, v137
    v_mfma_f32_32x32x16_bf16 v[96:111], v[56:59], a[176:179], v[96:111]
    v_cvt_pk_bf16_f32 v197, v138, v139
    v_cvt_pk_bf16_f32 v198, v140, v141
    v_cvt_pk_bf16_f32 v199, v142, v143
    v_exp_f32 v152, v152
    s_waitcnt lgkmcnt(3)
    v_mfma_f32_32x32x16_bf16 v[64:79], v[60:63], a[180:183], v[64:79]
    v_exp_f32 v153, v153
    buffer_load_dwordx4 v6, s[16:19], s29 offen offset:1024 nt lds
    v_exp_f32 v154, v154
    v_exp_f32 v155, v155
    v_mfma_f32_32x32x16_bf16 v[80:95], v[60:63], a[184:187], v[80:95]
    ds_read_b128 v[44:47], v15 offset:0
    v_exp_f32 v156, v156
    v_exp_f32 v157, v157
    v_exp_f32 v158, v158
    v_mfma_f32_32x32x16_bf16 v[96:111], v[60:63], a[188:191], v[96:111]
    v_exp_f32 v159, v159
    v_cvt_pk_bf16_f32 v204, v152, v153
    v_cvt_pk_bf16_f32 v205, v154, v155
    v_cvt_pk_bf16_f32 v206, v156, v157
    v_cvt_pk_bf16_f32 v207, v158, v159
    s_waitcnt lgkmcnt(3)
    v_mfma_f32_32x32x16_bf16 v[112:127], v[32:35], a[96:99], 0
    ds_read_b128 v[48:51], v16 offset:0
    v_mfma_f32_32x32x16_bf16 v[128:143], v[32:35], a[100:103], 0
    ds_read_b128 v[52:55], v17 offset:0
    v_mfma_f32_32x32x16_bf16 v[144:159], v[32:35], a[104:107], 0
    ds_read_b128 v[56:59], v18 offset:0
    buffer_load_dwordx4 v6, s[16:19], s29 offen offset:2048 nt lds
    s_waitcnt lgkmcnt(5)
    v_mfma_f32_32x32x16_bf16 v[112:127], v[36:39], a[108:111], v[112:127]
    ds_read_b128 v[60:63], v19 offset:0
    v_exp_f32 v64, v64
    v_exp_f32 v65, v65
    v_exp_f32 v66, v66
    v_mfma_f32_32x32x16_bf16 v[128:143], v[36:39], a[112:115], v[128:143]
    v_exp_f32 v67, v67
    s_and_b32 s30, s31, 0xfffffff0
    v_and_b32 v29, 0x30, v7
    v_lshrrev_b32 v29, 2, v29
    v_add_u32 v29, s30, v29
    global_load_dword v30, v29, s[48:49] sc1
    v_exp_f32 v68, v68
    v_exp_f32 v69, v69
    v_mfma_f32_32x32x16_bf16 v[144:159], v[36:39], a[116:119], v[144:159]
    v_exp_f32 v70, v70
    v_exp_f32 v71, v71
    v_cvt_pk_bf16_f32 v208, v64, v65
    s_waitcnt lgkmcnt(5)
    v_mfma_f32_32x32x16_bf16 v[112:127], v[40:43], a[120:123], v[112:127]
    v_cvt_pk_bf16_f32 v209, v66, v67
    v_cvt_pk_bf16_f32 v210, v68, v69
    buffer_load_dwordx4 v6, s[16:19], s29 offen offset:3072 nt lds
    v_cvt_pk_bf16_f32 v211, v70, v71
    v_exp_f32 v80, v80
    v_mfma_f32_32x32x16_bf16 v[128:143], v[40:43], a[124:127], v[128:143]
    v_exp_f32 v81, v81
    v_exp_f32 v82, v82
    v_exp_f32 v83, v83
    v_mfma_f32_32x32x16_bf16 v[144:159], v[40:43], a[128:131], v[144:159]
    v_exp_f32 v84, v84
    v_exp_f32 v85, v85
    v_exp_f32 v86, v86
    s_waitcnt lgkmcnt(4)
    v_mfma_f32_32x32x16_bf16 v[112:127], v[44:47], a[132:135], v[112:127]
    v_exp_f32 v87, v87
    v_cvt_pk_bf16_f32 v216, v80, v81
    v_cvt_pk_bf16_f32 v217, v82, v83
    v_cvt_pk_bf16_f32 v218, v84, v85
    v_cvt_pk_bf16_f32 v219, v86, v87
    v_mfma_f32_32x32x16_bf16 v[128:143], v[44:47], a[136:139], v[128:143]
    s_add_u32 m0, s28, 20480
    s_add_u32 s29, s95, 135168
    buffer_load_dwordx4 v6, s[16:19], s29 offen offset:0 nt lds
    v_exp_f32 v96, v96
    v_exp_f32 v97, v97
    v_exp_f32 v98, v98
    ds_write_b128 v24, v[160:163] offset:0
    v_mfma_f32_32x32x16_bf16 v[144:159], v[44:47], a[140:143], v[144:159]
    v_exp_f32 v99, v99
    v_exp_f32 v100, v100
    v_exp_f32 v101, v101
    s_waitcnt lgkmcnt(4)
    v_mfma_f32_32x32x16_bf16 v[112:127], v[48:51], a[144:147], v[112:127]
    v_exp_f32 v102, v102
    v_exp_f32 v103, v103
    v_cvt_pk_bf16_f32 v224, v96, v97
    v_mfma_f32_32x32x16_bf16 v[128:143], v[48:51], a[148:151], v[128:143]
    v_cvt_pk_bf16_f32 v225, v98, v99
    v_cvt_pk_bf16_f32 v226, v100, v101
    v_cvt_pk_bf16_f32 v227, v102, v103
    v_exp_f32 v72, v72
    v_mfma_f32_32x32x16_bf16 v[144:159], v[48:51], a[152:155], v[144:159]
    v_exp_f32 v73, v73
    v_exp_f32 v74, v74
    buffer_load_dwordx4 v6, s[16:19], s29 offen offset:1024 nt lds
    v_exp_f32 v75, v75
    s_waitcnt lgkmcnt(3)
    v_mfma_f32_32x32x16_bf16 v[112:127], v[52:55], a[156:159], v[112:127]
    v_exp_f32 v76, v76
    v_exp_f32 v77, v77
    v_exp_f32 v78, v78
    v_mfma_f32_32x32x16_bf16 v[128:143], v[52:55], a[160:163], v[128:143]
    v_exp_f32 v79, v79
    ds_write_b128 v24, v[168:171] offset:1024
    v_cvt_pk_bf16_f32 v212, v72, v73
    v_cvt_pk_bf16_f32 v213, v74, v75
    v_cvt_pk_bf16_f32 v214, v76, v77
    v_cvt_pk_bf16_f32 v215, v78, v79
    v_mfma_f32_32x32x16_bf16 v[144:159], v[52:55], a[164:167], v[144:159]
    v_exp_f32 v88, v88
    v_exp_f32 v89, v89
    v_exp_f32 v90, v90
    s_waitcnt lgkmcnt(3)
    v_mfma_f32_32x32x16_bf16 v[112:127], v[56:59], a[168:171], v[112:127]
    v_exp_f32 v91, v91
    buffer_load_dwordx4 v6, s[16:19], s29 offen offset:2048 nt lds
    v_exp_f32 v92, v92
    v_exp_f32 v93, v93
    v_mfma_f32_32x32x16_bf16 v[128:143], v[56:59], a[172:175], v[128:143]
    v_exp_f32 v94, v94
    v_exp_f32 v95, v95
    v_cvt_pk_bf16_f32 v220, v88, v89
    v_mfma_f32_32x32x16_bf16 v[144:159], v[56:59], a[176:179], v[144:159]
    v_cvt_pk_bf16_f32 v221, v90, v91
    v_cvt_pk_bf16_f32 v222, v92, v93
    v_cvt_pk_bf16_f32 v223, v94, v95
    v_exp_f32 v104, v104
    s_waitcnt lgkmcnt(2)
    v_mfma_f32_32x32x16_bf16 v[112:127], v[60:63], a[180:183], v[112:127]
    v_exp_f32 v105, v105
    v_exp_f32 v106, v106
    ds_write_b128 v24, v[176:179] offset:2048
    v_exp_f32 v107, v107
    v_mfma_f32_32x32x16_bf16 v[128:143], v[60:63], a[184:187], v[128:143]
    v_exp_f32 v108, v108
    buffer_load_dwordx4 v6, s[16:19], s29 offen offset:3072 nt lds
    v_exp_f32 v109, v109
    v_exp_f32 v110, v110
    v_mfma_f32_32x32x16_bf16 v[144:159], v[60:63], a[188:191], v[144:159]
    v_exp_f32 v111, v111
    v_cvt_pk_bf16_f32 v228, v104, v105
    v_cvt_pk_bf16_f32 v229, v106, v107
    v_cvt_pk_bf16_f32 v230, v108, v109
    v_cvt_pk_bf16_f32 v231, v110, v111
    s_lshr_b32 s50, s34, 3
    s_and_b32 s51, s3, 3
    s_lshl_b32 s60, s35, 3
    s_add_u32 s60, s60, s37
    s_lshl_b32 s42, s60, 2
    s_add_u32 s42, s42, s50
    s_mul_i32 s42, s42, 131072
    s_lshl_b32 s63, s24, 11
    s_add_u32 s42, s42, s63
    s_mul_i32 s43, s37, 43
    s_lshr_b32 s43, s43, 7
    s_mul_i32 s43, s43, 3
    s_sub_u32 s43, s37, s43
    s_mov_b32 s26, s50
    s_lshl_b32 s26, s26, 3
    s_lshl_b32 s63, s51, 1
    s_add_u32 s26, s26, s63
    s_lshl_b32 s56, s26, 17
    s_lshl_b32 s63, s24, 15
    s_add_u32 s56, s56, s63
    s_lshl_b32 s63, s50, 8
    s_add_u32 s56, s56, s63
    s_lshl_b32 s63, s60, 5
    s_add_u32 s26, s26, s63
    s_mul_i32 s52, s26, 28672
    s_mul_i32 s63, s24, 6144
    s_add_u32 s52, s52, s63
    s_add_u32 s26, s43, 0
    s_cmp_ge_u32 s26, 3
    s_cselect_b32 s63, 3, 0
    s_sub_u32 s26, s26, s63
    s_add_u32 s26, s26, 1
    s_add_u32 s26, s26, s50
    s_and_b32 s26, s26, 3
    s_lshl_b32 s26, s26, 3
    s_lshl_b32 s63, s51, 1
    s_add_u32 s26, s26, s63
    s_lshl_b32 s57, s26, 17
    s_lshl_b32 s63, s24, 15
    s_add_u32 s57, s57, s63
    s_lshl_b32 s63, s50, 8
    s_add_u32 s57, s57, s63
    s_lshl_b32 s63, s60, 5
    s_add_u32 s26, s26, s63
    s_mul_i32 s53, s26, 28672
    s_mul_i32 s63, s24, 6144
    s_add_u32 s53, s53, s63
    s_add_u32 s26, s43, 1
    s_cmp_ge_u32 s26, 3
    s_cselect_b32 s63, 3, 0
    s_sub_u32 s26, s26, s63
    s_add_u32 s26, s26, 1
    s_add_u32 s26, s26, s50
    s_and_b32 s26, s26, 3
    s_lshl_b32 s26, s26, 3
    s_lshl_b32 s63, s51, 1
    s_add_u32 s26, s26, s63
    s_lshl_b32 s58, s26, 17
    s_lshl_b32 s63, s24, 15
    s_add_u32 s58, s58, s63
    s_lshl_b32 s63, s50, 8
    s_add_u32 s58, s58, s63
    s_lshl_b32 s63, s60, 5
    s_add_u32 s26, s26, s63
    s_mul_i32 s54, s26, 28672
    s_mul_i32 s63, s24, 6144
    s_add_u32 s54, s54, s63
    s_add_u32 s26, s43, 2
    s_cmp_ge_u32 s26, 3
    s_cselect_b32 s63, 3, 0
    s_sub_u32 s26, s26, s63
    s_add_u32 s26, s26, 1
    s_add_u32 s26, s26, s50
    s_and_b32 s26, s26, 3
    s_lshl_b32 s26, s26, 3
    s_lshl_b32 s63, s51, 1
    s_add_u32 s26, s26, s63
    s_lshl_b32 s59, s26, 17
    s_lshl_b32 s63, s24, 15
    s_add_u32 s59, s59, s63
    s_lshl_b32 s63, s50, 8
    s_add_u32 s59, s59, s63
    s_lshl_b32 s63, s60, 5
    s_add_u32 s26, s26, s63
    s_mul_i32 s55, s26, 28672
    s_mul_i32 s63, s24, 6144
    s_add_u32 s55, s55, s63
    s_mul_i32 s27, s37, 96
    s_lshl_b32 s63, s51, 3
    s_add_u32 s27, s27, s63
    s_lshl_b32 s27, s27, 11
    s_lshl_b32 s63, s35, 10
    s_add_u32 s27, s27, s63
    s_lshl_b32 s63, s50, 8
    s_add_u32 s27, s27, s63
    s_and_b32 s63, s24, 1
    s_lshl_b32 s63, s63, 7
    s_add_u32 s27, s27, s63
    s_lshr_b32 s63, s24, 1
    s_lshl_b32 s63, s63, 6
    s_add_u32 s27, s27, s63
    s_mov_b32 s8, s44
    s_mov_b32 s9, s45
    s_mov_b32 s10, 1572864
    s_mov_b32 s36, s51
    v_mbcnt_lo_u32_b32 v48, -1, 0
    v_mbcnt_hi_u32_b32 v48, -1, v48
    v_lshrrev_b32 v49, 4, v48
    v_and_b32 v50, 15, v48
    v_lshrrev_b32 v51, 5, v48
    v_and_b32 v52, 31, v48
    v_lshlrev_b32 v53, 2, v49
    v_xor_b32 v53, v50, v53
    v_lshlrev_b32 v53, 4, v53
    v_lshl_add_u32 v2, v49, 10, v53
    v_add_u32 v3, 3072, v2
    v_add_u32 v4, 6144, v2
    v_add_u32 v5, 9216, v2
    v_lshlrev_b32 v53, 1, v52
    v_lshl_add_u32 v12, v51, 13, v53
    v_add_u32 v1, s28, v7
    v_add_u32 v31, 0x10000, v7
    s_lshl_b32 s26, s24, 11
    v_add_u32 v19, s26, v7
    s_xor_b32 s50, s24, 1
    s_mul_i32 s26, s50, 3072
    v_add_u32 v17, s26, v25
    s_lshl_b32 s26, s50, 15
    v_add_u32 v18, s26, v7
    s_xor_b32 s26, s28, 0x10000
    v_add_u32 v31, s26, v7
    s_and_b32 s26, s24, 1
    s_lshl_b32 s26, s26, 1
    s_lshr_b32 s50, s24, 1
    s_xor_b32 s50, s50, 0
    s_add_u32 s26, s26, s50
    s_xor_b32 s26, s26, s24
    s_lshl_b32 s26, s26, 6
    v_xor_b32 v53, s26, v22
    s_xor_b32 s26, s28, 0
    v_add_u32 v13, s26, v53
    s_and_b32 s26, s24, 1
    s_lshl_b32 s26, s26, 1
    s_lshr_b32 s50, s24, 1
    s_xor_b32 s50, s50, 1
    s_add_u32 s26, s26, s50
    s_xor_b32 s26, s26, s24
    s_lshl_b32 s26, s26, 6
    v_xor_b32 v53, s26, v22
    s_xor_b32 s26, s28, 0
    v_add_u32 v14, s26, v53
    s_and_b32 s26, s24, 1
    s_lshl_b32 s26, s26, 1
    s_lshr_b32 s50, s24, 1
    s_xor_b32 s50, s50, 0
    s_add_u32 s26, s26, s50
    s_xor_b32 s26, s26, s24
    s_lshl_b32 s26, s26, 6
    v_xor_b32 v53, s26, v22
    s_xor_b32 s26, s28, 32768
    v_add_u32 v15, s26, v53
    s_and_b32 s26, s24, 1
    s_lshl_b32 s26, s26, 1
    s_lshr_b32 s50, s24, 1
    s_xor_b32 s50, s50, 1
    s_add_u32 s26, s26, s50
    s_xor_b32 s26, s26, s24
    s_lshl_b32 s26, s26, 6
    v_xor_b32 v53, s26, v22
    s_xor_b32 s26, s28, 32768
    v_add_u32 v16, s26, v53
    s_waitcnt vmcnt(13) lgkmcnt(0)
    s_barrier
    ds_read_b64_tr_b16 v[32:33], v22 offset:8192
    ds_read_b64_tr_b16 v[34:35], v22 offset:10240
    ds_read_b128 v[36:39], v25 offset:0
    ds_read_b128 v[40:43], v25 offset:1024
    ds_read_b128 v[44:47], v25 offset:2048
    ds_read_b64_tr_b16 v[48:49], v22 offset:40960
    ds_read_b64_tr_b16 v[50:51], v22 offset:43008
    ds_read_b128 v[52:55], v25 offset:3072
    ds_read_b128 v[56:59], v25 offset:4096
    ds_read_b128 v[60:63], v25 offset:5120
    v_mfma_f32_32x32x16_bf16 v[64:79], v[8:11], v[160:163], 0
    v_exp_f32 v112, v112
    v_mfma_f32_32x32x16_bf16 v[80:95], v[8:11], v[168:171], 0
    ds_write_b128 v24, v[164:167] offset:12288
    v_exp_f32 v113, v113
    s_add_u32 m0, s28, 24576
    s_add_u32 s29, s96, 131072
    buffer_load_dwordx4 v6, s[16:19], s29 offen offset:0 nt lds
    v_mfma_f32_32x32x16_bf16 v[96:111], v[8:11], v[176:179], 0
    v_exp_f32 v114, v114
    v_exp_f32 v115, v115
    v_mfma_f32_32x32x16_bf16 v[64:79], v[8:11], v[164:167], v[64:79]
    ds_write_b128 v24, v[172:175] offset:13312
    v_exp_f32 v116, v116
    v_mfma_f32_32x32x16_bf16 v[80:95], v[8:11], v[172:175], v[80:95]
    v_exp_f32 v117, v117
    buffer_load_dwordx4 v6, s[16:19], s29 offen offset:1024 nt lds
    v_mfma_f32_32x32x16_bf16 v[96:111], v[8:11], v[180:183], v[96:111]
    v_exp_f32 v118, v118
    ds_write_b128 v24, v[180:183] offset:14336
    v_exp_f32 v119, v119
    s_waitcnt lgkmcnt(10)
    v_mfma_f32_32x32x16_bf16 a[192:207], v[32:35], v[36:39], 0
    ds_read_b64_tr_b16 a[240:241], v23 offset:8192
    ds_read_b64_tr_b16 a[242:243], v23 offset:10240
    ds_read_b128 a[244:247], v25 offset:6144
    v_cvt_pk_bf16_f32 v232, v112, v113
    v_cvt_pk_bf16_f32 v233, v114, v115
    s_waitcnt lgkmcnt(12)
    v_mfma_f32_32x32x16_bf16 a[208:223], v[32:35], v[40:43], 0
    v_cvt_pk_bf16_f32 v234, v116, v117
    ds_read_b128 a[248:251], v25 offset:7168
    v_cvt_pk_bf16_f32 v235, v118, v119
    buffer_load_dwordx4 v6, s[16:19], s29 offen offset:2048 nt lds
    v_exp_f32 v128, v128
    s_waitcnt lgkmcnt(12)
    v_mfma_f32_32x32x16_bf16 a[224:239], v[32:35], v[44:47], 0
    ds_read_b128 a[252:255], v25 offset:8192
    v_exp_f32 v129, v129
    s_waitcnt lgkmcnt(10)
    v_mfma_f32_32x32x16_bf16 a[192:207], v[48:51], v[52:55], a[192:207]
    ds_read_b64_tr_b16 v[32:33], v23 offset:40960
    ds_read_b64_tr_b16 v[34:35], v23 offset:43008
    ds_read_b128 v[36:39], v25 offset:9216
    v_exp_f32 v130, v130
    s_waitcnt lgkmcnt(12)
    v_mfma_f32_32x32x16_bf16 a[208:223], v[48:51], v[56:59], a[208:223]
    v_exp_f32 v131, v131
    ds_read_b128 v[40:43], v25 offset:10240
    buffer_load_dwordx4 v6, s[16:19], s29 offen offset:3072 nt lds
    v_exp_f32 v132, v132
    s_waitcnt lgkmcnt(12)
    v_mfma_f32_32x32x16_bf16 a[224:239], v[48:51], v[60:63], a[224:239]
    ds_read_b128 v[44:47], v25 offset:11264
    v_exp_f32 v133, v133
    s_waitcnt vmcnt(13) lgkmcnt(0)
    s_barrier
    ds_read_b64_tr_b16 v[48:49], v22 offset:12288
    ds_read_b64_tr_b16 v[50:51], v22 offset:14336
    ds_read_b128 v[52:55], v25 offset:12288
    v_mfma_f32_32x32x16_bf16 a[192:207], a[240:243], a[244:247], a[192:207]
    ds_read_b128 v[56:59], v25 offset:13312
    v_mfma_f32_32x32x16_bf16 a[208:223], a[240:243], a[248:251], a[208:223]
    v_exp_f32 v134, v134
    ds_read_b128 v[60:63], v25 offset:14336
    ds_write_b128 v24, v[184:187] offset:0
    v_mfma_f32_32x32x16_bf16 a[224:239], a[240:243], a[252:255], a[224:239]
    v_exp_f32 v135, v135
    s_add_u32 m0, s28, 28672
    s_add_u32 s29, s96, 135168
    buffer_load_dwordx4 v6, s[16:19], s29 offen offset:0 nt lds
    v_mfma_f32_32x32x16_bf16 a[192:207], v[32:35], v[36:39], a[192:207]
    ds_read_b64_tr_b16 a[240:241], v22 offset:45056
    ds_read_b64_tr_b16 a[242:243], v22 offset:47104
    v_cvt_pk_bf16_f32 v240, v128, v129
    ds_read_b128 a[244:247], v25 offset:15360
    ds_write_b128 v24, v[192:195] offset:1024
    v_cvt_pk_bf16_f32 v241, v130, v131
    v_mfma_f32_32x32x16_bf16 a[208:223], v[32:35], v[40:43], a[208:223]
    ds_read_b128 a[248:251], v25 offset:16384
    v_cvt_pk_bf16_f32 v242, v132, v133
    v_mfma_f32_32x32x16_bf16 a[224:239], v[32:35], v[44:47], a[224:239]
    ds_read_b128 a[252:255], v25 offset:17408
    v_cvt_pk_bf16_f32 v243, v134, v135
    ds_write_b128 v24, v[200:203] offset:2048
    s_waitcnt lgkmcnt(10)
    v_mfma_f32_32x32x16_bf16 a[192:207], v[48:51], v[52:55], a[192:207]
    v_exp_f32 v144, v144
    ds_read_b64_tr_b16 v[32:33], v23 offset:12288
    ds_read_b64_tr_b16 v[34:35], v23 offset:14336
    ds_read_b128 v[36:39], v25 offset:18432
    buffer_load_dwordx4 v6, s[16:19], s29 offen offset:1024 nt lds
    s_waitcnt lgkmcnt(12)
    v_mfma_f32_32x32x16_bf16 a[208:223], v[48:51], v[56:59], a[208:223]
    ds_read_b128 v[40:43], v25 offset:19456
    v_exp_f32 v145, v145
    s_waitcnt lgkmcnt(12)
    v_mfma_f32_32x32x16_bf16 a[224:239], v[48:51], v[60:63], a[224:239]
    ds_read_b128 v[44:47], v25 offset:20480
    v_exp_f32 v146, v146
    v_mfma_f32_32x32x16_bf16 v[64:79], v[8:11], v[184:187], v[64:79]
    v_exp_f32 v147, v147
    v_mfma_f32_32x32x16_bf16 v[80:95], v[8:11], v[192:195], v[80:95]
    v_mfma_f32_32x32x16_bf16 v[96:111], v[8:11], v[200:203], v[96:111]
    v_exp_f32 v148, v148
    buffer_load_dwordx4 v6, s[16:19], s29 offen offset:2048 nt lds
    v_mfma_f32_32x32x16_bf16 v[64:79], v[8:11], v[188:191], v[64:79]
    v_exp_f32 v149, v149
    v_mfma_f32_32x32x16_bf16 v[80:95], v[8:11], v[196:199], v[80:95]
    v_exp_f32 v150, v150
    v_mfma_f32_32x32x16_bf16 v[96:111], v[8:11], v[204:207], v[96:111]
    v_exp_f32 v151, v151
    s_waitcnt lgkmcnt(9)
    v_mfma_f32_32x32x16_bf16 a[192:207], a[240:243], a[244:247], a[192:207]
    ds_read_b64_tr_b16 v[48:49], v23 offset:45056
    ds_read_b64_tr_b16 v[50:51], v23 offset:47104
    ds_read_b128 v[52:55], v25 offset:21504
    buffer_load_dwordx4 v6, s[16:19], s29 offen offset:3072 nt lds
    v_cvt_pk_bf16_f32 v248, v144, v145
    s_waitcnt lgkmcnt(10)
    v_mfma_f32_32x32x16_bf16 a[208:223], a[240:243], a[248:251], a[208:223]
    ds_read_b128 v[56:59], v25 offset:22528
    v_cvt_pk_bf16_f32 v249, v146, v147
    v_cvt_pk_bf16_f32 v250, v148, v149
    s_waitcnt lgkmcnt(10)
    v_mfma_f32_32x32x16_bf16 a[224:239], a[240:243], a[252:255], a[224:239]
    ds_read_b128 v[60:63], v25 offset:23552
    v_cvt_pk_bf16_f32 v251, v150, v151
    s_waitcnt vmcnt(12) lgkmcnt(0)
    s_barrier
    ds_read_b64_tr_b16 a[240:241], v22 offset:16384
    ds_read_b64_tr_b16 a[242:243], v22 offset:18432
    ds_read_b128 a[244:247], v25 offset:0
    v_mfma_f32_32x32x16_bf16 a[192:207], v[32:35], v[36:39], a[192:207]
    ds_read_b128 a[248:251], v25 offset:1024
    v_exp_f32 v120, v120
    v_mfma_f32_32x32x16_bf16 a[208:223], v[32:35], v[40:43], a[208:223]
    ds_read_b128 a[252:255], v25 offset:2048
    ds_write_b128 v24, v[188:191] offset:12288
    v_exp_f32 v121, v121
    v_mfma_f32_32x32x16_bf16 a[224:239], v[32:35], v[44:47], a[224:239]
    s_add_u32 m0, s28, 0
    s_add_u32 s29, s97, 131072
    buffer_load_dwordx4 v6, s[16:19], s29 offen offset:0 nt lds
    v_exp_f32 v122, v122
    v_mfma_f32_32x32x16_bf16 a[192:207], v[48:51], v[52:55], a[192:207]
    ds_read_b64_tr_b16 v[32:33], v22 offset:49152
    ds_read_b64_tr_b16 v[34:35], v22 offset:51200
    ds_read_b128 v[36:39], v25 offset:3072
    ds_write_b128 v24, v[196:199] offset:13312
    v_exp_f32 v123, v123
    v_mfma_f32_32x32x16_bf16 a[208:223], v[48:51], v[56:59], a[208:223]
    ds_read_b128 v[40:43], v25 offset:4096
    v_exp_f32 v124, v124
    v_mfma_f32_32x32x16_bf16 a[224:239], v[48:51], v[60:63], a[224:239]
    ds_read_b128 v[44:47], v25 offset:5120
    v_exp_f32 v125, v125
    ds_write_b128 v24, v[204:207] offset:14336
    buffer_load_dwordx4 v6, s[16:19], s29 offen offset:1024 nt lds
    s_waitcnt lgkmcnt(10)
    v_mfma_f32_32x32x16_bf16 a[192:207], a[240:243], a[244:247], a[192:207]
    ds_read_b64_tr_b16 v[48:49], v23 offset:16384
    ds_read_b64_tr_b16 v[50:51], v23 offset:18432
    ds_read_b128 v[52:55], v25 offset:6144
    v_exp_f32 v126, v126
    s_waitcnt lgkmcnt(12)
    v_mfma_f32_32x32x16_bf16 a[208:223], a[240:243], a[248:251], a[208:223]
    ds_read_b128 v[56:59], v25 offset:7168
    v_exp_f32 v127, v127
    v_cvt_pk_bf16_f32 v236, v120, v121
    s_waitcnt lgkmcnt(12)
    v_mfma_f32_32x32x16_bf16 a[224:239], a[240:243], a[252:255], a[224:239]
    ds_read_b128 v[60:63], v25 offset:8192
    v_cvt_pk_bf16_f32 v237, v122, v123
    v_cvt_pk_bf16_f32 v238, v124, v125
    v_mfma_f32_32x32x16_bf16 v[64:79], v[8:11], v[208:211], v[64:79]
    v_cvt_pk_bf16_f32 v239, v126, v127
    buffer_load_dwordx4 v6, s[16:19], s29 offen offset:2048 nt lds
    v_exp_f32 v136, v136
    v_mfma_f32_32x32x16_bf16 v[80:95], v[8:11], v[216:219], v[80:95]
    v_exp_f32 v137, v137
    v_mfma_f32_32x32x16_bf16 v[96:111], v[8:11], v[224:227], v[96:111]
    v_exp_f32 v138, v138
    s_waitcnt lgkmcnt(9)
    v_mfma_f32_32x32x16_bf16 a[192:207], v[32:35], v[36:39], a[192:207]
    ds_read_b64_tr_b16 a[240:241], v23 offset:49152
    ds_read_b64_tr_b16 a[242:243], v23 offset:51200
    ds_read_b128 a[244:247], v25 offset:9216
    v_exp_f32 v139, v139
    s_waitcnt lgkmcnt(10)
    v_mfma_f32_32x32x16_bf16 a[208:223], v[32:35], v[40:43], a[208:223]
    buffer_load_dwordx4 v6, s[16:19], s29 offen offset:3072 nt lds
    ds_read_b128 a[248:251], v25 offset:10240
    v_exp_f32 v140, v140
    s_waitcnt lgkmcnt(10)
    v_mfma_f32_32x32x16_bf16 a[224:239], v[32:35], v[44:47], a[224:239]
    ds_read_b128 a[252:255], v25 offset:11264
    v_exp_f32 v141, v141
    s_waitcnt vmcnt(12) lgkmcnt(0)
    s_barrier
    ds_read_b64_tr_b16 v[32:33], v22 offset:20480
    ds_read_b64_tr_b16 v[34:35], v22 offset:22528
    ds_read_b128 v[36:39], v25 offset:12288
    v_mfma_f32_32x32x16_bf16 a[192:207], v[48:51], v[52:55], a[192:207]
    ds_read_b128 v[40:43], v25 offset:13312
    v_exp_f32 v142, v142
    v_mfma_f32_32x32x16_bf16 a[208:223], v[48:51], v[56:59], a[208:223]
    ds_read_b128 v[44:47], v25 offset:14336
    ds_write_b128 v24, v[208:211] offset:0
    v_exp_f32 v143, v143
    v_mfma_f32_32x32x16_bf16 a[224:239], v[48:51], v[60:63], a[224:239]
    s_add_u32 m0, s28, 4096
    s_add_u32 s29, s97, 135168
    buffer_load_dwordx4 v6, s[16:19], s29 offen offset:0 nt lds
    v_cvt_pk_bf16_f32 v244, v136, v137
    v_mfma_f32_32x32x16_bf16 a[192:207], a[240:243], a[244:247], a[192:207]
    ds_read_b64_tr_b16 v[48:49], v22 offset:53248
    ds_read_b64_tr_b16 v[50:51], v22 offset:55296
    v_cvt_pk_bf16_f32 v245, v138, v139
    ds_read_b128 v[52:55], v25 offset:15360
    ds_write_b128 v24, v[216:219] offset:1024
    v_cvt_pk_bf16_f32 v246, v140, v141
    v_mfma_f32_32x32x16_bf16 a[208:223], a[240:243], a[248:251], a[208:223]
    ds_read_b128 v[56:59], v25 offset:16384
    v_cvt_pk_bf16_f32 v247, v142, v143
    v_mfma_f32_32x32x16_bf16 a[224:239], a[240:243], a[252:255], a[224:239]
    v_exp_f32 v152, v152
    ds_read_b128 v[60:63], v25 offset:17408
    ds_write_b128 v24, v[224:227] offset:2048
    buffer_load_dwordx4 v6, s[16:19], s29 offen offset:1024 nt lds
    s_waitcnt lgkmcnt(10)
    v_mfma_f32_32x32x16_bf16 a[192:207], v[32:35], v[36:39], a[192:207]
    ds_read_b64_tr_b16 a[240:241], v23 offset:20480
    v_exp_f32 v153, v153
    ds_read_b64_tr_b16 a[242:243], v23 offset:22528
    ds_read_b128 a[244:247], v25 offset:18432
    s_waitcnt lgkmcnt(12)
    v_mfma_f32_32x32x16_bf16 a[208:223], v[32:35], v[40:43], a[208:223]
    ds_read_b128 a[248:251], v25 offset:19456
    v_exp_f32 v154, v154
    s_waitcnt lgkmcnt(12)
    v_mfma_f32_32x32x16_bf16 a[224:239], v[32:35], v[44:47], a[224:239]
    ds_read_b128 a[252:255], v25 offset:20480
    v_exp_f32 v155, v155
    v_mfma_f32_32x32x16_bf16 v[64:79], v[8:11], v[212:215], v[64:79]
    v_exp_f32 v156, v156
    buffer_load_dwordx4 v6, s[16:19], s29 offen offset:2048 nt lds
    v_mfma_f32_32x32x16_bf16 v[80:95], v[8:11], v[220:223], v[80:95]
    v_exp_f32 v157, v157
    v_mfma_f32_32x32x16_bf16 v[96:111], v[8:11], v[228:231], v[96:111]
    v_exp_f32 v158, v158
    s_waitcnt lgkmcnt(9)
    v_mfma_f32_32x32x16_bf16 a[192:207], v[48:51], v[52:55], a[192:207]
    ds_read_b64_tr_b16 v[32:33], v23 offset:53248
    ds_read_b64_tr_b16 v[34:35], v23 offset:55296
    v_exp_f32 v159, v159
    ds_read_b128 v[36:39], v25 offset:21504
    s_waitcnt lgkmcnt(10)
    v_mfma_f32_32x32x16_bf16 a[208:223], v[48:51], v[56:59], a[208:223]
    v_cvt_pk_bf16_f32 v252, v152, v153
    buffer_load_dwordx4 v6, s[16:19], s29 offen offset:3072 nt lds
    ds_read_b128 v[40:43], v25 offset:22528
    v_cvt_pk_bf16_f32 v253, v154, v155
    s_waitcnt lgkmcnt(10)
    v_mfma_f32_32x32x16_bf16 a[224:239], v[48:51], v[60:63], a[224:239]
    v_cvt_pk_bf16_f32 v254, v156, v157
    ds_read_b128 v[44:47], v25 offset:23552
    v_cvt_pk_bf16_f32 v255, v158, v159
    s_waitcnt vmcnt(12) lgkmcnt(0)
    s_barrier
    ds_read_b64_tr_b16 v[48:49], v22 offset:24576
    ds_read_b64_tr_b16 v[50:51], v22 offset:26624
    ds_read_b128 v[52:55], v25 offset:0
    v_mfma_f32_32x32x16_bf16 a[192:207], a[240:243], a[244:247], a[192:207]
    ds_read_b128 v[56:59], v25 offset:1024
    v_mfma_f32_32x32x16_bf16 a[208:223], a[240:243], a[248:251], a[208:223]
    ds_read_b128 v[60:63], v25 offset:2048
    ds_write_b128 v24, v[212:215] offset:12288
    v_mfma_f32_32x32x16_bf16 a[224:239], a[240:243], a[252:255], a[224:239]
    s_add_u32 m0, s28, 8192
    s_add_u32 s43, s56, 0
    buffer_load_dwordx4 v2, s[4:7], s43 offen offset:0 lds
    v_mfma_f32_32x32x16_bf16 a[192:207], v[32:35], v[36:39], a[192:207]
    ds_read_b64_tr_b16 a[240:241], v22 offset:57344
    ds_read_b64_tr_b16 a[242:243], v22 offset:59392
    ds_read_b128 a[244:247], v25 offset:3072
    ds_write_b128 v24, v[220:223] offset:13312
    v_mfma_f32_32x32x16_bf16 a[208:223], v[32:35], v[40:43], a[208:223]
    ds_read_b128 a[248:251], v25 offset:4096
    v_mfma_f32_32x32x16_bf16 a[224:239], v[32:35], v[44:47], a[224:239]
    ds_read_b128 a[252:255], v25 offset:5120
    ds_write_b128 v24, v[228:231] offset:14336
    buffer_load_dwordx4 v3, s[4:7], s43 offen offset:1024 lds
    s_waitcnt lgkmcnt(10)
    v_mfma_f32_32x32x16_bf16 a[192:207], v[48:51], v[52:55], a[192:207]
    ds_read_b64_tr_b16 v[32:33], v23 offset:24576
    ds_read_b64_tr_b16 v[34:35], v23 offset:26624
    ds_read_b128 v[36:39], v25 offset:6144
    s_waitcnt lgkmcnt(12)
    v_mfma_f32_32x32x16_bf16 a[208:223], v[48:51], v[56:59], a[208:223]
    ds_read_b128 v[40:43], v25 offset:7168
    s_waitcnt lgkmcnt(12)
    v_mfma_f32_32x32x16_bf16 a[224:239], v[48:51], v[60:63], a[224:239]
    ds_read_b128 v[44:47], v25 offset:8192
    v_mfma_f32_32x32x16_bf16 v[64:79], v[8:11], v[232:235], v[64:79]
    buffer_load_dwordx4 v4, s[4:7], s43 offen offset:2048 lds
    v_mfma_f32_32x32x16_bf16 v[80:95], v[8:11], v[240:243], v[80:95]
    v_mfma_f32_32x32x16_bf16 v[96:111], v[8:11], v[248:251], v[96:111]
    s_waitcnt lgkmcnt(9)
    v_mfma_f32_32x32x16_bf16 a[192:207], a[240:243], a[244:247], a[192:207]
    ds_read_b64_tr_b16 v[48:49], v23 offset:57344
    ds_read_b64_tr_b16 v[50:51], v23 offset:59392
    ds_read_b128 v[52:55], v25 offset:9216
    s_waitcnt lgkmcnt(10)
    v_mfma_f32_32x32x16_bf16 a[208:223], a[240:243], a[248:251], a[208:223]
    buffer_load_dwordx4 v5, s[4:7], s43 offen offset:3072 lds
    ds_read_b128 v[56:59], v25 offset:10240
    s_waitcnt lgkmcnt(10)
    v_mfma_f32_32x32x16_bf16 a[224:239], a[240:243], a[252:255], a[224:239]
    ds_read_b128 v[60:63], v25 offset:11264
    s_waitcnt vmcnt(12) lgkmcnt(0)
    s_barrier
    ds_read_b64_tr_b16 a[240:241], v22 offset:28672
    ds_read_b64_tr_b16 a[242:243], v22 offset:30720
    ds_read_b128 a[244:247], v25 offset:12288
    v_mfma_f32_32x32x16_bf16 a[192:207], v[32:35], v[36:39], a[192:207]
    ds_read_b128 a[248:251], v25 offset:13312
    v_mfma_f32_32x32x16_bf16 a[208:223], v[32:35], v[40:43], a[208:223]
    ds_read_b128 a[252:255], v25 offset:14336
    ds_write_b128 v24, v[232:235] offset:0
    v_mfma_f32_32x32x16_bf16 a[224:239], v[32:35], v[44:47], a[224:239]
    s_add_u32 m0, s28, 12288
    s_add_u32 s43, s56, 16384
    buffer_load_dwordx4 v2, s[4:7], s43 offen offset:0 lds
    v_mfma_f32_32x32x16_bf16 a[192:207], v[48:51], v[52:55], a[192:207]
    ds_read_b64_tr_b16 v[32:33], v22 offset:61440
    ds_read_b64_tr_b16 v[34:35], v22 offset:63488
    ds_read_b128 v[36:39], v25 offset:15360
    ds_write_b128 v24, v[240:243] offset:1024
    v_mfma_f32_32x32x16_bf16 a[208:223], v[48:51], v[56:59], a[208:223]
    ds_read_b128 v[40:43], v25 offset:16384
    v_mfma_f32_32x32x16_bf16 a[224:239], v[48:51], v[60:63], a[224:239]
    ds_read_b128 v[44:47], v25 offset:17408
    ds_write_b128 v24, v[248:251] offset:2048
    buffer_load_dwordx4 v3, s[4:7], s43 offen offset:1024 lds
    s_waitcnt lgkmcnt(10)
    v_mfma_f32_32x32x16_bf16 a[192:207], a[240:243], a[244:247], a[192:207]
    ds_read_b64_tr_b16 v[48:49], v23 offset:28672
    ds_read_b64_tr_b16 v[50:51], v23 offset:30720
    ds_read_b128 v[52:55], v25 offset:18432
    s_waitcnt lgkmcnt(12)
    v_mfma_f32_32x32x16_bf16 a[208:223], a[240:243], a[248:251], a[208:223]
    ds_read_b128 v[56:59], v25 offset:19456
    s_waitcnt lgkmcnt(12)
    v_mfma_f32_32x32x16_bf16 a[224:239], a[240:243], a[252:255], a[224:239]
    ds_read_b128 v[60:63], v25 offset:20480
    v_mfma_f32_32x32x16_bf16 v[64:79], v[8:11], v[236:239], v[64:79]
    buffer_load_dwordx4 v4, s[4:7], s43 offen offset:2048 lds
    v_mfma_f32_32x32x16_bf16 v[80:95], v[8:11], v[244:247], v[80:95]
    v_mfma_f32_32x32x16_bf16 v[96:111], v[8:11], v[252:255], v[96:111]
    s_waitcnt lgkmcnt(9)
    v_mfma_f32_32x32x16_bf16 a[192:207], v[32:35], v[36:39], a[192:207]
    ds_read_b64_tr_b16 a[240:241], v23 offset:61440
    ds_read_b64_tr_b16 a[242:243], v23 offset:63488
    ds_read_b128 a[244:247], v25 offset:21504
    s_waitcnt lgkmcnt(10)
    v_mfma_f32_32x32x16_bf16 a[208:223], v[32:35], v[40:43], a[208:223]
    buffer_load_dwordx4 v5, s[4:7], s43 offen offset:3072 lds
    ds_read_b128 a[248:251], v25 offset:22528
    s_waitcnt lgkmcnt(10)
    v_mfma_f32_32x32x16_bf16 a[224:239], v[32:35], v[44:47], a[224:239]
    ds_read_b128 a[252:255], v25 offset:23552
    s_waitcnt vmcnt(12) lgkmcnt(0)
    s_barrier
    v_cmp_ne_u32 vcc, s62, v30
    s_mov_b32 s63, 0
    s_cbranch_vccz L_pok_13
L_poll_12:
    global_load_dword v30, v29, s[48:49] sc1
    s_add_u32 s63, s63, 1
    s_waitcnt vmcnt(0)
    v_cmp_ne_u32 vcc, s62, v30
    s_cmp_ge_u32 s63, 65536
    s_cbranch_scc1 L_pok_13
    s_cbranch_vccnz L_poll_12
L_pok_13:
    ds_read_b64_tr_b16 v[32:33], v22 offset:0
    ds_read_b64_tr_b16 v[34:35], v22 offset:2048
    ds_read_b128 v[36:39], v25 offset:0
    v_mfma_f32_32x32x16_bf16 a[192:207], v[48:51], v[52:55], a[192:207]
    ds_read_b128 v[40:43], v25 offset:1024
    v_mfma_f32_32x32x16_bf16 a[208:223], v[48:51], v[56:59], a[208:223]
    ds_read_b128 v[44:47], v25 offset:2048
    ds_write_b128 v24, v[236:239] offset:12288
    s_add_u32 m0, s28, 16384
    s_add_u32 s43, s57, 0
    buffer_load_dwordx4 v2, s[4:7], s43 offen offset:0 lds
    v_mfma_f32_32x32x16_bf16 a[224:239], v[48:51], v[60:63], a[224:239]
    s_add_u32 s30, s53, 0
    buffer_load_dwordx4 a[24:27], v7, s[20:23], s30 offen offset:0 sc1
    v_mfma_f32_32x32x16_bf16 a[192:207], a[240:243], a[244:247], a[192:207]
    ds_read_b64_tr_b16 v[48:49], v22 offset:32768
    ds_read_b64_tr_b16 v[50:51], v22 offset:34816
    ds_read_b128 v[52:55], v25 offset:3072
    ds_write_b128 v24, v[244:247] offset:13312
    v_mfma_f32_32x32x16_bf16 a[208:223], a[240:243], a[248:251], a[208:223]
    ds_read_b128 v[56:59], v25 offset:4096
    buffer_load_dwordx4 v3, s[4:7], s43 offen offset:1024 lds
    v_mfma_f32_32x32x16_bf16 a[224:239], a[240:243], a[252:255], a[224:239]
    ds_read_b128 v[60:63], v25 offset:5120
    ds_write_b128 v24, v[252:255] offset:14336
    s_waitcnt lgkmcnt(10)
    v_mfma_f32_32x32x16_bf16 a[192:207], v[32:35], v[36:39], a[192:207]
    ds_read_b64_tr_b16 a[240:241], v23 offset:0
    buffer_load_dwordx4 a[28:31], v7, s[20:23], s30 offen offset:1024 sc1
    ds_read_b64_tr_b16 a[242:243], v23 offset:2048
    ds_read_b128 a[244:247], v25 offset:6144
    s_waitcnt lgkmcnt(12)
    v_mfma_f32_32x32x16_bf16 a[208:223], v[32:35], v[40:43], a[208:223]
    ds_read_b128 a[248:251], v25 offset:7168
    buffer_load_dwordx4 v4, s[4:7], s43 offen offset:2048 lds
    ds_write_b32 v26, v64 offset:1536
    ds_write_b32 v26, v80 offset:2048
    ds_write_b32 v26, v96 offset:2560
    s_waitcnt lgkmcnt(15)
    v_mfma_f32_32x32x16_bf16 a[224:239], v[32:35], v[44:47], a[224:239]
    ds_read_b128 a[252:255], v25 offset:8192
    s_waitcnt lgkmcnt(12)
    v_mfma_f32_32x32x16_bf16 a[192:207], v[48:51], v[52:55], a[192:207]
    ds_read_b64_tr_b16 v[32:33], v23 offset:32768
    ds_read_b64_tr_b16 v[34:35], v23 offset:34816
    ds_read_b128 v[36:39], v25 offset:9216
    buffer_load_dwordx4 a[32:35], v7, s[20:23], s30 offen offset:2048 sc1
    s_waitcnt lgkmcnt(13)
    v_mfma_f32_32x32x16_bf16 a[208:223], v[48:51], v[56:59], a[208:223]
    ds_read_b128 v[40:43], v25 offset:10240
    buffer_load_dwordx4 v5, s[4:7], s43 offen offset:3072 lds
    s_waitcnt lgkmcnt(13)
    v_mfma_f32_32x32x16_bf16 a[224:239], v[48:51], v[60:63], a[224:239]
    ds_read_b128 v[44:47], v25 offset:11264
    s_waitcnt vmcnt(15) lgkmcnt(0)
    s_barrier
    ds_read_b64_tr_b16 v[48:49], v22 offset:4096
    ds_read_b64_tr_b16 v[50:51], v22 offset:6144
    ds_read_b128 v[52:55], v25 offset:12288
    v_mfma_f32_32x32x16_bf16 a[192:207], a[240:243], a[244:247], a[192:207]
    ds_read_b128 v[56:59], v25 offset:13312
    v_mfma_f32_32x32x16_bf16 a[208:223], a[240:243], a[248:251], a[208:223]
    ds_read_b128 v[60:63], v25 offset:14336
    v_mfma_f32_32x32x16_bf16 a[224:239], a[240:243], a[252:255], a[224:239]
    s_add_u32 m0, s28, 20480
    s_add_u32 s43, s57, 16384
    buffer_load_dwordx4 v2, s[4:7], s43 offen offset:0 lds
    buffer_load_dwordx4 a[36:39], v7, s[20:23], s30 offen offset:3072 sc1
    v_mfma_f32_32x32x16_bf16 a[192:207], v[32:35], v[36:39], a[192:207]
    ds_read_b64_tr_b16 a[240:241], v22 offset:36864
    ds_read_b64_tr_b16 a[242:243], v22 offset:38912
    ds_read_b128 v[112:115], v27 offset:1536
    ds_read_b128 v[116:119], v27 offset:2048
    ds_read_b128 v[120:123], v27 offset:2560
    ds_read_b128 a[244:247], v25 offset:15360
    v_mfma_f32_32x32x16_bf16 a[208:223], v[32:35], v[40:43], a[208:223]
    ds_read_b128 a[248:251], v25 offset:16384
    v_mfma_f32_32x32x16_bf16 a[224:239], v[32:35], v[44:47], a[224:239]
    ds_read_b128 a[252:255], v25 offset:17408
    s_waitcnt lgkmcnt(10)
    v_mfma_f32_32x32x16_bf16 a[192:207], v[48:51], v[52:55], a[192:207]
    ds_read_b64_tr_b16 v[32:33], v23 offset:4096
    ds_read_b64_tr_b16 v[34:35], v23 offset:6144
    ds_read_b128 v[36:39], v25 offset:18432
    buffer_load_dwordx4 v3, s[4:7], s43 offen offset:1024 lds
    s_add_u32 s30, s53, 4096
    buffer_load_dwordx4 a[40:43], v7, s[20:23], s30 offen offset:0 sc1
    s_waitcnt lgkmcnt(12)
    v_mfma_f32_32x32x16_bf16 a[208:223], v[48:51], v[56:59], a[208:223]
    ds_read_b128 v[40:43], v25 offset:19456
    s_waitcnt lgkmcnt(12)
    v_mfma_f32_32x32x16_bf16 a[224:239], v[48:51], v[60:63], a[224:239]
    ds_read_b128 v[44:47], v25 offset:20480
    s_waitcnt lgkmcnt(7)
    v_mfma_f32_32x32x16_bf16 a[192:207], a[240:243], a[244:247], a[192:207]
    ds_read_b64_tr_b16 v[48:49], v23 offset:36864
    ds_read_b64_tr_b16 v[50:51], v23 offset:38912
    s_mov_b32 s50, 0x30800000
    s_mov_b32 s51, 0x4e800000
    v_add_f32 v112, v112, v113
    v_add_f32 v114, v114, v115
    v_add_f32 v112, v112, v114
    v_add_f32 v116, v116, v117
    v_add_f32 v118, v118, v119
    v_add_f32 v116, v116, v118
    v_add_f32 v120, v120, v121
    v_add_f32 v122, v122, v123
    v_add_f32 v120, v120, v122
    v_min3_f32 v113, v112, v116, v120
    v_max3_f32 v114, v112, v116, v120
    v_cmp_u_f32 vcc, v112, v116
    v_cmp_u_f32 s[0:1], v120, v120
    s_or_b64 s[0:1], vcc, s[0:1]
    v_cmp_nle_f32 vcc, s50, v113
    s_or_b64 s[0:1], vcc, s[0:1]
    v_cmp_nge_f32 vcc, s51, v114
    s_or_b64 s[0:1], vcc, s[0:1]
    v_rcp_f32 v124, v112
    v_rcp_f32 v125, v112
    v_rcp_f32 v126, v116
    v_rcp_f32 v127, v116
    v_rcp_f32 v128, v120
    v_rcp_f32 v129, v120
    ds_read_b128 v[52:55], v25 offset:21504
    s_waitcnt lgkmcnt(9)
    v_mfma_f32_32x32x16_bf16 a[208:223], a[240:243], a[248:251], a[208:223]
    ds_read_b128 v[56:59], v25 offset:22528
    s_waitcnt lgkmcnt(9)
    v_mfma_f32_32x32x16_bf16 a[224:239], a[240:243], a[252:255], a[224:239]
    ds_read_b128 v[60:63], v25 offset:23552
    buffer_load_dwordx4 v4, s[4:7], s43 offen offset:2048 lds
    buffer_load_dwordx4 a[44:47], v7, s[20:23], s30 offen offset:1024 sc1
    s_waitcnt lgkmcnt(7)
    v_mfma_f32_32x32x16_bf16 a[192:207], v[32:35], v[36:39], a[192:207]
    s_waitcnt lgkmcnt(6)
    v_mfma_f32_32x32x16_bf16 a[208:223], v[32:35], v[40:43], a[208:223]
    s_waitcnt lgkmcnt(5)
    v_mfma_f32_32x32x16_bf16 a[224:239], v[32:35], v[44:47], a[224:239]
    s_waitcnt lgkmcnt(2)
    v_mfma_f32_32x32x16_bf16 a[192:207], v[48:51], v[52:55], a[192:207]
    buffer_load_dwordx4 v5, s[4:7], s43 offen offset:3072 lds
    s_and_b32 s50, s37, 1
    s_lshl_b32 s51, s50, 17
    s_lshl_b32 s50, s50, 14
    s_sub_u32 s26, s32, s51
    s_add_u32 s26, s26, s50
    s_add_u32 s26, s26, 131072
    v_and_b32 v20, 0xf00, v28
    v_and_b32 v21, 0x80, v28
    v_lshl_add_u32 v20, v20, 2, v21
    buffer_load_dword v0, v20, s[4:7], s26 offen
    s_waitcnt lgkmcnt(1)
    v_mfma_f32_32x32x16_bf16 a[208:223], v[48:51], v[56:59], a[208:223]
    s_waitcnt lgkmcnt(0)
    v_mfma_f32_32x32x16_bf16 a[224:239], v[48:51], v[60:63], a[224:239]
    s_barrier
    s_mov_b64 vcc, s[0:1]
    s_and_b64 vcc, vcc, s[38:39]
    s_cbranch_vccnz L_slow1
L_epi1:
    s_mov_b64 s[38:39], -1
    s_add_u32 m0, s28, 24576
    s_add_u32 s43, s58, 0
    buffer_load_dwordx4 v2, s[4:7], s43 offen offset:0 lds
    buffer_load_dwordx4 v3, s[4:7], s43 offen offset:1024 lds
    v_accvgpr_read_b32 v160, a192
    v_accvgpr_read_b32 v161, a193
    v_accvgpr_read_b32 v162, a194
    v_accvgpr_read_b32 v163, a195
    v_accvgpr_read_b32 v164, a196
    v_accvgpr_read_b32 v165, a197
    v_accvgpr_read_b32 v166, a198
    v_accvgpr_read_b32 v167, a199
    v_accvgpr_read_b32 v168, a200
    v_accvgpr_read_b32 v169, a201
    v_accvgpr_read_b32 v170, a202
    v_accvgpr_read_b32 v171, a203
    v_accvgpr_read_b32 v172, a204
    v_accvgpr_read_b32 v173, a205
    v_accvgpr_read_b32 v174, a206
    v_accvgpr_read_b32 v175, a207
    v_pk_mul_f32 v[160:161], v[160:161], v[124:125]
    v_pk_mul_f32 v[162:163], v[162:163], v[124:125]
    v_pk_mul_f32 v[164:165], v[164:165], v[124:125]
    v_pk_mul_f32 v[166:167], v[166:167], v[124:125]
    v_pk_mul_f32 v[168:169], v[168:169], v[124:125]
    v_pk_mul_f32 v[170:171], v[170:171], v[124:125]
    v_pk_mul_f32 v[172:173], v[172:173], v[124:125]
    v_pk_mul_f32 v[174:175], v[174:175], v[124:125]
    v_cvt_pk_bf16_f32 v176, v160, v161
    v_cvt_pk_bf16_f32 v177, v162, v163
    v_cvt_pk_bf16_f32 v178, v164, v165
    v_cvt_pk_bf16_f32 v232, v166, v167
    v_cvt_pk_bf16_f32 v180, v168, v169
    v_cvt_pk_bf16_f32 v181, v170, v171
    v_cvt_pk_bf16_f32 v182, v172, v173
    v_cvt_pk_bf16_f32 v236, v174, v175
    v_mov_b32 v179, s62
    v_mov_b32 v183, s62
    v_mov_b32 v235, s62
    v_mov_b32 v239, s62
    ds_write_b128 v24, a[0:3] offset:0
    ds_write_b128 v24, a[4:7] offset:1024
    ds_write_b128 v24, a[8:11] offset:2048
    ds_write_b128 v24, a[12:15] offset:12288
    ds_write_b128 v24, a[16:19] offset:13312
    ds_write_b128 v24, a[20:23] offset:14336
    buffer_load_dwordx4 v4, s[4:7], s43 offen offset:2048 lds
    buffer_load_dwordx4 v5, s[4:7], s43 offen offset:3072 lds
    s_add_u32 m0, s28, 28672
    s_add_u32 s43, s58, 16384
    buffer_load_dwordx4 v2, s[4:7], s43 offen offset:0 lds
    v_accvgpr_read_b32 v184, a208
    v_accvgpr_read_b32 v185, a209
    v_accvgpr_read_b32 v186, a210
    v_accvgpr_read_b32 v187, a211
    v_accvgpr_read_b32 v188, a212
    v_accvgpr_read_b32 v189, a213
    v_accvgpr_read_b32 v190, a214
    v_accvgpr_read_b32 v191, a215
    v_accvgpr_read_b32 v192, a216
    v_accvgpr_read_b32 v193, a217
    v_accvgpr_read_b32 v194, a218
    v_accvgpr_read_b32 v195, a219
    v_accvgpr_read_b32 v196, a220
    v_accvgpr_read_b32 v197, a221
    v_accvgpr_read_b32 v198, a222
    v_accvgpr_read_b32 v199, a223
    v_pk_mul_f32 v[184:185], v[184:185], v[126:127]
    v_pk_mul_f32 v[186:187], v[186:187], v[126:127]
    v_pk_mul_f32 v[188:189], v[188:189], v[126:127]
    v_pk_mul_f32 v[190:191], v[190:191], v[126:127]
    v_pk_mul_f32 v[192:193], v[192:193], v[126:127]
    v_pk_mul_f32 v[194:195], v[194:195], v[126:127]
    v_pk_mul_f32 v[196:197], v[196:197], v[126:127]
    v_pk_mul_f32 v[198:199], v[198:199], v[126:127]
    v_cvt_pk_bf16_f32 v200, v184, v185
    v_cvt_pk_bf16_f32 v201, v186, v187
    v_cvt_pk_bf16_f32 v202, v188, v189
    v_cvt_pk_bf16_f32 v233, v190, v191
    v_cvt_pk_bf16_f32 v204, v192, v193
    v_cvt_pk_bf16_f32 v205, v194, v195
    v_cvt_pk_bf16_f32 v206, v196, v197
    v_cvt_pk_bf16_f32 v237, v198, v199
    v_mov_b32 v203, s62
    v_mov_b32 v207, s62
    buffer_load_dwordx4 v3, s[4:7], s43 offen offset:1024 lds
    buffer_load_dwordx4 v4, s[4:7], s43 offen offset:2048 lds
    buffer_load_dwordx4 v5, s[4:7], s43 offen offset:3072 lds
    v_accvgpr_read_b32 v208, a224
    v_accvgpr_read_b32 v209, a225
    v_accvgpr_read_b32 v210, a226
    v_accvgpr_read_b32 v211, a227
    v_accvgpr_read_b32 v212, a228
    v_accvgpr_read_b32 v213, a229
    v_accvgpr_read_b32 v214, a230
    v_accvgpr_read_b32 v215, a231
    v_accvgpr_read_b32 v216, a232
    v_accvgpr_read_b32 v217, a233
    v_accvgpr_read_b32 v218, a234
    v_accvgpr_read_b32 v219, a235
    v_accvgpr_read_b32 v220, a236
    v_accvgpr_read_b32 v221, a237
    v_accvgpr_read_b32 v222, a238
    v_accvgpr_read_b32 v223, a239
    v_pk_mul_f32 v[208:209], v[208:209], v[128:129]
    v_pk_mul_f32 v[210:211], v[210:211], v[128:129]
    v_pk_mul_f32 v[212:213], v[212:213], v[128:129]
    v_pk_mul_f32 v[214:215], v[214:215], v[128:129]
    v_pk_mul_f32 v[216:217], v[216:217], v[128:129]
    v_pk_mul_f32 v[218:219], v[218:219], v[128:129]
    v_pk_mul_f32 v[220:221], v[220:221], v[128:129]
    v_pk_mul_f32 v[222:223], v[222:223], v[128:129]
    v_cvt_pk_bf16_f32 v224, v208, v209
    v_cvt_pk_bf16_f32 v225, v210, v211
    v_cvt_pk_bf16_f32 v226, v212, v213
    v_cvt_pk_bf16_f32 v234, v214, v215
    v_cvt_pk_bf16_f32 v228, v216, v217
    v_cvt_pk_bf16_f32 v229, v218, v219
    v_cvt_pk_bf16_f32 v230, v220, v221
    v_cvt_pk_bf16_f32 v238, v222, v223
    v_mov_b32 v227, s62
    v_mov_b32 v231, s62
    s_lshl_b32 s26, s24, 11
    s_add_u32 s26, s26, s33
    s_add_u32 s26, s26, 24576
    s_add_u32 s50, s26, 4096
    buffer_store_dwordx4 v[176:179], v7, s[20:23], s26 offen offset:0 sc1
    buffer_store_dwordx4 v[200:203], v7, s[20:23], s26 offen offset:1024 sc1
    buffer_store_dwordx4 v[224:227], v7, s[20:23], s26 offen offset:2048 sc1
    buffer_store_dwordx4 v[180:183], v7, s[20:23], s26 offen offset:3072 sc1
    buffer_store_dwordx4 v[204:207], v7, s[20:23], s50 offen offset:0 sc1
    buffer_store_dwordx4 v[228:231], v7, s[20:23], s50 offen offset:1024 sc1
    buffer_store_dwordx4 v[232:235], v7, s[20:23], s50 offen offset:2048 sc1
    buffer_store_dwordx4 v[236:239], v7, s[20:23], s50 offen offset:3072 sc1
    s_nop 1
    v_mov_b32 v179, v232
    v_mov_b32 v203, v233
    v_mov_b32 v227, v234
    v_mov_b32 v183, v236
    v_mov_b32 v207, v237
    v_mov_b32 v231, v238
    s_waitcnt vmcnt(31) lgkmcnt(0)
    s_barrier
    ds_read_b64_tr_b16 a[144:145], v13 offset:8192
    ds_read_b64_tr_b16 a[146:147], v13 offset:10240
    ds_read_b64_tr_b16 a[148:149], v14 offset:8192
    ds_read_b64_tr_b16 a[150:151], v14 offset:10240
    ds_read_b64_tr_b16 a[152:153], v13 offset:12288
    ds_read_b64_tr_b16 a[154:155], v13 offset:14336
    s_waitcnt lgkmcnt(4)
    v_mfma_f32_32x32x16_bf16 v[64:79], a[0:3], a[144:147], 0
    ds_read_b64_tr_b16 a[156:157], v14 offset:12288
    v_mfma_f32_32x32x16_bf16 v[80:95], a[4:7], a[144:147], 0
    ds_read_b64_tr_b16 a[158:159], v14 offset:14336
    s_add_u32 s30, s54, 0
    buffer_load_dwordx4 a[48:51], v7, s[20:23], s30 offen offset:0 sc1
    v_mfma_f32_32x32x16_bf16 v[96:111], a[8:11], a[144:147], 0
    ds_read_b128 a[96:99], v17 offset:0
    buffer_load_dwordx4 a[52:55], v7, s[20:23], s30 offen offset:1024 sc1
    s_waitcnt lgkmcnt(5)
    v_mfma_f32_32x32x16_bf16 v[184:199], a[0:3], a[148:151], 0
    ds_read_b64_tr_b16 a[144:145], v15 offset:8192
    ds_read_b128 a[100:103], v17 offset:1024
    buffer_load_dwordx4 a[56:59], v7, s[20:23], s30 offen offset:2048 sc1
    v_mfma_f32_32x32x16_bf16 v[208:223], a[4:7], a[148:151], 0
    ds_read_b64_tr_b16 a[146:147], v15 offset:10240
    ds_read_b128 a[104:107], v17 offset:2048
    buffer_load_dwordx4 a[60:63], v7, s[20:23], s30 offen offset:3072 sc1
    v_mfma_f32_32x32x16_bf16 v[240:255], a[8:11], a[148:151], 0
    ds_read_b128 a[108:111], v17 offset:12288
    s_add_u32 s30, s54, 4096
    buffer_load_dwordx4 a[64:67], v7, s[20:23], s30 offen offset:0 sc1
    s_waitcnt lgkmcnt(8)
    v_mfma_f32_32x32x16_bf16 v[64:79], a[12:15], a[152:155], v[64:79]
    ds_read_b64_tr_b16 a[148:149], v16 offset:8192
    ds_read_b128 a[112:115], v17 offset:13312
    v_mfma_f32_32x32x16_bf16 v[80:95], a[16:19], a[152:155], v[80:95]
    ds_read_b64_tr_b16 a[150:151], v16 offset:10240
    buffer_load_dwordx4 a[68:71], v7, s[20:23], s30 offen offset:1024 sc1
    ds_read_b128 a[116:119], v17 offset:14336
    v_mfma_f32_32x32x16_bf16 v[96:111], a[20:23], a[152:155], v[96:111]
    s_add_u32 s30, s55, 0
    buffer_load_dwordx4 a[72:75], v7, s[20:23], s30 offen offset:0 sc1
    s_waitcnt vmcnt(25)
    ds_write_b128 v1, a[24:27] offset:0
    s_waitcnt lgkmcnt(11)
    v_mfma_f32_32x32x16_bf16 v[184:199], a[12:15], a[156:159], v[184:199]
    ds_read_b64_tr_b16 a[152:153], v15 offset:12288
    ds_write_b128 v1, a[28:31] offset:1024
    buffer_load_dwordx4 a[76:79], v7, s[20:23], s30 offen offset:1024 sc1
    v_mfma_f32_32x32x16_bf16 v[208:223], a[16:19], a[156:159], v[208:223]
    ds_read_b64_tr_b16 a[154:155], v15 offset:14336
    ds_write_b128 v1, a[32:35] offset:2048
    buffer_load_dwordx4 a[80:83], v7, s[20:23], s30 offen offset:2048 sc1
    v_mfma_f32_32x32x16_bf16 v[240:255], a[20:23], a[156:159], v[240:255]
    ds_write_b128 v1, a[36:39] offset:3072
    buffer_load_dwordx4 a[84:87], v7, s[20:23], s30 offen offset:3072 sc1
    s_waitcnt lgkmcnt(12)
    v_mfma_f32_32x32x16_bf16 v[64:79], a[96:99], a[144:147], v[64:79]
    ds_read_b64_tr_b16 a[156:157], v16 offset:12288
    ds_write_b128 v1, a[40:43] offset:4096
    v_mfma_f32_32x32x16_bf16 v[80:95], a[100:103], a[144:147], v[80:95]
    ds_read_b64_tr_b16 a[158:159], v16 offset:14336
    ds_write_b128 v1, a[44:47] offset:5120
    s_add_u32 s30, s55, 4096
    buffer_load_dwordx4 a[88:91], v7, s[20:23], s30 offen offset:0 sc1
    s_waitcnt lgkmcnt(15)
    v_mfma_f32_32x32x16_bf16 v[96:111], a[104:107], a[144:147], v[96:111]
    buffer_load_dwordx4 a[92:95], v7, s[20:23], s30 offen offset:1024 sc1
    s_waitcnt vmcnt(29) lgkmcnt(0)
    s_barrier
    ds_read_b64_tr_b16 a[144:145], v13 offset:16384
    v_mfma_f32_32x32x16_bf16 v[184:199], a[96:99], a[148:151], v[184:199]
    ds_read_b64_tr_b16 a[146:147], v13 offset:18432
    v_mfma_f32_32x32x16_bf16 v[208:223], a[100:103], a[148:151], v[208:223]
    s_add_u32 m0, s28, 8192
    s_add_u32 s43, s59, 0
    buffer_load_dwordx4 v2, s[4:7], s43 offen offset:0 lds
    v_mfma_f32_32x32x16_bf16 v[240:255], a[104:107], a[148:151], v[240:255]
    ds_read_b128 a[120:123], v18 offset:0
    v_mfma_f32_32x32x16_bf16 v[64:79], a[108:111], a[152:155], v[64:79]
    ds_read_b64_tr_b16 a[148:149], v14 offset:16384
    ds_read_b128 a[124:127], v18 offset:1024
    v_mfma_f32_32x32x16_bf16 v[80:95], a[112:115], a[152:155], v[80:95]
    ds_read_b64_tr_b16 a[150:151], v14 offset:18432
    ds_read_b128 a[128:131], v18 offset:2048
    buffer_load_dwordx4 v3, s[4:7], s43 offen offset:1024 lds
    v_mfma_f32_32x32x16_bf16 v[96:111], a[116:119], a[152:155], v[96:111]
    ds_read_b128 a[132:135], v18 offset:3072
    v_mfma_f32_32x32x16_bf16 v[184:199], a[108:111], a[156:159], v[184:199]
    ds_read_b64_tr_b16 a[152:153], v13 offset:20480
    ds_read_b128 a[136:139], v18 offset:4096
    v_mfma_f32_32x32x16_bf16 v[208:223], a[112:115], a[156:159], v[208:223]
    ds_read_b64_tr_b16 a[154:155], v13 offset:22528
    ds_read_b128 a[140:143], v18 offset:5120
    buffer_load_dwordx4 v4, s[4:7], s43 offen offset:2048 lds
    v_mfma_f32_32x32x16_bf16 v[240:255], a[116:119], a[156:159], v[240:255]
    s_waitcnt vmcnt(9)
    ds_write_b128 v24, a[48:51] offset:0
    s_waitcnt lgkmcnt(11)
    v_mfma_f32_32x32x16_bf16 v[64:79], a[24:27], a[144:147], v[64:79]
    ds_read_b64_tr_b16 a[156:157], v14 offset:20480
    v_mfma_f32_32x32x16_bf16 v[80:95], a[28:31], a[144:147], v[80:95]
    ds_read_b64_tr_b16 a[158:159], v14 offset:22528
    ds_write_b128 v24, a[52:55] offset:1024
    buffer_load_dwordx4 v5, s[4:7], s43 offen offset:3072 lds
    v_mfma_f32_32x32x16_bf16 v[96:111], a[32:35], a[144:147], v[96:111]
    s_waitcnt lgkmcnt(10)
    v_mfma_f32_32x32x16_bf16 v[184:199], a[24:27], a[148:151], v[184:199]
    ds_read_b64_tr_b16 a[144:145], v15 offset:16384
    ds_write_b128 v24, a[56:59] offset:2048
    v_mfma_f32_32x32x16_bf16 v[208:223], a[28:31], a[148:151], v[208:223]
    ds_read_b64_tr_b16 a[146:147], v15 offset:18432
    s_add_u32 m0, s28, 12288
    s_add_u32 s43, s59, 16384
    buffer_load_dwordx4 v2, s[4:7], s43 offen offset:0 lds
    v_mfma_f32_32x32x16_bf16 v[240:255], a[32:35], a[148:151], v[240:255]
    ds_write_b128 v24, a[60:63] offset:12288
    s_waitcnt lgkmcnt(9)
    v_mfma_f32_32x32x16_bf16 v[64:79], a[36:39], a[152:155], v[64:79]
    ds_read_b64_tr_b16 a[148:149], v16 offset:16384
    v_mfma_f32_32x32x16_bf16 v[80:95], a[40:43], a[152:155], v[80:95]
    ds_read_b64_tr_b16 a[150:151], v16 offset:18432
    ds_write_b128 v24, a[64:67] offset:13312
    buffer_load_dwordx4 v3, s[4:7], s43 offen offset:1024 lds
    v_mfma_f32_32x32x16_bf16 v[96:111], a[44:47], a[152:155], v[96:111]
    s_waitcnt lgkmcnt(8)
    v_mfma_f32_32x32x16_bf16 v[184:199], a[36:39], a[156:159], v[184:199]
    ds_read_b64_tr_b16 a[152:153], v15 offset:20480
    ds_write_b128 v24, a[68:71] offset:14336
    v_mfma_f32_32x32x16_bf16 v[208:223], a[40:43], a[156:159], v[208:223]
    ds_read_b64_tr_b16 a[154:155], v15 offset:22528
    buffer_load_dwordx4 v4, s[4:7], s43 offen offset:2048 lds
    v_mfma_f32_32x32x16_bf16 v[240:255], a[44:47], a[156:159], v[240:255]
    s_waitcnt lgkmcnt(7)
    v_mfma_f32_32x32x16_bf16 v[64:79], a[120:123], a[144:147], v[64:79]
    ds_read_b64_tr_b16 a[156:157], v16 offset:20480
    v_mfma_f32_32x32x16_bf16 v[80:95], a[124:127], a[144:147], v[80:95]
    ds_read_b64_tr_b16 a[158:159], v16 offset:22528
    buffer_load_dwordx4 v5, s[4:7], s43 offen offset:3072 lds
    v_mfma_f32_32x32x16_bf16 v[96:111], a[128:131], a[144:147], v[96:111]
    s_waitcnt lgkmcnt(0)
    s_barrier
    ds_read_b64_tr_b16 a[144:145], v13 offset:24576
    v_mfma_f32_32x32x16_bf16 v[184:199], a[120:123], a[148:151], v[184:199]
    ds_read_b64_tr_b16 a[146:147], v13 offset:26624
    v_mfma_f32_32x32x16_bf16 v[208:223], a[124:127], a[148:151], v[208:223]
    s_add_u32 m0, s28, 16384
    s_add_u32 s43, s56, 131072
    buffer_load_dwordx4 v2, s[4:7], s43 offen offset:0 lds
    v_mfma_f32_32x32x16_bf16 v[240:255], a[128:131], a[148:151], v[240:255]
    ds_read_b128 a[96:99], v17 offset:0
    v_mfma_f32_32x32x16_bf16 v[64:79], a[132:135], a[152:155], v[64:79]
    ds_read_b64_tr_b16 a[148:149], v14 offset:24576
    ds_read_b128 a[100:103], v17 offset:1024
    v_mfma_f32_32x32x16_bf16 v[80:95], a[136:139], a[152:155], v[80:95]
    ds_read_b64_tr_b16 a[150:151], v14 offset:26624
    ds_read_b128 a[104:107], v17 offset:2048
    buffer_load_dwordx4 v3, s[4:7], s43 offen offset:1024 lds
    v_mfma_f32_32x32x16_bf16 v[96:111], a[140:143], a[152:155], v[96:111]
    ds_read_b128 a[108:111], v17 offset:12288
    v_mfma_f32_32x32x16_bf16 v[184:199], a[132:135], a[156:159], v[184:199]
    ds_read_b64_tr_b16 a[152:153], v13 offset:28672
    ds_read_b128 a[112:115], v17 offset:13312
    v_mfma_f32_32x32x16_bf16 v[208:223], a[136:139], a[156:159], v[208:223]
    ds_read_b64_tr_b16 a[154:155], v13 offset:30720
    ds_read_b128 a[116:119], v17 offset:14336
    buffer_load_dwordx4 v4, s[4:7], s43 offen offset:2048 lds
    v_mfma_f32_32x32x16_bf16 v[240:255], a[140:143], a[156:159], v[240:255]
    s_waitcnt vmcnt(11)
    ds_write_b128 v1, a[72:75] offset:0
    s_waitcnt lgkmcnt(11)
    v_mfma_f32_32x32x16_bf16 v[64:79], a[48:51], a[144:147], v[64:79]
    ds_read_b64_tr_b16 a[156:157], v14 offset:28672
    v_mfma_f32_32x32x16_bf16 v[80:95], a[52:55], a[144:147], v[80:95]
    ds_read_b64_tr_b16 a[158:159], v14 offset:30720
    ds_write_b128 v1, a[76:79] offset:1024
    buffer_load_dwordx4 v5, s[4:7], s43 offen offset:3072 lds
    v_mfma_f32_32x32x16_bf16 v[96:111], a[56:59], a[144:147], v[96:111]
    s_waitcnt lgkmcnt(10)
    v_mfma_f32_32x32x16_bf16 v[184:199], a[48:51], a[148:151], v[184:199]
    ds_read_b64_tr_b16 a[144:145], v15 offset:24576
    ds_write_b128 v1, a[80:83] offset:2048
    v_mfma_f32_32x32x16_bf16 v[208:223], a[52:55], a[148:151], v[208:223]
    ds_read_b64_tr_b16 a[146:147], v15 offset:26624
    s_add_u32 m0, s28, 20480
    s_add_u32 s43, s56, 147456
    buffer_load_dwordx4 v2, s[4:7], s43 offen offset:0 lds
    v_mfma_f32_32x32x16_bf16 v[240:255], a[56:59], a[148:151], v[240:255]
    ds_write_b128 v1, a[84:87] offset:3072
    s_waitcnt lgkmcnt(9)
    v_mfma_f32_32x32x16_bf16 v[64:79], a[60:63], a[152:155], v[64:79]
    ds_read_b64_tr_b16 a[148:149], v16 offset:24576
    v_mfma_f32_32x32x16_bf16 v[80:95], a[64:67], a[152:155], v[80:95]
    ds_read_b64_tr_b16 a[150:151], v16 offset:26624
    ds_write_b128 v1, a[88:91] offset:4096
    buffer_load_dwordx4 v3, s[4:7], s43 offen offset:1024 lds
    v_mfma_f32_32x32x16_bf16 v[96:111], a[68:71], a[152:155], v[96:111]
    s_waitcnt lgkmcnt(8)
    v_mfma_f32_32x32x16_bf16 v[184:199], a[60:63], a[156:159], v[184:199]
    ds_read_b64_tr_b16 a[152:153], v15 offset:28672
    ds_write_b128 v1, a[92:95] offset:5120
    v_mfma_f32_32x32x16_bf16 v[208:223], a[64:67], a[156:159], v[208:223]
    ds_read_b64_tr_b16 a[154:155], v15 offset:30720
    buffer_load_dwordx4 v4, s[4:7], s43 offen offset:2048 lds
    v_mfma_f32_32x32x16_bf16 v[240:255], a[68:71], a[156:159], v[240:255]
    s_waitcnt lgkmcnt(7)
    v_mfma_f32_32x32x16_bf16 v[64:79], a[96:99], a[144:147], v[64:79]
    ds_read_b64_tr_b16 a[156:157], v16 offset:28672
    v_mfma_f32_32x32x16_bf16 v[80:95], a[100:103], a[144:147], v[80:95]
    ds_read_b64_tr_b16 a[158:159], v16 offset:30720
    buffer_load_dwordx4 v5, s[4:7], s43 offen offset:3072 lds
    v_mfma_f32_32x32x16_bf16 v[96:111], a[104:107], a[144:147], v[96:111]
    s_waitcnt vmcnt(8) lgkmcnt(0)
    s_barrier
    ds_read_b64_tr_b16 a[144:145], v13 offset:8192
    v_mfma_f32_32x32x16_bf16 v[184:199], a[96:99], a[148:151], v[184:199]
    ds_read_b64_tr_b16 a[146:147], v13 offset:10240
    v_mfma_f32_32x32x16_bf16 v[208:223], a[100:103], a[148:151], v[208:223]
    s_add_u32 m0, s28, 24576
    s_add_u32 s43, s57, 131072
    buffer_load_dwordx4 v2, s[4:7], s43 offen offset:0 lds
    v_mfma_f32_32x32x16_bf16 v[240:255], a[104:107], a[148:151], v[240:255]
    ds_read_b128 a[120:123], v18 offset:0
    buffer_load_dwordx4 v3, s[4:7], s43 offen offset:1024 lds
    v_mfma_f32_32x32x16_bf16 v[64:79], a[108:111], a[152:155], v[64:79]
    ds_read_b64_tr_b16 a[148:149], v14 offset:8192
    ds_read_b128 a[124:127], v18 offset:1024
    v_mfma_f32_32x32x16_bf16 v[80:95], a[112:115], a[152:155], v[80:95]
    ds_read_b64_tr_b16 a[150:151], v14 offset:10240
    buffer_load_dwordx4 v4, s[4:7], s43 offen offset:2048 lds
    ds_read_b128 a[128:131], v18 offset:2048
    v_mfma_f32_32x32x16_bf16 v[96:111], a[116:119], a[152:155], v[96:111]
    ds_read_b128 a[132:135], v18 offset:3072
    buffer_load_dwordx4 v5, s[4:7], s43 offen offset:3072 lds
    v_mfma_f32_32x32x16_bf16 v[184:199], a[108:111], a[156:159], v[184:199]
    ds_read_b64_tr_b16 a[152:153], v13 offset:12288
    ds_read_b128 a[136:139], v18 offset:4096
    v_mfma_f32_32x32x16_bf16 v[208:223], a[112:115], a[156:159], v[208:223]
    s_add_u32 m0, s28, 28672
    s_add_u32 s43, s57, 147456
    buffer_load_dwordx4 v2, s[4:7], s43 offen offset:0 lds
    ds_read_b64_tr_b16 a[154:155], v13 offset:14336
    ds_read_b128 a[140:143], v18 offset:5120
    v_mfma_f32_32x32x16_bf16 v[240:255], a[116:119], a[156:159], v[240:255]
    buffer_load_dwordx4 v3, s[4:7], s43 offen offset:1024 lds
    ds_write_b128 v24, v[176:179] offset:0
    s_waitcnt lgkmcnt(11)
    v_mfma_f32_32x32x16_bf16 v[64:79], a[72:75], a[144:147], v[64:79]
    ds_read_b64_tr_b16 a[156:157], v14 offset:12288
    buffer_load_dwordx4 v4, s[4:7], s43 offen offset:2048 lds
    v_mfma_f32_32x32x16_bf16 v[80:95], a[76:79], a[144:147], v[80:95]
    ds_read_b64_tr_b16 a[158:159], v14 offset:14336
    ds_write_b128 v24, v[200:203] offset:1024
    v_mfma_f32_32x32x16_bf16 v[96:111], a[80:83], a[144:147], v[96:111]
    buffer_load_dwordx4 v5, s[4:7], s43 offen offset:3072 lds
    s_waitcnt lgkmcnt(10)
    v_mfma_f32_32x32x16_bf16 v[184:199], a[72:75], a[148:151], v[184:199]
    ds_read_b64_tr_b16 a[144:145], v15 offset:8192
    ds_write_b128 v24, v[224:227] offset:2048
    s_add_u32 s30, s53, 24576
    buffer_load_dwordx4 v[32:35], v19, s[20:23], s30 offen offset:0 sc1
    v_mfma_f32_32x32x16_bf16 v[208:223], a[76:79], a[148:151], v[208:223]
    ds_read_b64_tr_b16 a[146:147], v15 offset:10240
    v_mfma_f32_32x32x16_bf16 v[240:255], a[80:83], a[148:151], v[240:255]
    buffer_load_dwordx4 v[36:39], v19, s[20:23], s30 offen offset:1024 sc1
    ds_write_b128 v24, v[180:183] offset:12288
    s_waitcnt lgkmcnt(9)
    v_mfma_f32_32x32x16_bf16 v[64:79], a[84:87], a[152:155], v[64:79]
    ds_read_b64_tr_b16 a[148:149], v16 offset:8192
    buffer_load_dwordx4 v[40:43], v19, s[20:23], s30 offen offset:2048 sc1
    v_mfma_f32_32x32x16_bf16 v[80:95], a[88:91], a[152:155], v[80:95]
    ds_read_b64_tr_b16 a[150:151], v16 offset:10240
    ds_write_b128 v24, v[204:207] offset:13312
    v_mfma_f32_32x32x16_bf16 v[96:111], a[92:95], a[152:155], v[96:111]
    buffer_load_dwordx4 v[44:47], v19, s[20:23], s30 offen offset:3072 sc1
    s_waitcnt lgkmcnt(8)
    v_mfma_f32_32x32x16_bf16 v[184:199], a[84:87], a[156:159], v[184:199]
    ds_read_b64_tr_b16 a[152:153], v15 offset:12288
    ds_write_b128 v24, v[228:231] offset:14336
    s_add_u32 s30, s53, 28672
    buffer_load_dwordx4 v[48:51], v19, s[20:23], s30 offen offset:0 sc1
    v_mfma_f32_32x32x16_bf16 v[208:223], a[88:91], a[156:159], v[208:223]
    ds_read_b64_tr_b16 a[154:155], v15 offset:14336
    v_mfma_f32_32x32x16_bf16 v[240:255], a[92:95], a[156:159], v[240:255]
    buffer_load_dwordx4 v[52:55], v19, s[20:23], s30 offen offset:1024 sc1
    s_waitcnt lgkmcnt(7)
    v_mfma_f32_32x32x16_bf16 v[64:79], a[120:123], a[144:147], v[64:79]
    ds_read_b64_tr_b16 a[156:157], v16 offset:12288
    buffer_load_dwordx4 v[56:59], v19, s[20:23], s30 offen offset:2048 sc1
    v_mfma_f32_32x32x16_bf16 v[80:95], a[124:127], a[144:147], v[80:95]
    ds_read_b64_tr_b16 a[158:159], v16 offset:14336
    v_mfma_f32_32x32x16_bf16 v[96:111], a[128:131], a[144:147], v[96:111]
    buffer_load_dwordx4 v[60:63], v19, s[20:23], s30 offen offset:3072 sc1
    s_waitcnt vmcnt(16) lgkmcnt(0)
    s_barrier
    ds_read_b64_tr_b16 a[144:145], v13 offset:16384
    v_mfma_f32_32x32x16_bf16 v[184:199], a[120:123], a[148:151], v[184:199]
    ds_read_b64_tr_b16 a[146:147], v13 offset:18432
    v_mfma_f32_32x32x16_bf16 v[208:223], a[124:127], a[148:151], v[208:223]
    s_add_u32 m0, s28, 8192
    s_add_u32 s43, s58, 131072
    buffer_load_dwordx4 v2, s[4:7], s43 offen offset:0 lds
    v_mfma_f32_32x32x16_bf16 v[240:255], a[128:131], a[148:151], v[240:255]
    ds_read_b128 a[96:99], v17 offset:0
    buffer_load_dwordx4 v3, s[4:7], s43 offen offset:1024 lds
    v_mfma_f32_32x32x16_bf16 v[64:79], a[132:135], a[152:155], v[64:79]
    ds_read_b64_tr_b16 a[148:149], v14 offset:16384
    ds_read_b128 a[100:103], v17 offset:1024
    v_mfma_f32_32x32x16_bf16 v[80:95], a[136:139], a[152:155], v[80:95]
    ds_read_b64_tr_b16 a[150:151], v14 offset:18432
    buffer_load_dwordx4 v4, s[4:7], s43 offen offset:2048 lds
    ds_read_b128 a[104:107], v17 offset:2048
    v_mfma_f32_32x32x16_bf16 v[96:111], a[140:143], a[152:155], v[96:111]
    ds_read_b128 a[108:111], v17 offset:12288
    buffer_load_dwordx4 v5, s[4:7], s43 offen offset:3072 lds
    v_mfma_f32_32x32x16_bf16 v[184:199], a[132:135], a[156:159], v[184:199]
    ds_read_b64_tr_b16 a[152:153], v13 offset:20480
    ds_read_b128 a[112:115], v17 offset:13312
    v_mfma_f32_32x32x16_bf16 v[208:223], a[136:139], a[156:159], v[208:223]
    s_add_u32 m0, s28, 12288
    s_add_u32 s43, s58, 147456
    buffer_load_dwordx4 v2, s[4:7], s43 offen offset:0 lds
    ds_read_b64_tr_b16 a[154:155], v13 offset:22528
    ds_read_b128 a[116:119], v17 offset:14336
    v_mfma_f32_32x32x16_bf16 v[240:255], a[140:143], a[156:159], v[240:255]
    s_waitcnt vmcnt(5)
    s_mov_b32 s63, 0
    s_branch L_ochk_16
L_op_14:
    s_add_u32 s30, s53, 24576
    buffer_load_dwordx4 v[32:35], v19, s[20:23], s30 offen offset:0 sc1
    buffer_load_dwordx4 v[36:39], v19, s[20:23], s30 offen offset:1024 sc1
    buffer_load_dwordx4 v[40:43], v19, s[20:23], s30 offen offset:2048 sc1
    buffer_load_dwordx4 v[44:47], v19, s[20:23], s30 offen offset:3072 sc1
    s_add_u32 s30, s53, 28672
    buffer_load_dwordx4 v[48:51], v19, s[20:23], s30 offen offset:0 sc1
    buffer_load_dwordx4 v[52:55], v19, s[20:23], s30 offen offset:1024 sc1
    buffer_load_dwordx4 v[56:59], v19, s[20:23], s30 offen offset:2048 sc1
    buffer_load_dwordx4 v[60:63], v19, s[20:23], s30 offen offset:3072 sc1
    s_waitcnt vmcnt(0)
L_ochk_16:
    v_min3_u32 v20, v35, v39, v43
    v_max3_u32 v21, v35, v39, v43
    v_min3_u32 v20, v20, v47, v51
    v_max3_u32 v21, v21, v47, v51
    v_min3_u32 v20, v20, v55, v59
    v_max3_u32 v21, v21, v55, v59
    v_min_u32 v20, v20, v63
    v_max_u32 v21, v21, v63
    v_xor_b32 v20, s62, v20
    v_xor_b32 v21, s62, v21
    v_or_b32 v20, v20, v21
    s_add_u32 s63, s63, 1
    v_cmp_ne_u32 vcc, 0, v20
    s_cmp_ge_u32 s63, 65536
    s_cbranch_scc1 L_ook_15
    s_cbranch_vccnz L_op_14
L_ook_15:
    v_mov_b32 v35, v56
    v_mov_b32 v39, v57
    v_mov_b32 v43, v58
    v_mov_b32 v47, v60
    v_mov_b32 v51, v61
    v_mov_b32 v55, v62
    s_add_u32 m0, s28, 12288
    s_add_u32 s43, s58, 147456
    buffer_load_dwordx4 v3, s[4:7], s43 offen offset:1024 lds
    ds_write_b128 v1, v[32:35] offset:0
    s_waitcnt lgkmcnt(11)
    v_mfma_f32_32x32x16_bf16 v[64:79], v[176:179], a[144:147], v[64:79]
    ds_read_b64_tr_b16 a[156:157], v14 offset:20480
    buffer_load_dwordx4 v4, s[4:7], s43 offen offset:2048 lds
    v_mfma_f32_32x32x16_bf16 v[80:95], v[200:203], a[144:147], v[80:95]
    ds_read_b64_tr_b16 a[158:159], v14 offset:22528
    ds_write_b128 v1, v[36:39] offset:1024
    v_mfma_f32_32x32x16_bf16 v[96:111], v[224:227], a[144:147], v[96:111]
    buffer_load_dwordx4 v5, s[4:7], s43 offen offset:3072 lds
    s_waitcnt lgkmcnt(10)
    v_mfma_f32_32x32x16_bf16 v[184:199], v[176:179], a[148:151], v[184:199]
    ds_read_b64_tr_b16 a[144:145], v15 offset:16384
    ds_write_b128 v1, v[40:43] offset:2048
    s_add_u32 s30, s54, 24576
    buffer_load_dwordx4 v[112:115], v19, s[20:23], s30 offen offset:0 sc1
    v_mfma_f32_32x32x16_bf16 v[208:223], v[200:203], a[148:151], v[208:223]
    ds_read_b64_tr_b16 a[146:147], v15 offset:18432
    v_mfma_f32_32x32x16_bf16 v[240:255], v[224:227], a[148:151], v[240:255]
    buffer_load_dwordx4 v[116:119], v19, s[20:23], s30 offen offset:1024 sc1
    ds_write_b128 v1, v[44:47] offset:3072
    s_waitcnt lgkmcnt(9)
    v_mfma_f32_32x32x16_bf16 v[64:79], v[180:183], a[152:155], v[64:79]
    ds_read_b64_tr_b16 a[148:149], v16 offset:16384
    buffer_load_dwordx4 v[120:123], v19, s[20:23], s30 offen offset:2048 sc1
    v_mfma_f32_32x32x16_bf16 v[80:95], v[204:207], a[152:155], v[80:95]
    ds_read_b64_tr_b16 a[150:151], v16 offset:18432
    ds_write_b128 v1, v[48:51] offset:4096
    v_mfma_f32_32x32x16_bf16 v[96:111], v[228:231], a[152:155], v[96:111]
    buffer_load_dwordx4 v[124:127], v19, s[20:23], s30 offen offset:3072 sc1
    s_waitcnt lgkmcnt(8)
    v_mfma_f32_32x32x16_bf16 v[184:199], v[180:183], a[156:159], v[184:199]
    ds_read_b64_tr_b16 a[152:153], v15 offset:20480
    ds_write_b128 v1, v[52:55] offset:5120
    s_add_u32 s30, s54, 28672
    buffer_load_dwordx4 v[128:131], v19, s[20:23], s30 offen offset:0 sc1
    v_mfma_f32_32x32x16_bf16 v[208:223], v[204:207], a[156:159], v[208:223]
    ds_read_b64_tr_b16 a[154:155], v15 offset:22528
    v_mfma_f32_32x32x16_bf16 v[240:255], v[228:231], a[156:159], v[240:255]
    buffer_load_dwordx4 v[132:135], v19, s[20:23], s30 offen offset:1024 sc1
    s_waitcnt lgkmcnt(7)
    v_mfma_f32_32x32x16_bf16 v[64:79], a[96:99], a[144:147], v[64:79]
    ds_read_b64_tr_b16 a[156:157], v16 offset:20480
    buffer_load_dwordx4 v[136:139], v19, s[20:23], s30 offen offset:2048 sc1
    v_mfma_f32_32x32x16_bf16 v[80:95], a[100:103], a[144:147], v[80:95]
    ds_read_b64_tr_b16 a[158:159], v16 offset:22528
    v_mfma_f32_32x32x16_bf16 v[96:111], a[104:107], a[144:147], v[96:111]
    buffer_load_dwordx4 v[140:143], v19, s[20:23], s30 offen offset:3072 sc1
    s_waitcnt lgkmcnt(0)
    s_barrier
    ds_read_b64_tr_b16 a[144:145], v13 offset:24576
    v_mfma_f32_32x32x16_bf16 v[184:199], a[96:99], a[148:151], v[184:199]
    ds_read_b64_tr_b16 a[146:147], v13 offset:26624
    v_mfma_f32_32x32x16_bf16 v[208:223], a[100:103], a[148:151], v[208:223]
    s_add_u32 m0, s28, 16384
    s_add_u32 s43, s59, 131072
    buffer_load_dwordx4 v2, s[4:7], s43 offen offset:0 lds
    v_mfma_f32_32x32x16_bf16 v[240:255], a[104:107], a[148:151], v[240:255]
    ds_read_b128 a[120:123], v18 offset:0
    buffer_load_dwordx4 v3, s[4:7], s43 offen offset:1024 lds
    v_mfma_f32_32x32x16_bf16 v[64:79], a[108:111], a[152:155], v[64:79]
    ds_read_b64_tr_b16 a[148:149], v14 offset:24576
    ds_read_b128 a[124:127], v18 offset:1024
    v_mfma_f32_32x32x16_bf16 v[80:95], a[112:115], a[152:155], v[80:95]
    ds_read_b64_tr_b16 a[150:151], v14 offset:26624
    buffer_load_dwordx4 v4, s[4:7], s43 offen offset:2048 lds
    ds_read_b128 a[128:131], v18 offset:2048
    v_mfma_f32_32x32x16_bf16 v[96:111], a[116:119], a[152:155], v[96:111]
    ds_read_b128 a[132:135], v18 offset:3072
    buffer_load_dwordx4 v5, s[4:7], s43 offen offset:3072 lds
    v_mfma_f32_32x32x16_bf16 v[184:199], a[108:111], a[156:159], v[184:199]
    ds_read_b64_tr_b16 a[152:153], v13 offset:28672
    ds_read_b128 a[136:139], v18 offset:4096
    v_mfma_f32_32x32x16_bf16 v[208:223], a[112:115], a[156:159], v[208:223]
    s_add_u32 m0, s28, 20480
    s_add_u32 s43, s59, 147456
    buffer_load_dwordx4 v2, s[4:7], s43 offen offset:0 lds
    ds_read_b64_tr_b16 a[154:155], v13 offset:30720
    ds_read_b128 a[140:143], v18 offset:5120
    v_mfma_f32_32x32x16_bf16 v[240:255], a[116:119], a[156:159], v[240:255]
    s_waitcnt vmcnt(5)
    s_mov_b32 s63, 0
    s_branch L_ochk_19
L_op_17:
    s_add_u32 s30, s54, 24576
    buffer_load_dwordx4 v[112:115], v19, s[20:23], s30 offen offset:0 sc1
    buffer_load_dwordx4 v[116:119], v19, s[20:23], s30 offen offset:1024 sc1
    buffer_load_dwordx4 v[120:123], v19, s[20:23], s30 offen offset:2048 sc1
    buffer_load_dwordx4 v[124:127], v19, s[20:23], s30 offen offset:3072 sc1
    s_add_u32 s30, s54, 28672
    buffer_load_dwordx4 v[128:131], v19, s[20:23], s30 offen offset:0 sc1
    buffer_load_dwordx4 v[132:135], v19, s[20:23], s30 offen offset:1024 sc1
    buffer_load_dwordx4 v[136:139], v19, s[20:23], s30 offen offset:2048 sc1
    buffer_load_dwordx4 v[140:143], v19, s[20:23], s30 offen offset:3072 sc1
    s_waitcnt vmcnt(0)
L_ochk_19:
    v_min3_u32 v20, v115, v119, v123
    v_max3_u32 v21, v115, v119, v123
    v_min3_u32 v20, v20, v127, v131
    v_max3_u32 v21, v21, v127, v131
    v_min3_u32 v20, v20, v135, v139
    v_max3_u32 v21, v21, v135, v139
    v_min_u32 v20, v20, v143
    v_max_u32 v21, v21, v143
    v_xor_b32 v20, s62, v20
    v_xor_b32 v21, s62, v21
    v_or_b32 v20, v20, v21
    s_add_u32 s63, s63, 1
    v_cmp_ne_u32 vcc, 0, v20
    s_cmp_ge_u32 s63, 65536
    s_cbranch_scc1 L_ook_18
    s_cbranch_vccnz L_op_17
L_ook_18:
    v_mov_b32 v115, v136
    v_mov_b32 v119, v137
    v_mov_b32 v123, v138
    v_mov_b32 v127, v140
    v_mov_b32 v131, v141
    v_mov_b32 v135, v142
    s_add_u32 m0, s28, 20480
    s_add_u32 s43, s59, 147456
    buffer_load_dwordx4 v3, s[4:7], s43 offen offset:1024 lds
    ds_write_b128 v24, v[112:115] offset:0
    s_waitcnt lgkmcnt(11)
    v_mfma_f32_32x32x16_bf16 v[64:79], v[32:35], a[144:147], v[64:79]
    ds_read_b64_tr_b16 a[156:157], v14 offset:28672
    buffer_load_dwordx4 v4, s[4:7], s43 offen offset:2048 lds
    v_mfma_f32_32x32x16_bf16 v[80:95], v[36:39], a[144:147], v[80:95]
    ds_read_b64_tr_b16 a[158:159], v14 offset:30720
    ds_write_b128 v24, v[116:119] offset:1024
    v_mfma_f32_32x32x16_bf16 v[96:111], v[40:43], a[144:147], v[96:111]
    buffer_load_dwordx4 v5, s[4:7], s43 offen offset:3072 lds
    s_waitcnt lgkmcnt(10)
    v_mfma_f32_32x32x16_bf16 v[184:199], v[32:35], a[148:151], v[184:199]
    ds_read_b64_tr_b16 a[144:145], v15 offset:24576
    ds_write_b128 v24, v[120:123] offset:2048
    s_add_u32 s30, s55, 24576
    buffer_load_dwordx4 v[144:147], v19, s[20:23], s30 offen offset:0 sc1
    v_mfma_f32_32x32x16_bf16 v[208:223], v[36:39], a[148:151], v[208:223]
    ds_read_b64_tr_b16 a[146:147], v15 offset:26624
    v_mfma_f32_32x32x16_bf16 v[240:255], v[40:43], a[148:151], v[240:255]
    buffer_load_dwordx4 v[148:151], v19, s[20:23], s30 offen offset:1024 sc1
    ds_write_b128 v24, v[124:127] offset:12288
    s_waitcnt lgkmcnt(9)
    v_mfma_f32_32x32x16_bf16 v[64:79], v[44:47], a[152:155], v[64:79]
    ds_read_b64_tr_b16 a[148:149], v16 offset:24576
    buffer_load_dwordx4 v[152:155], v19, s[20:23], s30 offen offset:2048 sc1
    v_mfma_f32_32x32x16_bf16 v[80:95], v[48:51], a[152:155], v[80:95]
    ds_read_b64_tr_b16 a[150:151], v16 offset:26624
    ds_write_b128 v24, v[128:131] offset:13312
    v_mfma_f32_32x32x16_bf16 v[96:111], v[52:55], a[152:155], v[96:111]
    buffer_load_dwordx4 v[156:159], v19, s[20:23], s30 offen offset:3072 sc1
    s_waitcnt lgkmcnt(8)
    v_mfma_f32_32x32x16_bf16 v[184:199], v[44:47], a[156:159], v[184:199]
    ds_read_b64_tr_b16 a[152:153], v15 offset:28672
    ds_write_b128 v24, v[132:135] offset:14336
    s_add_u32 s30, s55, 28672
    buffer_load_dwordx4 v[160:163], v19, s[20:23], s30 offen offset:0 sc1
    v_mfma_f32_32x32x16_bf16 v[208:223], v[48:51], a[156:159], v[208:223]
    ds_read_b64_tr_b16 a[154:155], v15 offset:30720
    v_mfma_f32_32x32x16_bf16 v[240:255], v[52:55], a[156:159], v[240:255]
    buffer_load_dwordx4 v[164:167], v19, s[20:23], s30 offen offset:1024 sc1
    s_waitcnt lgkmcnt(7)
    v_mfma_f32_32x32x16_bf16 v[64:79], a[120:123], a[144:147], v[64:79]
    ds_read_b64_tr_b16 a[156:157], v16 offset:28672
    buffer_load_dwordx4 v[168:171], v19, s[20:23], s30 offen offset:2048 sc1
    v_mfma_f32_32x32x16_bf16 v[80:95], a[124:127], a[144:147], v[80:95]
    ds_read_b64_tr_b16 a[158:159], v16 offset:30720
    v_mfma_f32_32x32x16_bf16 v[96:111], a[128:131], a[144:147], v[96:111]
    buffer_load_dwordx4 v[172:175], v19, s[20:23], s30 offen offset:3072 sc1
    s_waitcnt lgkmcnt(0)
    s_barrier
    ds_read_b64_tr_b16 a[144:145], v13 offset:8192
    v_mfma_f32_32x32x16_bf16 v[184:199], a[120:123], a[148:151], v[184:199]
    ds_read_b64_tr_b16 a[146:147], v13 offset:10240
    v_mfma_f32_32x32x16_bf16 v[208:223], a[124:127], a[148:151], v[208:223]
    v_mfma_f32_32x32x16_bf16 v[240:255], a[128:131], a[148:151], v[240:255]
    ds_read_b128 a[96:99], v17 offset:0
    v_mfma_f32_32x32x16_bf16 v[64:79], a[132:135], a[152:155], v[64:79]
    ds_read_b64_tr_b16 a[148:149], v14 offset:8192
    ds_read_b128 a[100:103], v17 offset:1024
    v_mfma_f32_32x32x16_bf16 v[80:95], a[136:139], a[152:155], v[80:95]
    ds_read_b64_tr_b16 a[150:151], v14 offset:10240
    ds_read_b128 a[104:107], v17 offset:2048
    v_mfma_f32_32x32x16_bf16 v[96:111], a[140:143], a[152:155], v[96:111]
    ds_read_b128 a[108:111], v17 offset:12288
    v_mfma_f32_32x32x16_bf16 v[184:199], a[132:135], a[156:159], v[184:199]
    ds_read_b64_tr_b16 a[152:153], v13 offset:12288
    ds_read_b128 a[112:115], v17 offset:13312
    v_mfma_f32_32x32x16_bf16 v[208:223], a[136:139], a[156:159], v[208:223]
    ds_read_b64_tr_b16 a[154:155], v13 offset:14336
    ds_read_b128 a[116:119], v17 offset:14336
    v_mfma_f32_32x32x16_bf16 v[240:255], a[140:143], a[156:159], v[240:255]
    s_waitcnt vmcnt(0)
    s_mov_b32 s63, 0
    s_branch L_ochk_22
L_op_20:
    s_add_u32 s30, s55, 24576
    buffer_load_dwordx4 v[144:147], v19, s[20:23], s30 offen offset:0 sc1
    buffer_load_dwordx4 v[148:151], v19, s[20:23], s30 offen offset:1024 sc1
    buffer_load_dwordx4 v[152:155], v19, s[20:23], s30 offen offset:2048 sc1
    buffer_load_dwordx4 v[156:159], v19, s[20:23], s30 offen offset:3072 sc1
    s_add_u32 s30, s55, 28672
    buffer_load_dwordx4 v[160:163], v19, s[20:23], s30 offen offset:0 sc1
    buffer_load_dwordx4 v[164:167], v19, s[20:23], s30 offen offset:1024 sc1
    buffer_load_dwordx4 v[168:171], v19, s[20:23], s30 offen offset:2048 sc1
    buffer_load_dwordx4 v[172:175], v19, s[20:23], s30 offen offset:3072 sc1
    s_waitcnt vmcnt(0)
L_ochk_22:
    v_min3_u32 v20, v147, v151, v155
    v_max3_u32 v21, v147, v151, v155
    v_min3_u32 v20, v20, v159, v163
    v_max3_u32 v21, v21, v159, v163
    v_min3_u32 v20, v20, v167, v171
    v_max3_u32 v21, v21, v167, v171
    v_min_u32 v20, v20, v175
    v_max_u32 v21, v21, v175
    v_xor_b32 v20, s62, v20
    v_xor_b32 v21, s62, v21
    v_or_b32 v20, v20, v21
    s_add_u32 s63, s63, 1
    v_cmp_ne_u32 vcc, 0, v20
    s_cmp_ge_u32 s63, 65536
    s_cbranch_scc1 L_ook_21
    s_cbranch_vccnz L_op_20
L_ook_21:
    v_mov_b32 v147, v168
    v_mov_b32 v151, v169
    v_mov_b32 v155, v170
    v_mov_b32 v159, v172
    v_mov_b32 v163, v173
    v_mov_b32 v167, v174
    ds_write_b128 v1, v[144:147] offset:0
    s_waitcnt lgkmcnt(11)
    v_mfma_f32_32x32x16_bf16 v[64:79], v[112:115], a[144:147], v[64:79]
    ds_read_b64_tr_b16 a[156:157], v14 offset:12288
    v_mfma_f32_32x32x16_bf16 v[80:95], v[116:119], a[144:147], v[80:95]
    ds_read_b64_tr_b16 a[158:159], v14 offset:14336
    ds_write_b128 v1, v[148:151] offset:1024
    v_mfma_f32_32x32x16_bf16 v[96:111], v[120:123], a[144:147], v[96:111]
    s_waitcnt lgkmcnt(10)
    v_mfma_f32_32x32x16_bf16 v[184:199], v[112:115], a[148:151], v[184:199]
    ds_read_b64_tr_b16 a[144:145], v15 offset:8192
    ds_write_b128 v1, v[152:155] offset:2048
    v_mfma_f32_32x32x16_bf16 v[208:223], v[116:119], a[148:151], v[208:223]
    ds_read_b64_tr_b16 a[146:147], v15 offset:10240
    v_mfma_f32_32x32x16_bf16 v[240:255], v[120:123], a[148:151], v[240:255]
    ds_write_b128 v1, v[156:159] offset:3072
    s_waitcnt lgkmcnt(9)
    v_mfma_f32_32x32x16_bf16 v[64:79], v[124:127], a[152:155], v[64:79]
    ds_read_b64_tr_b16 a[148:149], v16 offset:8192
    v_mfma_f32_32x32x16_bf16 v[80:95], v[128:131], a[152:155], v[80:95]
    ds_read_b64_tr_b16 a[150:151], v16 offset:10240
    ds_write_b128 v1, v[160:163] offset:4096
    v_mfma_f32_32x32x16_bf16 v[96:111], v[132:135], a[152:155], v[96:111]
    s_waitcnt lgkmcnt(8)
    v_mfma_f32_32x32x16_bf16 v[184:199], v[124:127], a[156:159], v[184:199]
    ds_read_b64_tr_b16 a[152:153], v15 offset:12288
    ds_write_b128 v1, v[164:167] offset:5120
    v_mfma_f32_32x32x16_bf16 v[208:223], v[128:131], a[156:159], v[208:223]
    ds_read_b64_tr_b16 a[154:155], v15 offset:14336
    v_mfma_f32_32x32x16_bf16 v[240:255], v[132:135], a[156:159], v[240:255]
    s_waitcnt lgkmcnt(7)
    v_mfma_f32_32x32x16_bf16 v[64:79], a[96:99], a[144:147], v[64:79]
    ds_read_b64_tr_b16 a[156:157], v16 offset:12288
    v_mfma_f32_32x32x16_bf16 v[80:95], a[100:103], a[144:147], v[80:95]
    ds_read_b64_tr_b16 a[158:159], v16 offset:14336
    v_mfma_f32_32x32x16_bf16 v[96:111], a[104:107], a[144:147], v[96:111]
    s_waitcnt lgkmcnt(0)
    s_barrier
    ds_read_b64_tr_b16 a[144:145], v14 offset:16384
    v_mfma_f32_32x32x16_bf16 v[184:199], a[96:99], a[148:151], v[184:199]
    ds_read_b64_tr_b16 a[146:147], v14 offset:18432
    v_mfma_f32_32x32x16_bf16 v[208:223], a[100:103], a[148:151], v[208:223]
    v_mfma_f32_32x32x16_bf16 v[240:255], a[104:107], a[148:151], v[240:255]
    ds_read_b128 a[120:123], v18 offset:0
    ds_read_b128 a[124:127], v18 offset:1024
    v_mfma_f32_32x32x16_bf16 v[64:79], a[108:111], a[152:155], v[64:79]
    ds_read_b64_tr_b16 a[148:149], v14 offset:20480
    ds_read_b128 a[128:131], v18 offset:2048
    ds_read_b128 a[132:135], v18 offset:3072
    v_mfma_f32_32x32x16_bf16 v[80:95], a[112:115], a[152:155], v[80:95]
    ds_read_b64_tr_b16 a[150:151], v14 offset:22528
    ds_read_b128 a[136:139], v18 offset:4096
    ds_read_b128 a[140:143], v18 offset:5120
    v_mfma_f32_32x32x16_bf16 v[96:111], a[116:119], a[152:155], v[96:111]
    v_mfma_f32_32x32x16_bf16 v[184:199], a[108:111], a[156:159], v[184:199]
    ds_read_b64_tr_b16 a[152:153], v16 offset:16384
    v_mfma_f32_32x32x16_bf16 v[208:223], a[112:115], a[156:159], v[208:223]
    ds_read_b64_tr_b16 a[154:155], v16 offset:18432
    v_mfma_f32_32x32x16_bf16 v[240:255], a[116:119], a[156:159], v[240:255]
    s_waitcnt lgkmcnt(10)
    v_mfma_f32_32x32x16_bf16 v[184:199], v[144:147], a[144:147], v[184:199]
    ds_read_b64_tr_b16 a[156:157], v16 offset:20480
    v_mfma_f32_32x32x16_bf16 v[208:223], v[148:151], a[144:147], v[208:223]
    ds_read_b64_tr_b16 a[158:159], v16 offset:22528
    v_mfma_f32_32x32x16_bf16 v[240:255], v[152:155], a[144:147], v[240:255]
    s_waitcnt lgkmcnt(6)
    v_mfma_f32_32x32x16_bf16 v[184:199], v[156:159], a[148:151], v[184:199]
    ds_read_b64_tr_b16 a[144:145], v13 offset:16384
    v_mfma_f32_32x32x16_bf16 v[208:223], v[160:163], a[148:151], v[208:223]
    ds_read_b64_tr_b16 a[146:147], v13 offset:18432
    v_mfma_f32_32x32x16_bf16 v[240:255], v[164:167], a[148:151], v[240:255]
    s_waitcnt lgkmcnt(4)
    v_mfma_f32_32x32x16_bf16 v[184:199], a[120:123], a[152:155], v[184:199]
    ds_read_b64_tr_b16 a[148:149], v13 offset:20480
    v_mfma_f32_32x32x16_bf16 v[208:223], a[124:127], a[152:155], v[208:223]
    ds_read_b64_tr_b16 a[150:151], v13 offset:22528
    v_mfma_f32_32x32x16_bf16 v[240:255], a[128:131], a[152:155], v[240:255]
    s_waitcnt lgkmcnt(4)
    v_mfma_f32_32x32x16_bf16 v[184:199], a[132:135], a[156:159], v[184:199]
    ds_read_b64_tr_b16 a[152:153], v15 offset:16384
    v_mfma_f32_32x32x16_bf16 v[208:223], a[136:139], a[156:159], v[208:223]
    ds_read_b64_tr_b16 a[154:155], v15 offset:18432
    v_mfma_f32_32x32x16_bf16 v[240:255], a[140:143], a[156:159], v[240:255]
    s_waitcnt lgkmcnt(4)
    v_mfma_f32_32x32x16_bf16 v[64:79], v[144:147], a[144:147], v[64:79]
    s_mov_b32 s16, s48
    s_mov_b32 s17, s49
    s_add_u32 s16, s16, 33554432
    s_addc_u32 s17, s17, 0
    s_mov_b32 s18, 8388608
    s_lshl_b32 s50, s36, 13
    s_add_u32 s50, s50, s42
    s_lshl_b32 s51, s36, 15
    s_add_u32 s51, s51, s42
    s_add_u32 s57, s36, 1
    s_and_b32 s57, s57, 3
    s_lshl_b32 s57, s57, 13
    s_add_u32 s57, s57, s51
    s_add_u32 s58, s36, 2
    s_and_b32 s58, s58, 3
    s_lshl_b32 s58, s58, 13
    s_add_u32 s58, s58, s51
    s_add_u32 s59, s36, 3
    s_and_b32 s59, s59, 3
    s_lshl_b32 s59, s59, 13
    s_add_u32 s59, s59, s51
    ds_read_b64_tr_b16 a[156:157], v15 offset:20480
    v_mfma_f32_32x32x16_bf16 v[80:95], v[148:151], a[144:147], v[80:95]
    ds_read_b64_tr_b16 a[158:159], v15 offset:22528
    v_mfma_f32_32x32x16_bf16 v[96:111], v[152:155], a[144:147], v[96:111]
    v_mov_b32 v35, s62
    s_waitcnt lgkmcnt(4)
    v_mfma_f32_32x32x16_bf16 v[64:79], v[156:159], a[148:151], v[64:79]
    v_mov_b32 v39, s62
    ds_write_b128 v1, v[184:187] offset:24576
    ds_write_b128 v1, v[188:191] offset:25600
    v_mfma_f32_32x32x16_bf16 v[80:95], v[160:163], a[148:151], v[80:95]
    v_mov_b32 v43, s62
    ds_write_b128 v1, v[192:195] offset:26624
    v_mfma_f32_32x32x16_bf16 v[96:111], v[164:167], a[148:151], v[96:111]
    v_mov_b32 v47, s62
    ds_write_b128 v1, v[196:199] offset:27648
    s_waitcnt lgkmcnt(6)
    v_mfma_f32_32x32x16_bf16 v[64:79], a[120:123], a[152:155], v[64:79]
    ds_write_b128 v1, v[208:211] offset:28672
    v_mov_b32 v51, s62
    ds_write_b128 v1, v[212:215] offset:29696
    v_mfma_f32_32x32x16_bf16 v[80:95], a[124:127], a[152:155], v[80:95]
    v_mov_b32 v55, s62
    ds_write_b128 v1, v[216:219] offset:30720
    v_mfma_f32_32x32x16_bf16 v[96:111], a[128:131], a[152:155], v[96:111]
    v_mov_b32 v59, s62
    ds_write_b128 v1, v[220:223] offset:31744
    ds_write_b128 v1, v[240:243] offset:8192
    s_waitcnt lgkmcnt(9)
    v_mfma_f32_32x32x16_bf16 v[64:79], a[132:135], a[156:159], v[64:79]
    v_mov_b32 v63, s62
    ds_write_b128 v1, v[244:247] offset:9216
    v_mfma_f32_32x32x16_bf16 v[80:95], a[136:139], a[156:159], v[80:95]
    ds_write_b128 v1, v[248:251] offset:10240
    ds_write_b128 v1, v[252:255] offset:11264
    v_mfma_f32_32x32x16_bf16 v[96:111], a[140:143], a[156:159], v[96:111]
    s_waitcnt lgkmcnt(0)
    s_barrier
    ds_read_b128 v[112:115], v31 offset:24576
    ds_read_b128 v[116:119], v31 offset:25600
    ds_read_b128 v[120:123], v31 offset:26624
    ds_read_b128 v[124:127], v31 offset:27648
    ds_read_b128 v[128:131], v31 offset:28672
    ds_read_b128 v[132:135], v31 offset:29696
    ds_read_b128 v[136:139], v31 offset:30720
    ds_read_b128 v[140:143], v31 offset:31744
    ds_read_b128 v[144:147], v31 offset:8192
    ds_read_b128 v[148:151], v31 offset:9216
    ds_read_b128 v[152:155], v31 offset:10240
    ds_read_b128 v[156:159], v31 offset:11264
    s_waitcnt lgkmcnt(8)
    v_pk_add_f32 v[64:65], v[64:65], v[112:113]
    v_pk_add_f32 v[66:67], v[66:67], v[114:115]
    v_pk_add_f32 v[68:69], v[68:69], v[116:117]
    v_pk_add_f32 v[70:71], v[70:71], v[118:119]
    v_pk_add_f32 v[72:73], v[72:73], v[120:121]
    v_pk_add_f32 v[74:75], v[74:75], v[122:123]
    v_pk_add_f32 v[76:77], v[76:77], v[124:125]
    v_pk_add_f32 v[78:79], v[78:79], v[126:127]
    s_waitcnt lgkmcnt(4)
    v_pk_add_f32 v[80:81], v[80:81], v[128:129]
    v_pk_add_f32 v[82:83], v[82:83], v[130:131]
    v_pk_add_f32 v[84:85], v[84:85], v[132:133]
    v_pk_add_f32 v[86:87], v[86:87], v[134:135]
    v_pk_add_f32 v[88:89], v[88:89], v[136:137]
    v_pk_add_f32 v[90:91], v[90:91], v[138:139]
    v_pk_add_f32 v[92:93], v[92:93], v[140:141]
    v_pk_add_f32 v[94:95], v[94:95], v[142:143]
    s_waitcnt lgkmcnt(0)
    v_pk_add_f32 v[96:97], v[96:97], v[144:145]
    v_pk_add_f32 v[98:99], v[98:99], v[146:147]
    v_pk_add_f32 v[100:101], v[100:101], v[148:149]
    v_pk_add_f32 v[102:103], v[102:103], v[150:151]
    v_pk_add_f32 v[104:105], v[104:105], v[152:153]
    v_pk_add_f32 v[106:107], v[106:107], v[154:155]
    v_pk_add_f32 v[108:109], v[108:109], v[156:157]
    v_pk_add_f32 v[110:111], v[110:111], v[158:159]
    s_cmp_eq_u32 s36, 0
    s_cbranch_scc1 L_d_24
    v_cvt_pk_bf16_f32 v32, v64, v65
    v_cvt_pk_bf16_f32 v33, v66, v67
    v_cvt_pk_bf16_f32 v34, v80, v81
    v_cvt_pk_bf16_f32 v36, v82, v83
    v_cvt_pk_bf16_f32 v37, v96, v97
    v_cvt_pk_bf16_f32 v38, v98, v99
    s_add_u32 s26, s50, 0
    buffer_store_dwordx4 v[32:35], v7, s[16:19], s26 offen offset:0 sc1
    buffer_store_dwordx4 v[36:39], v7, s[16:19], s26 offen offset:1024 sc1
    s_branch L_n_25
L_d_24:
    v_mov_b32 v160, v64
    v_mov_b32 v161, v65
    v_mov_b32 v162, v66
    v_mov_b32 v163, v67
    v_mov_b32 v164, v80
    v_mov_b32 v165, v81
    v_mov_b32 v166, v82
    v_mov_b32 v167, v83
    v_mov_b32 v168, v96
    v_mov_b32 v169, v97
    v_mov_b32 v170, v98
    v_mov_b32 v171, v99
L_n_25:
    s_cmp_eq_u32 s36, 1
    s_cbranch_scc1 L_d_26
    v_cvt_pk_bf16_f32 v40, v68, v69
    v_cvt_pk_bf16_f32 v41, v70, v71
    v_cvt_pk_bf16_f32 v42, v84, v85
    v_cvt_pk_bf16_f32 v44, v86, v87
    v_cvt_pk_bf16_f32 v45, v100, v101
    v_cvt_pk_bf16_f32 v46, v102, v103
    s_add_u32 s26, s50, 32768
    buffer_store_dwordx4 v[40:43], v7, s[16:19], s26 offen offset:0 sc1
    buffer_store_dwordx4 v[44:47], v7, s[16:19], s26 offen offset:1024 sc1
    s_branch L_n_27
L_d_26:
    v_mov_b32 v160, v68
    v_mov_b32 v161, v69
    v_mov_b32 v162, v70
    v_mov_b32 v163, v71
    v_mov_b32 v164, v84
    v_mov_b32 v165, v85
    v_mov_b32 v166, v86
    v_mov_b32 v167, v87
    v_mov_b32 v168, v100
    v_mov_b32 v169, v101
    v_mov_b32 v170, v102
    v_mov_b32 v171, v103
L_n_27:
    s_cmp_eq_u32 s36, 2
    s_cbranch_scc1 L_d_28
    v_cvt_pk_bf16_f32 v48, v72, v73
    v_cvt_pk_bf16_f32 v49, v74, v75
    v_cvt_pk_bf16_f32 v50, v88, v89
    v_cvt_pk_bf16_f32 v52, v90, v91
    v_cvt_pk_bf16_f32 v53, v104, v105
    v_cvt_pk_bf16_f32 v54, v106, v107
    s_add_u32 s26, s50, 65536
    buffer_store_dwordx4 v[48:51], v7, s[16:19], s26 offen offset:0 sc1
    buffer_store_dwordx4 v[52:55], v7, s[16:19], s26 offen offset:1024 sc1
    s_branch L_n_29
L_d_28:
    v_mov_b32 v160, v72
    v_mov_b32 v161, v73
    v_mov_b32 v162, v74
    v_mov_b32 v163, v75
    v_mov_b32 v164, v88
    v_mov_b32 v165, v89
    v_mov_b32 v166, v90
    v_mov_b32 v167, v91
    v_mov_b32 v168, v104
    v_mov_b32 v169, v105
    v_mov_b32 v170, v106
    v_mov_b32 v171, v107
L_n_29:
    s_cmp_eq_u32 s36, 3
    s_cbranch_scc1 L_d_30
    v_cvt_pk_bf16_f32 v56, v76, v77
    v_cvt_pk_bf16_f32 v57, v78, v79
    v_cvt_pk_bf16_f32 v58, v92, v93
    v_cvt_pk_bf16_f32 v60, v94, v95
    v_cvt_pk_bf16_f32 v61, v108, v109
    v_cvt_pk_bf16_f32 v62, v110, v111
    s_add_u32 s26, s50, 98304
    buffer_store_dwordx4 v[56:59], v7, s[16:19], s26 offen offset:0 sc1
    buffer_store_dwordx4 v[60:63], v7, s[16:19], s26 offen offset:1024 sc1
    s_branch L_n_31
L_d_30:
    v_mov_b32 v160, v76
    v_mov_b32 v161, v77
    v_mov_b32 v162, v78
    v_mov_b32 v163, v79
    v_mov_b32 v164, v92
    v_mov_b32 v165, v93
    v_mov_b32 v166, v94
    v_mov_b32 v167, v95
    v_mov_b32 v168, v108
    v_mov_b32 v169, v109
    v_mov_b32 v170, v110
    v_mov_b32 v171, v111
L_n_31:
    s_mov_b32 s63, 0
L_pp_32:
    buffer_load_dwordx4 v[112:115], v7, s[16:19], s57 offen offset:0 sc1
    buffer_load_dwordx4 v[116:119], v7, s[16:19], s57 offen offset:1024 sc1
    buffer_load_dwordx4 v[120:123], v7, s[16:19], s58 offen offset:0 sc1
    buffer_load_dwordx4 v[124:127], v7, s[16:19], s58 offen offset:1024 sc1
    buffer_load_dwordx4 v[128:131], v7, s[16:19], s59 offen offset:0 sc1
    buffer_load_dwordx4 v[132:135], v7, s[16:19], s59 offen offset:1024 sc1
    s_add_u32 s63, s63, 1
    s_waitcnt vmcnt(0)
    v_xor_b32 v140, s62, v115
    v_xor_b32 v141, s62, v119
    v_xor_b32 v142, s62, v123
    v_xor_b32 v143, s62, v127
    v_xor_b32 v144, s62, v131
    v_xor_b32 v145, s62, v135
    v_or3_b32 v20, v140, v141, v142
    v_or3_b32 v21, v143, v144, v145
    v_or_b32 v20, v20, v21
    v_cmp_ne_u32 vcc, 0, v20
    s_cmp_ge_u32 s63, 65536
    s_cbranch_scc1 L_pok_33
    s_cbranch_vccnz L_pp_32
L_pok_33:
    v_lshlrev_b32 v172, 16, v112
    v_and_b32 v173, 0xffff0000, v112
    v_pk_add_f32 v[160:161], v[160:161], v[172:173]
    v_lshlrev_b32 v174, 16, v113
    v_and_b32 v175, 0xffff0000, v113
    v_pk_add_f32 v[162:163], v[162:163], v[174:175]
    v_lshlrev_b32 v172, 16, v114
    v_and_b32 v173, 0xffff0000, v114
    v_pk_add_f32 v[164:165], v[164:165], v[172:173]
    v_lshlrev_b32 v174, 16, v116
    v_and_b32 v175, 0xffff0000, v116
    v_pk_add_f32 v[166:167], v[166:167], v[174:175]
    v_lshlrev_b32 v172, 16, v117
    v_and_b32 v173, 0xffff0000, v117
    v_pk_add_f32 v[168:169], v[168:169], v[172:173]
    v_lshlrev_b32 v174, 16, v118
    v_and_b32 v175, 0xffff0000, v118
    v_pk_add_f32 v[170:171], v[170:171], v[174:175]
    v_lshlrev_b32 v172, 16, v120
    v_and_b32 v173, 0xffff0000, v120
    v_pk_add_f32 v[160:161], v[160:161], v[172:173]
    v_lshlrev_b32 v174, 16, v121
    v_and_b32 v175, 0xffff0000, v121
    v_pk_add_f32 v[162:163], v[162:163], v[174:175]
    v_lshlrev_b32 v172, 16, v122
    v_and_b32 v173, 0xffff0000, v122
    v_pk_add_f32 v[164:165], v[164:165], v[172:173]
    v_lshlrev_b32 v174, 16, v124
    v_and_b32 v175, 0xffff0000, v124
    v_pk_add_f32 v[166:167], v[166:167], v[174:175]
    v_lshlrev_b32 v172, 16, v125
    v_and_b32 v173, 0xffff0000, v125
    v_pk_add_f32 v[168:169], v[168:169], v[172:173]
    v_lshlrev_b32 v174, 16, v126
    v_and_b32 v175, 0xffff0000, v126
    v_pk_add_f32 v[170:171], v[170:171], v[174:175]
    v_lshlrev_b32 v172, 16, v128
    v_and_b32 v173, 0xffff0000, v128
    v_pk_add_f32 v[160:161], v[160:161], v[172:173]
    v_lshlrev_b32 v174, 16, v129
    v_and_b32 v175, 0xffff0000, v129
    v_pk_add_f32 v[162:163], v[162:163], v[174:175]
    v_lshlrev_b32 v172, 16, v130
    v_and_b32 v173, 0xffff0000, v130
    v_pk_add_f32 v[164:165], v[164:165], v[172:173]
    v_lshlrev_b32 v174, 16, v132
    v_and_b32 v175, 0xffff0000, v132
    v_pk_add_f32 v[166:167], v[166:167], v[174:175]
    v_lshlrev_b32 v172, 16, v133
    v_and_b32 v173, 0xffff0000, v133
    v_pk_add_f32 v[168:169], v[168:169], v[172:173]
    v_lshlrev_b32 v174, 16, v134
    v_and_b32 v175, 0xffff0000, v134
    v_pk_add_f32 v[170:171], v[170:171], v[174:175]
    v_cvt_pk_bf16_f32 v208, v160, v161
    v_cvt_pk_bf16_f32 v209, v162, v163
    v_cvt_pk_bf16_f32 v210, v164, v165
    v_cvt_pk_bf16_f32 v211, v166, v167
    v_cvt_pk_bf16_f32 v212, v168, v169
    v_cvt_pk_bf16_f32 v213, v170, v171
    s_add_u32 s26, s27, 0
    buffer_store_short v208, v12, s[8:11], s26 offen
    buffer_store_short_d16_hi v208, v12, s[8:11], s26 offen offset:2048
    s_add_u32 s26, s27, 4096
    buffer_store_short v209, v12, s[8:11], s26 offen
    buffer_store_short_d16_hi v209, v12, s[8:11], s26 offen offset:2048
    s_add_u32 s26, s27, 65536
    buffer_store_short v210, v12, s[8:11], s26 offen
    buffer_store_short_d16_hi v210, v12, s[8:11], s26 offen offset:2048
    s_add_u32 s26, s27, 69632
    buffer_store_short v211, v12, s[8:11], s26 offen
    buffer_store_short_d16_hi v211, v12, s[8:11], s26 offen offset:2048
    s_add_u32 s26, s27, 131072
    buffer_store_short v212, v12, s[8:11], s26 offen
    buffer_store_short_d16_hi v212, v12, s[8:11], s26 offen offset:2048
    s_add_u32 s26, s27, 135168
    buffer_store_short v213, v12, s[8:11], s26 offen
    buffer_store_short_d16_hi v213, v12, s[8:11], s26 offen offset:2048
L_end:
    s_endpgm
L_slow0:
    s_waitcnt vmcnt(0) lgkmcnt(0)
    s_barrier
    s_mov_b64 s[38:39], 0
    s_add_u32 m0, s28, 0
    s_add_u32 s29, s94, 0
    buffer_load_dwordx4 v2, s[12:15], s29 offen offset:0 nt lds
    buffer_load_dwordx4 v3, s[12:15], s29 offen offset:1024 nt lds
    buffer_load_dwordx4 v4, s[12:15], s29 offen offset:2048 nt lds
    buffer_load_dwordx4 v5, s[12:15], s29 offen offset:3072 nt lds
    s_add_u32 m0, s28, 4096
    s_add_u32 s29, s94, 4096
    buffer_load_dwordx4 v2, s[12:15], s29 offen offset:0 nt lds
    buffer_load_dwordx4 v3, s[12:15], s29 offen offset:1024 nt lds
    buffer_load_dwordx4 v4, s[12:15], s29 offen offset:2048 nt lds
    buffer_load_dwordx4 v5, s[12:15], s29 offen offset:3072 nt lds
    s_add_u32 m0, s28, 8192
    s_add_u32 s29, s95, 0
    buffer_load_dwordx4 v2, s[12:15], s29 offen offset:0 nt lds
    buffer_load_dwordx4 v3, s[12:15], s29 offen offset:1024 nt lds
    buffer_load_dwordx4 v4, s[12:15], s29 offen offset:2048 nt lds
    buffer_load_dwordx4 v5, s[12:15], s29 offen offset:3072 nt lds
    s_add_u32 m0, s28, 12288
    s_add_u32 s29, s95, 4096
    buffer_load_dwordx4 v2, s[12:15], s29 offen offset:0 nt lds
    buffer_load_dwordx4 v3, s[12:15], s29 offen offset:1024 nt lds
    buffer_load_dwordx4 v4, s[12:15], s29 offen offset:2048 nt lds
    buffer_load_dwordx4 v5, s[12:15], s29 offen offset:3072 nt lds
    s_add_u32 m0, s28, 16384
    s_add_u32 s29, s96, 0
    buffer_load_dwordx4 v2, s[12:15], s29 offen offset:0 nt lds
    buffer_load_dwordx4 v3, s[12:15], s29 offen offset:1024 nt lds
    buffer_load_dwordx4 v4, s[12:15], s29 offen offset:2048 nt lds
    buffer_load_dwordx4 v5, s[12:15], s29 offen offset:3072 nt lds
    s_add_u32 m0, s28, 20480
    s_add_u32 s29, s96, 4096
    buffer_load_dwordx4 v2, s[12:15], s29 offen offset:0 nt lds
    buffer_load_dwordx4 v3, s[12:15], s29 offen offset:1024 nt lds
    buffer_load_dwordx4 v4, s[12:15], s29 offen offset:2048 nt lds
    buffer_load_dwordx4 v5, s[12:15], s29 offen offset:3072 nt lds
    s_add_u32 m0, s28, 24576
    s_add_u32 s29, s97, 0
    buffer_load_dwordx4 v2, s[12:15], s29 offen offset:0 nt lds
    buffer_load_dwordx4 v3, s[12:15], s29 offen offset:1024 nt lds
    buffer_load_dwordx4 v4, s[12:15], s29 offen offset:2048 nt lds
    buffer_load_dwordx4 v5, s[12:15], s29 offen offset:3072 nt lds
    s_add_u32 m0, s28, 28672
    s_add_u32 s29, s97, 4096
    buffer_load_dwordx4 v2, s[12:15], s29 offen offset:0 nt lds
    buffer_load_dwordx4 v3, s[12:15], s29 offen offset:1024 nt lds
    buffer_load_dwordx4 v4, s[12:15], s29 offen offset:2048 nt lds
    buffer_load_dwordx4 v5, s[12:15], s29 offen offset:3072 nt lds
    s_waitcnt vmcnt(0)
    ds_read_b128 v[32:35], v12 offset:0
    ds_read_b128 v[36:39], v13 offset:0
    ds_read_b128 v[40:43], v14 offset:0
    ds_read_b128 v[44:47], v15 offset:0
    ds_read_b128 v[48:51], v16 offset:0
    ds_read_b128 v[52:55], v17 offset:0
    ds_read_b128 v[56:59], v18 offset:0
    ds_read_b128 v[60:63], v19 offset:0
    s_waitcnt lgkmcnt(0)
    v_mfma_f32_32x32x16_bf16 v[64:79], v[32:35], a[0:3], 0
    v_mfma_f32_32x32x16_bf16 v[80:95], v[32:35], a[4:7], 0
    v_mfma_f32_32x32x16_bf16 v[96:111], v[32:35], a[8:11], 0
    v_mfma_f32_32x32x16_bf16 v[64:79], v[36:39], a[12:15], v[64:79]
    v_mfma_f32_32x32x16_bf16 v[80:95], v[36:39], a[16:19], v[80:95]
    v_mfma_f32_32x32x16_bf16 v[96:111], v[36:39], a[20:23], v[96:111]
    v_mfma_f32_32x32x16_bf16 v[64:79], v[40:43], a[24:27], v[64:79]
    v_mfma_f32_32x32x16_bf16 v[80:95], v[40:43], a[28:31], v[80:95]
    v_mfma_f32_32x32x16_bf16 v[96:111], v[40:43], a[32:35], v[96:111]
    v_mfma_f32_32x32x16_bf16 v[64:79], v[44:47], a[36:39], v[64:79]
    v_mfma_f32_32x32x16_bf16 v[80:95], v[44:47], a[40:43], v[80:95]
    v_mfma_f32_32x32x16_bf16 v[96:111], v[44:47], a[44:47], v[96:111]
    v_mfma_f32_32x32x16_bf16 v[64:79], v[48:51], a[48:51], v[64:79]
    v_mfma_f32_32x32x16_bf16 v[80:95], v[48:51], a[52:55], v[80:95]
    v_mfma_f32_32x32x16_bf16 v[96:111], v[48:51], a[56:59], v[96:111]
    v_mfma_f32_32x32x16_bf16 v[64:79], v[52:55], a[60:63], v[64:79]
    v_mfma_f32_32x32x16_bf16 v[80:95], v[52:55], a[64:67], v[80:95]
    v_mfma_f32_32x32x16_bf16 v[96:111], v[52:55], a[68:71], v[96:111]
    v_mfma_f32_32x32x16_bf16 v[64:79], v[56:59], a[72:75], v[64:79]
    v_mfma_f32_32x32x16_bf16 v[80:95], v[56:59], a[76:79], v[80:95]
    v_mfma_f32_32x32x16_bf16 v[96:111], v[56:59], a[80:83], v[96:111]
    v_mfma_f32_32x32x16_bf16 v[64:79], v[60:63], a[84:87], v[64:79]
    v_mfma_f32_32x32x16_bf16 v[80:95], v[60:63], a[88:91], v[80:95]
    v_mfma_f32_32x32x16_bf16 v[96:111], v[60:63], a[92:95], v[96:111]
    ds_read_b128 v[32:35], v12 offset:8192
    ds_read_b128 v[36:39], v13 offset:8192
    ds_read_b128 v[40:43], v14 offset:8192
    ds_read_b128 v[44:47], v15 offset:8192
    ds_read_b128 v[48:51], v16 offset:8192
    ds_read_b128 v[52:55], v17 offset:8192
    ds_read_b128 v[56:59], v18 offset:8192
    ds_read_b128 v[60:63], v19 offset:8192
    s_waitcnt lgkmcnt(0)
    v_mfma_f32_32x32x16_bf16 v[112:127], v[32:35], a[0:3], 0
    v_mfma_f32_32x32x16_bf16 v[128:143], v[32:35], a[4:7], 0
    v_mfma_f32_32x32x16_bf16 v[144:159], v[32:35], a[8:11], 0
    v_mfma_f32_32x32x16_bf16 v[112:127], v[36:39], a[12:15], v[112:127]
    v_mfma_f32_32x32x16_bf16 v[128:143], v[36:39], a[16:19], v[128:143]
    v_mfma_f32_32x32x16_bf16 v[144:159], v[36:39], a[20:23], v[144:159]
    v_mfma_f32_32x32x16_bf16 v[112:127], v[40:43], a[24:27], v[112:127]
    v_mfma_f32_32x32x16_bf16 v[128:143], v[40:43], a[28:31], v[128:143]
    v_mfma_f32_32x32x16_bf16 v[144:159], v[40:43], a[32:35], v[144:159]
    v_mfma_f32_32x32x16_bf16 v[112:127], v[44:47], a[36:39], v[112:127]
    v_mfma_f32_32x32x16_bf16 v[128:143], v[44:47], a[40:43], v[128:143]
    v_mfma_f32_32x32x16_bf16 v[144:159], v[44:47], a[44:47], v[144:159]
    v_mfma_f32_32x32x16_bf16 v[112:127], v[48:51], a[48:51], v[112:127]
    v_mfma_f32_32x32x16_bf16 v[128:143], v[48:51], a[52:55], v[128:143]
    v_mfma_f32_32x32x16_bf16 v[144:159], v[48:51], a[56:59], v[144:159]
    v_mfma_f32_32x32x16_bf16 v[112:127], v[52:55], a[60:63], v[112:127]
    v_mfma_f32_32x32x16_bf16 v[128:143], v[52:55], a[64:67], v[128:143]
    v_mfma_f32_32x32x16_bf16 v[144:159], v[52:55], a[68:71], v[144:159]
    v_mfma_f32_32x32x16_bf16 v[112:127], v[56:59], a[72:75], v[112:127]
    v_mfma_f32_32x32x16_bf16 v[128:143], v[56:59], a[76:79], v[128:143]
    v_mfma_f32_32x32x16_bf16 v[144:159], v[56:59], a[80:83], v[144:159]
    v_mfma_f32_32x32x16_bf16 v[112:127], v[60:63], a[84:87], v[112:127]
    v_mfma_f32_32x32x16_bf16 v[128:143], v[60:63], a[88:91], v[128:143]
    v_mfma_f32_32x32x16_bf16 v[144:159], v[60:63], a[92:95], v[144:159]
    ds_read_b128 v[32:35], v12 offset:16384
    ds_read_b128 v[36:39], v13 offset:16384
    ds_read_b128 v[40:43], v14 offset:16384
    ds_read_b128 v[44:47], v15 offset:16384
    ds_read_b128 v[48:51], v16 offset:16384
    ds_read_b128 v[52:55], v17 offset:16384
    ds_read_b128 v[56:59], v18 offset:16384
    ds_read_b128 v[60:63], v19 offset:16384
    s_waitcnt lgkmcnt(0)
    v_mfma_f32_32x32x16_bf16 v[160:175], v[32:35], a[0:3], 0
    v_mfma_f32_32x32x16_bf16 v[176:191], v[32:35], a[4:7], 0
    v_mfma_f32_32x32x16_bf16 v[192:207], v[32:35], a[8:11], 0
    v_mfma_f32_32x32x16_bf16 v[160:175], v[36:39], a[12:15], v[160:175]
    v_mfma_f32_32x32x16_bf16 v[176:191], v[36:39], a[16:19], v[176:191]
    v_mfma_f32_32x32x16_bf16 v[192:207], v[36:39], a[20:23], v[192:207]
    v_mfma_f32_32x32x16_bf16 v[160:175], v[40:43], a[24:27], v[160:175]
    v_mfma_f32_32x32x16_bf16 v[176:191], v[40:43], a[28:31], v[176:191]
    v_mfma_f32_32x32x16_bf16 v[192:207], v[40:43], a[32:35], v[192:207]
    v_mfma_f32_32x32x16_bf16 v[160:175], v[44:47], a[36:39], v[160:175]
    v_mfma_f32_32x32x16_bf16 v[176:191], v[44:47], a[40:43], v[176:191]
    v_mfma_f32_32x32x16_bf16 v[192:207], v[44:47], a[44:47], v[192:207]
    v_mfma_f32_32x32x16_bf16 v[160:175], v[48:51], a[48:51], v[160:175]
    v_mfma_f32_32x32x16_bf16 v[176:191], v[48:51], a[52:55], v[176:191]
    v_mfma_f32_32x32x16_bf16 v[192:207], v[48:51], a[56:59], v[192:207]
    v_mfma_f32_32x32x16_bf16 v[160:175], v[52:55], a[60:63], v[160:175]
    v_mfma_f32_32x32x16_bf16 v[176:191], v[52:55], a[64:67], v[176:191]
    v_mfma_f32_32x32x16_bf16 v[192:207], v[52:55], a[68:71], v[192:207]
    v_mfma_f32_32x32x16_bf16 v[160:175], v[56:59], a[72:75], v[160:175]
    v_mfma_f32_32x32x16_bf16 v[176:191], v[56:59], a[76:79], v[176:191]
    v_mfma_f32_32x32x16_bf16 v[192:207], v[56:59], a[80:83], v[192:207]
    v_mfma_f32_32x32x16_bf16 v[160:175], v[60:63], a[84:87], v[160:175]
    v_mfma_f32_32x32x16_bf16 v[176:191], v[60:63], a[88:91], v[176:191]
    v_mfma_f32_32x32x16_bf16 v[192:207], v[60:63], a[92:95], v[192:207]
    ds_read_b128 v[32:35], v12 offset:24576
    ds_read_b128 v[36:39], v13 offset:24576
    ds_read_b128 v[40:43], v14 offset:24576
    ds_read_b128 v[44:47], v15 offset:24576
    ds_read_b128 v[48:51], v16 offset:24576
    ds_read_b128 v[52:55], v17 offset:24576
    ds_read_b128 v[56:59], v18 offset:24576
    ds_read_b128 v[60:63], v19 offset:24576
    s_waitcnt lgkmcnt(0)
    v_mfma_f32_32x32x16_bf16 v[208:223], v[32:35], a[0:3], 0
    v_mfma_f32_32x32x16_bf16 v[224:239], v[32:35], a[4:7], 0
    v_mfma_f32_32x32x16_bf16 v[240:255], v[32:35], a[8:11], 0
    v_mfma_f32_32x32x16_bf16 v[208:223], v[36:39], a[12:15], v[208:223]
    v_mfma_f32_32x32x16_bf16 v[224:239], v[36:39], a[16:19], v[224:239]
    v_mfma_f32_32x32x16_bf16 v[240:255], v[36:39], a[20:23], v[240:255]
    v_mfma_f32_32x32x16_bf16 v[208:223], v[40:43], a[24:27], v[208:223]
    v_mfma_f32_32x32x16_bf16 v[224:239], v[40:43], a[28:31], v[224:239]
    v_mfma_f32_32x32x16_bf16 v[240:255], v[40:43], a[32:35], v[240:255]
    v_mfma_f32_32x32x16_bf16 v[208:223], v[44:47], a[36:39], v[208:223]
    v_mfma_f32_32x32x16_bf16 v[224:239], v[44:47], a[40:43], v[224:239]
    v_mfma_f32_32x32x16_bf16 v[240:255], v[44:47], a[44:47], v[240:255]
    v_mfma_f32_32x32x16_bf16 v[208:223], v[48:51], a[48:51], v[208:223]
    v_mfma_f32_32x32x16_bf16 v[224:239], v[48:51], a[52:55], v[224:239]
    v_mfma_f32_32x32x16_bf16 v[240:255], v[48:51], a[56:59], v[240:255]
    v_mfma_f32_32x32x16_bf16 v[208:223], v[52:55], a[60:63], v[208:223]
    v_mfma_f32_32x32x16_bf16 v[224:239], v[52:55], a[64:67], v[224:239]
    v_mfma_f32_32x32x16_bf16 v[240:255], v[52:55], a[68:71], v[240:255]
    v_mfma_f32_32x32x16_bf16 v[208:223], v[56:59], a[72:75], v[208:223]
    v_mfma_f32_32x32x16_bf16 v[224:239], v[56:59], a[76:79], v[224:239]
    v_mfma_f32_32x32x16_bf16 v[240:255], v[56:59], a[80:83], v[240:255]
    v_mfma_f32_32x32x16_bf16 v[208:223], v[60:63], a[84:87], v[208:223]
    v_mfma_f32_32x32x16_bf16 v[224:239], v[60:63], a[88:91], v[224:239]
    v_mfma_f32_32x32x16_bf16 v[240:255], v[60:63], a[92:95], v[240:255]
    s_add_u32 m0, s28, 0
    s_add_u32 s29, s94, 0
    buffer_load_dwordx4 v6, s[16:19], s29 offen offset:0 nt lds
    buffer_load_dwordx4 v6, s[16:19], s29 offen offset:1024 nt lds
    buffer_load_dwordx4 v6, s[16:19], s29 offen offset:2048 nt lds
    buffer_load_dwordx4 v6, s[16:19], s29 offen offset:3072 nt lds
    s_add_u32 m0, s28, 4096
    s_add_u32 s29, s94, 4096
    buffer_load_dwordx4 v6, s[16:19], s29 offen offset:0 nt lds
    buffer_load_dwordx4 v6, s[16:19], s29 offen offset:1024 nt lds
    buffer_load_dwordx4 v6, s[16:19], s29 offen offset:2048 nt lds
    buffer_load_dwordx4 v6, s[16:19], s29 offen offset:3072 nt lds
    s_add_u32 m0, s28, 8192
    s_add_u32 s29, s95, 0
    buffer_load_dwordx4 v6, s[16:19], s29 offen offset:0 nt lds
    buffer_load_dwordx4 v6, s[16:19], s29 offen offset:1024 nt lds
    buffer_load_dwordx4 v6, s[16:19], s29 offen offset:2048 nt lds
    buffer_load_dwordx4 v6, s[16:19], s29 offen offset:3072 nt lds
    s_add_u32 m0, s28, 12288
    s_add_u32 s29, s95, 4096
    buffer_load_dwordx4 v6, s[16:19], s29 offen offset:0 nt lds
    buffer_load_dwordx4 v6, s[16:19], s29 offen offset:1024 nt lds
    buffer_load_dwordx4 v6, s[16:19], s29 offen offset:2048 nt lds
    buffer_load_dwordx4 v6, s[16:19], s29 offen offset:3072 nt lds
    s_add_u32 m0, s28, 16384
    s_add_u32 s29, s96, 0
    buffer_load_dwordx4 v6, s[16:19], s29 offen offset:0 nt lds
    buffer_load_dwordx4 v6, s[16:19], s29 offen offset:1024 nt lds
    buffer_load_dwordx4 v6, s[16:19], s29 offen offset:2048 nt lds
    buffer_load_dwordx4 v6, s[16:19], s29 offen offset:3072 nt lds
    s_add_u32 m0, s28, 20480
    s_add_u32 s29, s96, 4096
    buffer_load_dwordx4 v6, s[16:19], s29 offen offset:0 nt lds
    buffer_load_dwordx4 v6, s[16:19], s29 offen offset:1024 nt lds
    buffer_load_dwordx4 v6, s[16:19], s29 offen offset:2048 nt lds
    buffer_load_dwordx4 v6, s[16:19], s29 offen offset:3072 nt lds
    s_add_u32 m0, s28, 24576
    s_add_u32 s29, s97, 0
    buffer_load_dwordx4 v6, s[16:19], s29 offen offset:0 nt lds
    buffer_load_dwordx4 v6, s[16:19], s29 offen offset:1024 nt lds
    buffer_load_dwordx4 v6, s[16:19], s29 offen offset:2048 nt lds
    buffer_load_dwordx4 v6, s[16:19], s29 offen offset:3072 nt lds
    s_add_u32 m0, s28, 28672
    s_add_u32 s29, s97, 4096
    buffer_load_dwordx4 v6, s[16:19], s29 offen offset:0 nt lds
    buffer_load_dwordx4 v6, s[16:19], s29 offen offset:1024 nt lds
    buffer_load_dwordx4 v6, s[16:19], s29 offen offset:2048 nt lds
    buffer_load_dwordx4 v6, s[16:19], s29 offen offset:3072 nt lds
    v_mov_b32 v29, v64
    v_max3_f32 v29, v29, v64, v65
    v_max3_f32 v29, v29, v66, v67
    v_max3_f32 v29, v29, v68, v69
    v_max3_f32 v29, v29, v70, v71
    v_max3_f32 v29, v29, v72, v73
    v_max3_f32 v29, v29, v74, v75
    v_max3_f32 v29, v29, v76, v77
    v_max3_f32 v29, v29, v78, v79
    v_max3_f32 v29, v29, v112, v113
    v_max3_f32 v29, v29, v114, v115
    v_max3_f32 v29, v29, v116, v117
    v_max3_f32 v29, v29, v118, v119
    v_max3_f32 v29, v29, v120, v121
    v_max3_f32 v29, v29, v122, v123
    v_max3_f32 v29, v29, v124, v125
    v_max3_f32 v29, v29, v126, v127
    v_max3_f32 v29, v29, v160, v161
    v_max3_f32 v29, v29, v162, v163
    v_max3_f32 v29, v29, v164, v165
    v_max3_f32 v29, v29, v166, v167
    v_max3_f32 v29, v29, v168, v169
    v_max3_f32 v29, v29, v170, v171
    v_max3_f32 v29, v29, v172, v173
    v_max3_f32 v29, v29, v174, v175
    v_max3_f32 v29, v29, v208, v209
    v_max3_f32 v29, v29, v210, v211
    v_max3_f32 v29, v29, v212, v213
    v_max3_f32 v29, v29, v214, v215
    v_max3_f32 v29, v29, v216, v217
    v_max3_f32 v29, v29, v218, v219
    v_max3_f32 v29, v29, v220, v221
    v_max3_f32 v29, v29, v222, v223
    v_mov_b32 v30, v80
    v_max3_f32 v30, v30, v80, v81
    v_max3_f32 v30, v30, v82, v83
    v_max3_f32 v30, v30, v84, v85
    v_max3_f32 v30, v30, v86, v87
    v_max3_f32 v30, v30, v88, v89
    v_max3_f32 v30, v30, v90, v91
    v_max3_f32 v30, v30, v92, v93
    v_max3_f32 v30, v30, v94, v95
    v_max3_f32 v30, v30, v128, v129
    v_max3_f32 v30, v30, v130, v131
    v_max3_f32 v30, v30, v132, v133
    v_max3_f32 v30, v30, v134, v135
    v_max3_f32 v30, v30, v136, v137
    v_max3_f32 v30, v30, v138, v139
    v_max3_f32 v30, v30, v140, v141
    v_max3_f32 v30, v30, v142, v143
    v_max3_f32 v30, v30, v176, v177
    v_max3_f32 v30, v30, v178, v179
    v_max3_f32 v30, v30, v180, v181
    v_max3_f32 v30, v30, v182, v183
    v_max3_f32 v30, v30, v184, v185
    v_max3_f32 v30, v30, v186, v187
    v_max3_f32 v30, v30, v188, v189
    v_max3_f32 v30, v30, v190, v191
    v_max3_f32 v30, v30, v224, v225
    v_max3_f32 v30, v30, v226, v227
    v_max3_f32 v30, v30, v228, v229
    v_max3_f32 v30, v30, v230, v231
    v_max3_f32 v30, v30, v232, v233
    v_max3_f32 v30, v30, v234, v235
    v_max3_f32 v30, v30, v236, v237
    v_max3_f32 v30, v30, v238, v239
    v_mov_b32 v31, v96
    v_max3_f32 v31, v31, v96, v97
    v_max3_f32 v31, v31, v98, v99
    v_max3_f32 v31, v31, v100, v101
    v_max3_f32 v31, v31, v102, v103
    v_max3_f32 v31, v31, v104, v105
    v_max3_f32 v31, v31, v106, v107
    v_max3_f32 v31, v31, v108, v109
    v_max3_f32 v31, v31, v110, v111
    v_max3_f32 v31, v31, v144, v145
    v_max3_f32 v31, v31, v146, v147
    v_max3_f32 v31, v31, v148, v149
    v_max3_f32 v31, v31, v150, v151
    v_max3_f32 v31, v31, v152, v153
    v_max3_f32 v31, v31, v154, v155
    v_max3_f32 v31, v31, v156, v157
    v_max3_f32 v31, v31, v158, v159
    v_max3_f32 v31, v31, v192, v193
    v_max3_f32 v31, v31, v194, v195
    v_max3_f32 v31, v31, v196, v197
    v_max3_f32 v31, v31, v198, v199
    v_max3_f32 v31, v31, v200, v201
    v_max3_f32 v31, v31, v202, v203
    v_max3_f32 v31, v31, v204, v205
    v_max3_f32 v31, v31, v206, v207
    v_max3_f32 v31, v31, v240, v241
    v_max3_f32 v31, v31, v242, v243
    v_max3_f32 v31, v31, v244, v245
    v_max3_f32 v31, v31, v246, v247
    v_max3_f32 v31, v31, v248, v249
    v_max3_f32 v31, v31, v250, v251
    v_max3_f32 v31, v31, v252, v253
    v_max3_f32 v31, v31, v254, v255
    v_mov_b32 v32, v29
    v_mov_b32 v33, v30
    v_mov_b32 v34, v31
    v_permlane32_swap_b32 v29, v32
    v_permlane32_swap_b32 v30, v33
    v_permlane32_swap_b32 v31, v34
    v_max_f32 v29, v29, v32
    v_max_f32 v30, v30, v33
    v_max_f32 v31, v31, v34
    ds_write_b32 v26, v29 offset:0
    ds_write_b32 v26, v30 offset:512
    ds_write_b32 v26, v31 offset:1024
    s_waitcnt lgkmcnt(0)
    s_barrier
    ds_read_b128 v[36:39], v27 offset:0
    ds_read_b128 v[40:43], v27 offset:512
    ds_read_b128 v[44:47], v27 offset:1024
    s_waitcnt lgkmcnt(0)
    v_max3_f32 v36, v36, v37, v38
    v_max_f32 v20, v36, v39
    v_mov_b32 v60, 0
    v_max3_f32 v40, v40, v41, v42
    v_max_f32 v21, v40, v43
    v_mov_b32 v61, 0
    v_max3_f32 v44, v44, v45, v46
    v_max_f32 v1, v44, v47
    v_mov_b32 v62, 0
    v_sub_f32 v64, v64, v20
    v_sub_f32 v65, v65, v20
    v_sub_f32 v66, v66, v20
    v_sub_f32 v67, v67, v20
    v_sub_f32 v68, v68, v20
    v_sub_f32 v69, v69, v20
    v_sub_f32 v70, v70, v20
    v_sub_f32 v71, v71, v20
    v_sub_f32 v72, v72, v20
    v_sub_f32 v73, v73, v20
    v_sub_f32 v74, v74, v20
    v_sub_f32 v75, v75, v20
    v_sub_f32 v76, v76, v20
    v_sub_f32 v77, v77, v20
    v_sub_f32 v78, v78, v20
    v_sub_f32 v79, v79, v20
    v_exp_f32 v64, v64
    v_exp_f32 v65, v65
    v_exp_f32 v66, v66
    v_exp_f32 v67, v67
    v_exp_f32 v68, v68
    v_exp_f32 v69, v69
    v_exp_f32 v70, v70
    v_exp_f32 v71, v71
    v_exp_f32 v72, v72
    v_exp_f32 v73, v73
    v_exp_f32 v74, v74
    v_exp_f32 v75, v75
    v_exp_f32 v76, v76
    v_exp_f32 v77, v77
    v_exp_f32 v78, v78
    v_exp_f32 v79, v79
    v_add_f32 v60, v60, v64
    v_add_f32 v60, v60, v65
    v_cvt_pk_bf16_f32 v64, v64, v65
    v_add_f32 v60, v60, v66
    v_add_f32 v60, v60, v67
    v_cvt_pk_bf16_f32 v65, v66, v67
    v_add_f32 v60, v60, v68
    v_add_f32 v60, v60, v69
    v_cvt_pk_bf16_f32 v66, v68, v69
    v_add_f32 v60, v60, v70
    v_add_f32 v60, v60, v71
    v_cvt_pk_bf16_f32 v67, v70, v71
    v_add_f32 v60, v60, v72
    v_add_f32 v60, v60, v73
    v_cvt_pk_bf16_f32 v68, v72, v73
    v_add_f32 v60, v60, v74
    v_add_f32 v60, v60, v75
    v_cvt_pk_bf16_f32 v69, v74, v75
    v_add_f32 v60, v60, v76
    v_add_f32 v60, v60, v77
    v_cvt_pk_bf16_f32 v70, v76, v77
    v_add_f32 v60, v60, v78
    v_add_f32 v60, v60, v79
    v_cvt_pk_bf16_f32 v71, v78, v79
    v_sub_f32 v80, v80, v21
    v_sub_f32 v81, v81, v21
    v_sub_f32 v82, v82, v21
    v_sub_f32 v83, v83, v21
    v_sub_f32 v84, v84, v21
    v_sub_f32 v85, v85, v21
    v_sub_f32 v86, v86, v21
    v_sub_f32 v87, v87, v21
    v_sub_f32 v88, v88, v21
    v_sub_f32 v89, v89, v21
    v_sub_f32 v90, v90, v21
    v_sub_f32 v91, v91, v21
    v_sub_f32 v92, v92, v21
    v_sub_f32 v93, v93, v21
    v_sub_f32 v94, v94, v21
    v_sub_f32 v95, v95, v21
    v_exp_f32 v80, v80
    v_exp_f32 v81, v81
    v_exp_f32 v82, v82
    v_exp_f32 v83, v83
    v_exp_f32 v84, v84
    v_exp_f32 v85, v85
    v_exp_f32 v86, v86
    v_exp_f32 v87, v87
    v_exp_f32 v88, v88
    v_exp_f32 v89, v89
    v_exp_f32 v90, v90
    v_exp_f32 v91, v91
    v_exp_f32 v92, v92
    v_exp_f32 v93, v93
    v_exp_f32 v94, v94
    v_exp_f32 v95, v95
    v_add_f32 v61, v61, v80
    v_add_f32 v61, v61, v81
    v_cvt_pk_bf16_f32 v80, v80, v81
    v_add_f32 v61, v61, v82
    v_add_f32 v61, v61, v83
    v_cvt_pk_bf16_f32 v81, v82, v83
    v_add_f32 v61, v61, v84
    v_add_f32 v61, v61, v85
    v_cvt_pk_bf16_f32 v82, v84, v85
    v_add_f32 v61, v61, v86
    v_add_f32 v61, v61, v87
    v_cvt_pk_bf16_f32 v83, v86, v87
    v_add_f32 v61, v61, v88
    v_add_f32 v61, v61, v89
    v_cvt_pk_bf16_f32 v84, v88, v89
    v_add_f32 v61, v61, v90
    v_add_f32 v61, v61, v91
    v_cvt_pk_bf16_f32 v85, v90, v91
    v_add_f32 v61, v61, v92
    v_add_f32 v61, v61, v93
    v_cvt_pk_bf16_f32 v86, v92, v93
    v_add_f32 v61, v61, v94
    v_add_f32 v61, v61, v95
    v_cvt_pk_bf16_f32 v87, v94, v95
    v_sub_f32 v96, v96, v1
    v_sub_f32 v97, v97, v1
    v_sub_f32 v98, v98, v1
    v_sub_f32 v99, v99, v1
    v_sub_f32 v100, v100, v1
    v_sub_f32 v101, v101, v1
    v_sub_f32 v102, v102, v1
    v_sub_f32 v103, v103, v1
    v_sub_f32 v104, v104, v1
    v_sub_f32 v105, v105, v1
    v_sub_f32 v106, v106, v1
    v_sub_f32 v107, v107, v1
    v_sub_f32 v108, v108, v1
    v_sub_f32 v109, v109, v1
    v_sub_f32 v110, v110, v1
    v_sub_f32 v111, v111, v1
    v_exp_f32 v96, v96
    v_exp_f32 v97, v97
    v_exp_f32 v98, v98
    v_exp_f32 v99, v99
    v_exp_f32 v100, v100
    v_exp_f32 v101, v101
    v_exp_f32 v102, v102
    v_exp_f32 v103, v103
    v_exp_f32 v104, v104
    v_exp_f32 v105, v105
    v_exp_f32 v106, v106
    v_exp_f32 v107, v107
    v_exp_f32 v108, v108
    v_exp_f32 v109, v109
    v_exp_f32 v110, v110
    v_exp_f32 v111, v111
    v_add_f32 v62, v62, v96
    v_add_f32 v62, v62, v97
    v_cvt_pk_bf16_f32 v96, v96, v97
    v_add_f32 v62, v62, v98
    v_add_f32 v62, v62, v99
    v_cvt_pk_bf16_f32 v97, v98, v99
    v_add_f32 v62, v62, v100
    v_add_f32 v62, v62, v101
    v_cvt_pk_bf16_f32 v98, v100, v101
    v_add_f32 v62, v62, v102
    v_add_f32 v62, v62, v103
    v_cvt_pk_bf16_f32 v99, v102, v103
    v_add_f32 v62, v62, v104
    v_add_f32 v62, v62, v105
    v_cvt_pk_bf16_f32 v100, v104, v105
    v_add_f32 v62, v62, v106
    v_add_f32 v62, v62, v107
    v_cvt_pk_bf16_f32 v101, v106, v107
    v_add_f32 v62, v62, v108
    v_add_f32 v62, v62, v109
    v_cvt_pk_bf16_f32 v102, v108, v109
    v_add_f32 v62, v62, v110
    v_add_f32 v62, v62, v111
    v_cvt_pk_bf16_f32 v103, v110, v111
    v_sub_f32 v112, v112, v20
    v_sub_f32 v113, v113, v20
    v_sub_f32 v114, v114, v20
    v_sub_f32 v115, v115, v20
    v_sub_f32 v116, v116, v20
    v_sub_f32 v117, v117, v20
    v_sub_f32 v118, v118, v20
    v_sub_f32 v119, v119, v20
    v_sub_f32 v120, v120, v20
    v_sub_f32 v121, v121, v20
    v_sub_f32 v122, v122, v20
    v_sub_f32 v123, v123, v20
    v_sub_f32 v124, v124, v20
    v_sub_f32 v125, v125, v20
    v_sub_f32 v126, v126, v20
    v_sub_f32 v127, v127, v20
    v_exp_f32 v112, v112
    v_exp_f32 v113, v113
    v_exp_f32 v114, v114
    v_exp_f32 v115, v115
    v_exp_f32 v116, v116
    v_exp_f32 v117, v117
    v_exp_f32 v118, v118
    v_exp_f32 v119, v119
    v_exp_f32 v120, v120
    v_exp_f32 v121, v121
    v_exp_f32 v122, v122
    v_exp_f32 v123, v123
    v_exp_f32 v124, v124
    v_exp_f32 v125, v125
    v_exp_f32 v126, v126
    v_exp_f32 v127, v127
    v_add_f32 v60, v60, v112
    v_add_f32 v60, v60, v113
    v_cvt_pk_bf16_f32 v112, v112, v113
    v_add_f32 v60, v60, v114
    v_add_f32 v60, v60, v115
    v_cvt_pk_bf16_f32 v113, v114, v115
    v_add_f32 v60, v60, v116
    v_add_f32 v60, v60, v117
    v_cvt_pk_bf16_f32 v114, v116, v117
    v_add_f32 v60, v60, v118
    v_add_f32 v60, v60, v119
    v_cvt_pk_bf16_f32 v115, v118, v119
    v_add_f32 v60, v60, v120
    v_add_f32 v60, v60, v121
    v_cvt_pk_bf16_f32 v116, v120, v121
    v_add_f32 v60, v60, v122
    v_add_f32 v60, v60, v123
    v_cvt_pk_bf16_f32 v117, v122, v123
    v_add_f32 v60, v60, v124
    v_add_f32 v60, v60, v125
    v_cvt_pk_bf16_f32 v118, v124, v125
    v_add_f32 v60, v60, v126
    v_add_f32 v60, v60, v127
    v_cvt_pk_bf16_f32 v119, v126, v127
    v_sub_f32 v128, v128, v21
    v_sub_f32 v129, v129, v21
    v_sub_f32 v130, v130, v21
    v_sub_f32 v131, v131, v21
    v_sub_f32 v132, v132, v21
    v_sub_f32 v133, v133, v21
    v_sub_f32 v134, v134, v21
    v_sub_f32 v135, v135, v21
    v_sub_f32 v136, v136, v21
    v_sub_f32 v137, v137, v21
    v_sub_f32 v138, v138, v21
    v_sub_f32 v139, v139, v21
    v_sub_f32 v140, v140, v21
    v_sub_f32 v141, v141, v21
    v_sub_f32 v142, v142, v21
    v_sub_f32 v143, v143, v21
    v_exp_f32 v128, v128
    v_exp_f32 v129, v129
    v_exp_f32 v130, v130
    v_exp_f32 v131, v131
    v_exp_f32 v132, v132
    v_exp_f32 v133, v133
    v_exp_f32 v134, v134
    v_exp_f32 v135, v135
    v_exp_f32 v136, v136
    v_exp_f32 v137, v137
    v_exp_f32 v138, v138
    v_exp_f32 v139, v139
    v_exp_f32 v140, v140
    v_exp_f32 v141, v141
    v_exp_f32 v142, v142
    v_exp_f32 v143, v143
    v_add_f32 v61, v61, v128
    v_add_f32 v61, v61, v129
    v_cvt_pk_bf16_f32 v128, v128, v129
    v_add_f32 v61, v61, v130
    v_add_f32 v61, v61, v131
    v_cvt_pk_bf16_f32 v129, v130, v131
    v_add_f32 v61, v61, v132
    v_add_f32 v61, v61, v133
    v_cvt_pk_bf16_f32 v130, v132, v133
    v_add_f32 v61, v61, v134
    v_add_f32 v61, v61, v135
    v_cvt_pk_bf16_f32 v131, v134, v135
    v_add_f32 v61, v61, v136
    v_add_f32 v61, v61, v137
    v_cvt_pk_bf16_f32 v132, v136, v137
    v_add_f32 v61, v61, v138
    v_add_f32 v61, v61, v139
    v_cvt_pk_bf16_f32 v133, v138, v139
    v_add_f32 v61, v61, v140
    v_add_f32 v61, v61, v141
    v_cvt_pk_bf16_f32 v134, v140, v141
    v_add_f32 v61, v61, v142
    v_add_f32 v61, v61, v143
    v_cvt_pk_bf16_f32 v135, v142, v143
    v_sub_f32 v144, v144, v1
    v_sub_f32 v145, v145, v1
    v_sub_f32 v146, v146, v1
    v_sub_f32 v147, v147, v1
    v_sub_f32 v148, v148, v1
    v_sub_f32 v149, v149, v1
    v_sub_f32 v150, v150, v1
    v_sub_f32 v151, v151, v1
    v_sub_f32 v152, v152, v1
    v_sub_f32 v153, v153, v1
    v_sub_f32 v154, v154, v1
    v_sub_f32 v155, v155, v1
    v_sub_f32 v156, v156, v1
    v_sub_f32 v157, v157, v1
    v_sub_f32 v158, v158, v1
    v_sub_f32 v159, v159, v1
    v_exp_f32 v144, v144
    v_exp_f32 v145, v145
    v_exp_f32 v146, v146
    v_exp_f32 v147, v147
    v_exp_f32 v148, v148
    v_exp_f32 v149, v149
    v_exp_f32 v150, v150
    v_exp_f32 v151, v151
    v_exp_f32 v152, v152
    v_exp_f32 v153, v153
    v_exp_f32 v154, v154
    v_exp_f32 v155, v155
    v_exp_f32 v156, v156
    v_exp_f32 v157, v157
    v_exp_f32 v158, v158
    v_exp_f32 v159, v159
    v_add_f32 v62, v62, v144
    v_add_f32 v62, v62, v145
    v_cvt_pk_bf16_f32 v144, v144, v145
    v_add_f32 v62, v62, v146
    v_add_f32 v62, v62, v147
    v_cvt_pk_bf16_f32 v145, v146, v147
    v_add_f32 v62, v62, v148
    v_add_f32 v62, v62, v149
    v_cvt_pk_bf16_f32 v146, v148, v149
    v_add_f32 v62, v62, v150
    v_add_f32 v62, v62, v151
    v_cvt_pk_bf16_f32 v147, v150, v151
    v_add_f32 v62, v62, v152
    v_add_f32 v62, v62, v153
    v_cvt_pk_bf16_f32 v148, v152, v153
    v_add_f32 v62, v62, v154
    v_add_f32 v62, v62, v155
    v_cvt_pk_bf16_f32 v149, v154, v155
    v_add_f32 v62, v62, v156
    v_add_f32 v62, v62, v157
    v_cvt_pk_bf16_f32 v150, v156, v157
    v_add_f32 v62, v62, v158
    v_add_f32 v62, v62, v159
    v_cvt_pk_bf16_f32 v151, v158, v159
    v_sub_f32 v160, v160, v20
    v_sub_f32 v161, v161, v20
    v_sub_f32 v162, v162, v20
    v_sub_f32 v163, v163, v20
    v_sub_f32 v164, v164, v20
    v_sub_f32 v165, v165, v20
    v_sub_f32 v166, v166, v20
    v_sub_f32 v167, v167, v20
    v_sub_f32 v168, v168, v20
    v_sub_f32 v169, v169, v20
    v_sub_f32 v170, v170, v20
    v_sub_f32 v171, v171, v20
    v_sub_f32 v172, v172, v20
    v_sub_f32 v173, v173, v20
    v_sub_f32 v174, v174, v20
    v_sub_f32 v175, v175, v20
    v_exp_f32 v160, v160
    v_exp_f32 v161, v161
    v_exp_f32 v162, v162
    v_exp_f32 v163, v163
    v_exp_f32 v164, v164
    v_exp_f32 v165, v165
    v_exp_f32 v166, v166
    v_exp_f32 v167, v167
    v_exp_f32 v168, v168
    v_exp_f32 v169, v169
    v_exp_f32 v170, v170
    v_exp_f32 v171, v171
    v_exp_f32 v172, v172
    v_exp_f32 v173, v173
    v_exp_f32 v174, v174
    v_exp_f32 v175, v175
    v_add_f32 v60, v60, v160
    v_add_f32 v60, v60, v161
    v_cvt_pk_bf16_f32 v160, v160, v161
    v_add_f32 v60, v60, v162
    v_add_f32 v60, v60, v163
    v_cvt_pk_bf16_f32 v161, v162, v163
    v_add_f32 v60, v60, v164
    v_add_f32 v60, v60, v165
    v_cvt_pk_bf16_f32 v162, v164, v165
    v_add_f32 v60, v60, v166
    v_add_f32 v60, v60, v167
    v_cvt_pk_bf16_f32 v163, v166, v167
    v_add_f32 v60, v60, v168
    v_add_f32 v60, v60, v169
    v_cvt_pk_bf16_f32 v164, v168, v169
    v_add_f32 v60, v60, v170
    v_add_f32 v60, v60, v171
    v_cvt_pk_bf16_f32 v165, v170, v171
    v_add_f32 v60, v60, v172
    v_add_f32 v60, v60, v173
    v_cvt_pk_bf16_f32 v166, v172, v173
    v_add_f32 v60, v60, v174
    v_add_f32 v60, v60, v175
    v_cvt_pk_bf16_f32 v167, v174, v175
    v_sub_f32 v176, v176, v21
    v_sub_f32 v177, v177, v21
    v_sub_f32 v178, v178, v21
    v_sub_f32 v179, v179, v21
    v_sub_f32 v180, v180, v21
    v_sub_f32 v181, v181, v21
    v_sub_f32 v182, v182, v21
    v_sub_f32 v183, v183, v21
    v_sub_f32 v184, v184, v21
    v_sub_f32 v185, v185, v21
    v_sub_f32 v186, v186, v21
    v_sub_f32 v187, v187, v21
    v_sub_f32 v188, v188, v21
    v_sub_f32 v189, v189, v21
    v_sub_f32 v190, v190, v21
    v_sub_f32 v191, v191, v21
    v_exp_f32 v176, v176
    v_exp_f32 v177, v177
    v_exp_f32 v178, v178
    v_exp_f32 v179, v179
    v_exp_f32 v180, v180
    v_exp_f32 v181, v181
    v_exp_f32 v182, v182
    v_exp_f32 v183, v183
    v_exp_f32 v184, v184
    v_exp_f32 v185, v185
    v_exp_f32 v186, v186
    v_exp_f32 v187, v187
    v_exp_f32 v188, v188
    v_exp_f32 v189, v189
    v_exp_f32 v190, v190
    v_exp_f32 v191, v191
    v_add_f32 v61, v61, v176
    v_add_f32 v61, v61, v177
    v_cvt_pk_bf16_f32 v176, v176, v177
    v_add_f32 v61, v61, v178
    v_add_f32 v61, v61, v179
    v_cvt_pk_bf16_f32 v177, v178, v179
    v_add_f32 v61, v61, v180
    v_add_f32 v61, v61, v181
    v_cvt_pk_bf16_f32 v178, v180, v181
    v_add_f32 v61, v61, v182
    v_add_f32 v61, v61, v183
    v_cvt_pk_bf16_f32 v179, v182, v183
    v_add_f32 v61, v61, v184
    v_add_f32 v61, v61, v185
    v_cvt_pk_bf16_f32 v180, v184, v185
    v_add_f32 v61, v61, v186
    v_add_f32 v61, v61, v187
    v_cvt_pk_bf16_f32 v181, v186, v187
    v_add_f32 v61, v61, v188
    v_add_f32 v61, v61, v189
    v_cvt_pk_bf16_f32 v182, v188, v189
    v_add_f32 v61, v61, v190
    v_add_f32 v61, v61, v191
    v_cvt_pk_bf16_f32 v183, v190, v191
    v_sub_f32 v192, v192, v1
    v_sub_f32 v193, v193, v1
    v_sub_f32 v194, v194, v1
    v_sub_f32 v195, v195, v1
    v_sub_f32 v196, v196, v1
    v_sub_f32 v197, v197, v1
    v_sub_f32 v198, v198, v1
    v_sub_f32 v199, v199, v1
    v_sub_f32 v200, v200, v1
    v_sub_f32 v201, v201, v1
    v_sub_f32 v202, v202, v1
    v_sub_f32 v203, v203, v1
    v_sub_f32 v204, v204, v1
    v_sub_f32 v205, v205, v1
    v_sub_f32 v206, v206, v1
    v_sub_f32 v207, v207, v1
    v_exp_f32 v192, v192
    v_exp_f32 v193, v193
    v_exp_f32 v194, v194
    v_exp_f32 v195, v195
    v_exp_f32 v196, v196
    v_exp_f32 v197, v197
    v_exp_f32 v198, v198
    v_exp_f32 v199, v199
    v_exp_f32 v200, v200
    v_exp_f32 v201, v201
    v_exp_f32 v202, v202
    v_exp_f32 v203, v203
    v_exp_f32 v204, v204
    v_exp_f32 v205, v205
    v_exp_f32 v206, v206
    v_exp_f32 v207, v207
    v_add_f32 v62, v62, v192
    v_add_f32 v62, v62, v193
    v_cvt_pk_bf16_f32 v192, v192, v193
    v_add_f32 v62, v62, v194
    v_add_f32 v62, v62, v195
    v_cvt_pk_bf16_f32 v193, v194, v195
    v_add_f32 v62, v62, v196
    v_add_f32 v62, v62, v197
    v_cvt_pk_bf16_f32 v194, v196, v197
    v_add_f32 v62, v62, v198
    v_add_f32 v62, v62, v199
    v_cvt_pk_bf16_f32 v195, v198, v199
    v_add_f32 v62, v62, v200
    v_add_f32 v62, v62, v201
    v_cvt_pk_bf16_f32 v196, v200, v201
    v_add_f32 v62, v62, v202
    v_add_f32 v62, v62, v203
    v_cvt_pk_bf16_f32 v197, v202, v203
    v_add_f32 v62, v62, v204
    v_add_f32 v62, v62, v205
    v_cvt_pk_bf16_f32 v198, v204, v205
    v_add_f32 v62, v62, v206
    v_add_f32 v62, v62, v207
    v_cvt_pk_bf16_f32 v199, v206, v207
    v_sub_f32 v208, v208, v20
    v_sub_f32 v209, v209, v20
    v_sub_f32 v210, v210, v20
    v_sub_f32 v211, v211, v20
    v_sub_f32 v212, v212, v20
    v_sub_f32 v213, v213, v20
    v_sub_f32 v214, v214, v20
    v_sub_f32 v215, v215, v20
    v_sub_f32 v216, v216, v20
    v_sub_f32 v217, v217, v20
    v_sub_f32 v218, v218, v20
    v_sub_f32 v219, v219, v20
    v_sub_f32 v220, v220, v20
    v_sub_f32 v221, v221, v20
    v_sub_f32 v222, v222, v20
    v_sub_f32 v223, v223, v20
    v_exp_f32 v208, v208
    v_exp_f32 v209, v209
    v_exp_f32 v210, v210
    v_exp_f32 v211, v211
    v_exp_f32 v212, v212
    v_exp_f32 v213, v213
    v_exp_f32 v214, v214
    v_exp_f32 v215, v215
    v_exp_f32 v216, v216
    v_exp_f32 v217, v217
    v_exp_f32 v218, v218
    v_exp_f32 v219, v219
    v_exp_f32 v220, v220
    v_exp_f32 v221, v221
    v_exp_f32 v222, v222
    v_exp_f32 v223, v223
    v_add_f32 v60, v60, v208
    v_add_f32 v60, v60, v209
    v_cvt_pk_bf16_f32 v208, v208, v209
    v_add_f32 v60, v60, v210
    v_add_f32 v60, v60, v211
    v_cvt_pk_bf16_f32 v209, v210, v211
    v_add_f32 v60, v60, v212
    v_add_f32 v60, v60, v213
    v_cvt_pk_bf16_f32 v210, v212, v213
    v_add_f32 v60, v60, v214
    v_add_f32 v60, v60, v215
    v_cvt_pk_bf16_f32 v211, v214, v215
    v_add_f32 v60, v60, v216
    v_add_f32 v60, v60, v217
    v_cvt_pk_bf16_f32 v212, v216, v217
    v_add_f32 v60, v60, v218
    v_add_f32 v60, v60, v219
    v_cvt_pk_bf16_f32 v213, v218, v219
    v_add_f32 v60, v60, v220
    v_add_f32 v60, v60, v221
    v_cvt_pk_bf16_f32 v214, v220, v221
    v_add_f32 v60, v60, v222
    v_add_f32 v60, v60, v223
    v_cvt_pk_bf16_f32 v215, v222, v223
    v_sub_f32 v224, v224, v21
    v_sub_f32 v225, v225, v21
    v_sub_f32 v226, v226, v21
    v_sub_f32 v227, v227, v21
    v_sub_f32 v228, v228, v21
    v_sub_f32 v229, v229, v21
    v_sub_f32 v230, v230, v21
    v_sub_f32 v231, v231, v21
    v_sub_f32 v232, v232, v21
    v_sub_f32 v233, v233, v21
    v_sub_f32 v234, v234, v21
    v_sub_f32 v235, v235, v21
    v_sub_f32 v236, v236, v21
    v_sub_f32 v237, v237, v21
    v_sub_f32 v238, v238, v21
    v_sub_f32 v239, v239, v21
    v_exp_f32 v224, v224
    v_exp_f32 v225, v225
    v_exp_f32 v226, v226
    v_exp_f32 v227, v227
    v_exp_f32 v228, v228
    v_exp_f32 v229, v229
    v_exp_f32 v230, v230
    v_exp_f32 v231, v231
    v_exp_f32 v232, v232
    v_exp_f32 v233, v233
    v_exp_f32 v234, v234
    v_exp_f32 v235, v235
    v_exp_f32 v236, v236
    v_exp_f32 v237, v237
    v_exp_f32 v238, v238
    v_exp_f32 v239, v239
    v_add_f32 v61, v61, v224
    v_add_f32 v61, v61, v225
    v_cvt_pk_bf16_f32 v224, v224, v225
    v_add_f32 v61, v61, v226
    v_add_f32 v61, v61, v227
    v_cvt_pk_bf16_f32 v225, v226, v227
    v_add_f32 v61, v61, v228
    v_add_f32 v61, v61, v229
    v_cvt_pk_bf16_f32 v226, v228, v229
    v_add_f32 v61, v61, v230
    v_add_f32 v61, v61, v231
    v_cvt_pk_bf16_f32 v227, v230, v231
    v_add_f32 v61, v61, v232
    v_add_f32 v61, v61, v233
    v_cvt_pk_bf16_f32 v228, v232, v233
    v_add_f32 v61, v61, v234
    v_add_f32 v61, v61, v235
    v_cvt_pk_bf16_f32 v229, v234, v235
    v_add_f32 v61, v61, v236
    v_add_f32 v61, v61, v237
    v_cvt_pk_bf16_f32 v230, v236, v237
    v_add_f32 v61, v61, v238
    v_add_f32 v61, v61, v239
    v_cvt_pk_bf16_f32 v231, v238, v239
    v_sub_f32 v240, v240, v1
    v_sub_f32 v241, v241, v1
    v_sub_f32 v242, v242, v1
    v_sub_f32 v243, v243, v1
    v_sub_f32 v244, v244, v1
    v_sub_f32 v245, v245, v1
    v_sub_f32 v246, v246, v1
    v_sub_f32 v247, v247, v1
    v_sub_f32 v248, v248, v1
    v_sub_f32 v249, v249, v1
    v_sub_f32 v250, v250, v1
    v_sub_f32 v251, v251, v1
    v_sub_f32 v252, v252, v1
    v_sub_f32 v253, v253, v1
    v_sub_f32 v254, v254, v1
    v_sub_f32 v255, v255, v1
    v_exp_f32 v240, v240
    v_exp_f32 v241, v241
    v_exp_f32 v242, v242
    v_exp_f32 v243, v243
    v_exp_f32 v244, v244
    v_exp_f32 v245, v245
    v_exp_f32 v246, v246
    v_exp_f32 v247, v247
    v_exp_f32 v248, v248
    v_exp_f32 v249, v249
    v_exp_f32 v250, v250
    v_exp_f32 v251, v251
    v_exp_f32 v252, v252
    v_exp_f32 v253, v253
    v_exp_f32 v254, v254
    v_exp_f32 v255, v255
    v_add_f32 v62, v62, v240
    v_add_f32 v62, v62, v241
    v_cvt_pk_bf16_f32 v240, v240, v241
    v_add_f32 v62, v62, v242
    v_add_f32 v62, v62, v243
    v_cvt_pk_bf16_f32 v241, v242, v243
    v_add_f32 v62, v62, v244
    v_add_f32 v62, v62, v245
    v_cvt_pk_bf16_f32 v242, v244, v245
    v_add_f32 v62, v62, v246
    v_add_f32 v62, v62, v247
    v_cvt_pk_bf16_f32 v243, v246, v247
    v_add_f32 v62, v62, v248
    v_add_f32 v62, v62, v249
    v_cvt_pk_bf16_f32 v244, v248, v249
    v_add_f32 v62, v62, v250
    v_add_f32 v62, v62, v251
    v_cvt_pk_bf16_f32 v245, v250, v251
    v_add_f32 v62, v62, v252
    v_add_f32 v62, v62, v253
    v_cvt_pk_bf16_f32 v246, v252, v253
    v_add_f32 v62, v62, v254
    v_add_f32 v62, v62, v255
    v_cvt_pk_bf16_f32 v247, v254, v255
    v_mov_b32 v32, v60
    v_mov_b32 v33, v61
    v_mov_b32 v34, v62
    v_permlane32_swap_b32 v60, v32
    v_permlane32_swap_b32 v61, v33
    v_permlane32_swap_b32 v62, v34
    v_add_f32 v60, v60, v32
    v_add_f32 v61, v61, v33
    v_add_f32 v62, v62, v34
    ds_write_b32 v26, v60 offset:1536
    ds_write_b32 v26, v61 offset:2048
    ds_write_b32 v26, v62 offset:2560
    s_waitcnt vmcnt(0)
    ds_write_b128 v24, v[64:67] offset:0
    ds_write_b128 v24, v[80:83] offset:1024
    ds_write_b128 v24, v[96:99] offset:2048
    ds_write_b128 v24, v[68:71] offset:12288
    ds_write_b128 v24, v[84:87] offset:13312
    ds_write_b128 v24, v[100:103] offset:14336
    s_waitcnt lgkmcnt(0)
    s_barrier
    ds_read_b64_tr_b16 v[32:33], v22 offset:0
    ds_read_b64_tr_b16 v[34:35], v22 offset:2048
    ds_read_b128 v[36:39], v25 offset:0
    ds_read_b128 v[40:43], v25 offset:1024
    ds_read_b128 v[44:47], v25 offset:2048
    s_waitcnt lgkmcnt(0)
    v_mfma_f32_32x32x16_bf16 a[192:207], v[32:35], v[36:39], 0
    v_mfma_f32_32x32x16_bf16 a[208:223], v[32:35], v[40:43], 0
    v_mfma_f32_32x32x16_bf16 a[224:239], v[32:35], v[44:47], 0
    ds_read_b64_tr_b16 v[32:33], v22 offset:32768
    ds_read_b64_tr_b16 v[34:35], v22 offset:34816
    ds_read_b128 v[36:39], v25 offset:3072
    ds_read_b128 v[40:43], v25 offset:4096
    ds_read_b128 v[44:47], v25 offset:5120
    s_waitcnt lgkmcnt(0)
    v_mfma_f32_32x32x16_bf16 a[192:207], v[32:35], v[36:39], a[192:207]
    v_mfma_f32_32x32x16_bf16 a[208:223], v[32:35], v[40:43], a[208:223]
    v_mfma_f32_32x32x16_bf16 a[224:239], v[32:35], v[44:47], a[224:239]
    ds_read_b64_tr_b16 v[32:33], v23 offset:0
    ds_read_b64_tr_b16 v[34:35], v23 offset:2048
    ds_read_b128 v[36:39], v25 offset:6144
    ds_read_b128 v[40:43], v25 offset:7168
    ds_read_b128 v[44:47], v25 offset:8192
    s_waitcnt lgkmcnt(0)
    v_mfma_f32_32x32x16_bf16 a[192:207], v[32:35], v[36:39], a[192:207]
    v_mfma_f32_32x32x16_bf16 a[208:223], v[32:35], v[40:43], a[208:223]
    v_mfma_f32_32x32x16_bf16 a[224:239], v[32:35], v[44:47], a[224:239]
    ds_read_b64_tr_b16 v[32:33], v23 offset:32768
    ds_read_b64_tr_b16 v[34:35], v23 offset:34816
    ds_read_b128 v[36:39], v25 offset:9216
    ds_read_b128 v[40:43], v25 offset:10240
    ds_read_b128 v[44:47], v25 offset:11264
    s_waitcnt lgkmcnt(0)
    v_mfma_f32_32x32x16_bf16 a[192:207], v[32:35], v[36:39], a[192:207]
    v_mfma_f32_32x32x16_bf16 a[208:223], v[32:35], v[40:43], a[208:223]
    v_mfma_f32_32x32x16_bf16 a[224:239], v[32:35], v[44:47], a[224:239]
    ds_read_b64_tr_b16 v[32:33], v22 offset:4096
    ds_read_b64_tr_b16 v[34:35], v22 offset:6144
    ds_read_b128 v[36:39], v25 offset:12288
    ds_read_b128 v[40:43], v25 offset:13312
    ds_read_b128 v[44:47], v25 offset:14336
    s_waitcnt lgkmcnt(0)
    v_mfma_f32_32x32x16_bf16 a[192:207], v[32:35], v[36:39], a[192:207]
    v_mfma_f32_32x32x16_bf16 a[208:223], v[32:35], v[40:43], a[208:223]
    v_mfma_f32_32x32x16_bf16 a[224:239], v[32:35], v[44:47], a[224:239]
    ds_read_b64_tr_b16 v[32:33], v22 offset:36864
    ds_read_b64_tr_b16 v[34:35], v22 offset:38912
    ds_read_b128 v[36:39], v25 offset:15360
    ds_read_b128 v[40:43], v25 offset:16384
    ds_read_b128 v[44:47], v25 offset:17408
    s_waitcnt lgkmcnt(0)
    v_mfma_f32_32x32x16_bf16 a[192:207], v[32:35], v[36:39], a[192:207]
    v_mfma_f32_32x32x16_bf16 a[208:223], v[32:35], v[40:43], a[208:223]
    v_mfma_f32_32x32x16_bf16 a[224:239], v[32:35], v[44:47], a[224:239]
    ds_read_b64_tr_b16 v[32:33], v23 offset:4096
    ds_read_b64_tr_b16 v[34:35], v23 offset:6144
    ds_read_b128 v[36:39], v25 offset:18432
    ds_read_b128 v[40:43], v25 offset:19456
    ds_read_b128 v[44:47], v25 offset:20480
    s_waitcnt lgkmcnt(0)
    v_mfma_f32_32x32x16_bf16 a[192:207], v[32:35], v[36:39], a[192:207]
    v_mfma_f32_32x32x16_bf16 a[208:223], v[32:35], v[40:43], a[208:223]
    v_mfma_f32_32x32x16_bf16 a[224:239], v[32:35], v[44:47], a[224:239]
    ds_read_b64_tr_b16 v[32:33], v23 offset:36864
    ds_read_b64_tr_b16 v[34:35], v23 offset:38912
    ds_read_b128 v[36:39], v25 offset:21504
    ds_read_b128 v[40:43], v25 offset:22528
    ds_read_b128 v[44:47], v25 offset:23552
    s_waitcnt lgkmcnt(0)
    v_mfma_f32_32x32x16_bf16 a[192:207], v[32:35], v[36:39], a[192:207]
    v_mfma_f32_32x32x16_bf16 a[208:223], v[32:35], v[40:43], a[208:223]
    v_mfma_f32_32x32x16_bf16 a[224:239], v[32:35], v[44:47], a[224:239]
    s_barrier
    ds_write_b128 v24, v[112:115] offset:0
    ds_write_b128 v24, v[128:131] offset:1024
    ds_write_b128 v24, v[144:147] offset:2048
    ds_write_b128 v24, v[116:119] offset:12288
    ds_write_b128 v24, v[132:135] offset:13312
    ds_write_b128 v24, v[148:151] offset:14336
    s_waitcnt lgkmcnt(0)
    s_barrier
    ds_read_b64_tr_b16 v[32:33], v22 offset:8192
    ds_read_b64_tr_b16 v[34:35], v22 offset:10240
    ds_read_b128 v[36:39], v25 offset:0
    ds_read_b128 v[40:43], v25 offset:1024
    ds_read_b128 v[44:47], v25 offset:2048
    s_waitcnt lgkmcnt(0)
    v_mfma_f32_32x32x16_bf16 a[192:207], v[32:35], v[36:39], a[192:207]
    v_mfma_f32_32x32x16_bf16 a[208:223], v[32:35], v[40:43], a[208:223]
    v_mfma_f32_32x32x16_bf16 a[224:239], v[32:35], v[44:47], a[224:239]
    ds_read_b64_tr_b16 v[32:33], v22 offset:40960
    ds_read_b64_tr_b16 v[34:35], v22 offset:43008
    ds_read_b128 v[36:39], v25 offset:3072
    ds_read_b128 v[40:43], v25 offset:4096
    ds_read_b128 v[44:47], v25 offset:5120
    s_waitcnt lgkmcnt(0)
    v_mfma_f32_32x32x16_bf16 a[192:207], v[32:35], v[36:39], a[192:207]
    v_mfma_f32_32x32x16_bf16 a[208:223], v[32:35], v[40:43], a[208:223]
    v_mfma_f32_32x32x16_bf16 a[224:239], v[32:35], v[44:47], a[224:239]
    ds_read_b64_tr_b16 v[32:33], v23 offset:8192
    ds_read_b64_tr_b16 v[34:35], v23 offset:10240
    ds_read_b128 v[36:39], v25 offset:6144
    ds_read_b128 v[40:43], v25 offset:7168
    ds_read_b128 v[44:47], v25 offset:8192
    s_waitcnt lgkmcnt(0)
    v_mfma_f32_32x32x16_bf16 a[192:207], v[32:35], v[36:39], a[192:207]
    v_mfma_f32_32x32x16_bf16 a[208:223], v[32:35], v[40:43], a[208:223]
    v_mfma_f32_32x32x16_bf16 a[224:239], v[32:35], v[44:47], a[224:239]
    ds_read_b64_tr_b16 v[32:33], v23 offset:40960
    ds_read_b64_tr_b16 v[34:35], v23 offset:43008
    ds_read_b128 v[36:39], v25 offset:9216
    ds_read_b128 v[40:43], v25 offset:10240
    ds_read_b128 v[44:47], v25 offset:11264
    s_waitcnt lgkmcnt(0)
    v_mfma_f32_32x32x16_bf16 a[192:207], v[32:35], v[36:39], a[192:207]
    v_mfma_f32_32x32x16_bf16 a[208:223], v[32:35], v[40:43], a[208:223]
    v_mfma_f32_32x32x16_bf16 a[224:239], v[32:35], v[44:47], a[224:239]
    ds_read_b64_tr_b16 v[32:33], v22 offset:12288
    ds_read_b64_tr_b16 v[34:35], v22 offset:14336
    ds_read_b128 v[36:39], v25 offset:12288
    ds_read_b128 v[40:43], v25 offset:13312
    ds_read_b128 v[44:47], v25 offset:14336
    s_waitcnt lgkmcnt(0)
    v_mfma_f32_32x32x16_bf16 a[192:207], v[32:35], v[36:39], a[192:207]
    v_mfma_f32_32x32x16_bf16 a[208:223], v[32:35], v[40:43], a[208:223]
    v_mfma_f32_32x32x16_bf16 a[224:239], v[32:35], v[44:47], a[224:239]
    ds_read_b64_tr_b16 v[32:33], v22 offset:45056
    ds_read_b64_tr_b16 v[34:35], v22 offset:47104
    ds_read_b128 v[36:39], v25 offset:15360
    ds_read_b128 v[40:43], v25 offset:16384
    ds_read_b128 v[44:47], v25 offset:17408
    s_waitcnt lgkmcnt(0)
    v_mfma_f32_32x32x16_bf16 a[192:207], v[32:35], v[36:39], a[192:207]
    v_mfma_f32_32x32x16_bf16 a[208:223], v[32:35], v[40:43], a[208:223]
    v_mfma_f32_32x32x16_bf16 a[224:239], v[32:35], v[44:47], a[224:239]
    ds_read_b64_tr_b16 v[32:33], v23 offset:12288
    ds_read_b64_tr_b16 v[34:35], v23 offset:14336
    ds_read_b128 v[36:39], v25 offset:18432
    ds_read_b128 v[40:43], v25 offset:19456
    ds_read_b128 v[44:47], v25 offset:20480
    s_waitcnt lgkmcnt(0)
    v_mfma_f32_32x32x16_bf16 a[192:207], v[32:35], v[36:39], a[192:207]
    v_mfma_f32_32x32x16_bf16 a[208:223], v[32:35], v[40:43], a[208:223]
    v_mfma_f32_32x32x16_bf16 a[224:239], v[32:35], v[44:47], a[224:239]
    ds_read_b64_tr_b16 v[32:33], v23 offset:45056
    ds_read_b64_tr_b16 v[34:35], v23 offset:47104
    ds_read_b128 v[36:39], v25 offset:21504
    ds_read_b128 v[40:43], v25 offset:22528
    ds_read_b128 v[44:47], v25 offset:23552
    s_waitcnt lgkmcnt(0)
    v_mfma_f32_32x32x16_bf16 a[192:207], v[32:35], v[36:39], a[192:207]
    v_mfma_f32_32x32x16_bf16 a[208:223], v[32:35], v[40:43], a[208:223]
    v_mfma_f32_32x32x16_bf16 a[224:239], v[32:35], v[44:47], a[224:239]
    s_barrier
    ds_write_b128 v24, v[160:163] offset:0
    ds_write_b128 v24, v[176:179] offset:1024
    ds_write_b128 v24, v[192:195] offset:2048
    ds_write_b128 v24, v[164:167] offset:12288
    ds_write_b128 v24, v[180:183] offset:13312
    ds_write_b128 v24, v[196:199] offset:14336
    s_waitcnt lgkmcnt(0)
    s_barrier
    ds_read_b64_tr_b16 v[32:33], v22 offset:16384
    ds_read_b64_tr_b16 v[34:35], v22 offset:18432
    ds_read_b128 v[36:39], v25 offset:0
    ds_read_b128 v[40:43], v25 offset:1024
    ds_read_b128 v[44:47], v25 offset:2048
    s_waitcnt lgkmcnt(0)
    v_mfma_f32_32x32x16_bf16 a[192:207], v[32:35], v[36:39], a[192:207]
    v_mfma_f32_32x32x16_bf16 a[208:223], v[32:35], v[40:43], a[208:223]
    v_mfma_f32_32x32x16_bf16 a[224:239], v[32:35], v[44:47], a[224:239]
    ds_read_b64_tr_b16 v[32:33], v22 offset:49152
    ds_read_b64_tr_b16 v[34:35], v22 offset:51200
    ds_read_b128 v[36:39], v25 offset:3072
    ds_read_b128 v[40:43], v25 offset:4096
    ds_read_b128 v[44:47], v25 offset:5120
    s_waitcnt lgkmcnt(0)
    v_mfma_f32_32x32x16_bf16 a[192:207], v[32:35], v[36:39], a[192:207]
    v_mfma_f32_32x32x16_bf16 a[208:223], v[32:35], v[40:43], a[208:223]
    v_mfma_f32_32x32x16_bf16 a[224:239], v[32:35], v[44:47], a[224:239]
    ds_read_b64_tr_b16 v[32:33], v23 offset:16384
    ds_read_b64_tr_b16 v[34:35], v23 offset:18432
    ds_read_b128 v[36:39], v25 offset:6144
    ds_read_b128 v[40:43], v25 offset:7168
    ds_read_b128 v[44:47], v25 offset:8192
    s_waitcnt lgkmcnt(0)
    v_mfma_f32_32x32x16_bf16 a[192:207], v[32:35], v[36:39], a[192:207]
    v_mfma_f32_32x32x16_bf16 a[208:223], v[32:35], v[40:43], a[208:223]
    v_mfma_f32_32x32x16_bf16 a[224:239], v[32:35], v[44:47], a[224:239]
    ds_read_b64_tr_b16 v[32:33], v23 offset:49152
    ds_read_b64_tr_b16 v[34:35], v23 offset:51200
    ds_read_b128 v[36:39], v25 offset:9216
    ds_read_b128 v[40:43], v25 offset:10240
    ds_read_b128 v[44:47], v25 offset:11264
    s_waitcnt lgkmcnt(0)
    v_mfma_f32_32x32x16_bf16 a[192:207], v[32:35], v[36:39], a[192:207]
    v_mfma_f32_32x32x16_bf16 a[208:223], v[32:35], v[40:43], a[208:223]
    v_mfma_f32_32x32x16_bf16 a[224:239], v[32:35], v[44:47], a[224:239]
    ds_read_b64_tr_b16 v[32:33], v22 offset:20480
    ds_read_b64_tr_b16 v[34:35], v22 offset:22528
    ds_read_b128 v[36:39], v25 offset:12288
    ds_read_b128 v[40:43], v25 offset:13312
    ds_read_b128 v[44:47], v25 offset:14336
    s_waitcnt lgkmcnt(0)
    v_mfma_f32_32x32x16_bf16 a[192:207], v[32:35], v[36:39], a[192:207]
    v_mfma_f32_32x32x16_bf16 a[208:223], v[32:35], v[40:43], a[208:223]
    v_mfma_f32_32x32x16_bf16 a[224:239], v[32:35], v[44:47], a[224:239]
    ds_read_b64_tr_b16 v[32:33], v22 offset:53248
    ds_read_b64_tr_b16 v[34:35], v22 offset:55296
    ds_read_b128 v[36:39], v25 offset:15360
    ds_read_b128 v[40:43], v25 offset:16384
    ds_read_b128 v[44:47], v25 offset:17408
    s_waitcnt lgkmcnt(0)
    v_mfma_f32_32x32x16_bf16 a[192:207], v[32:35], v[36:39], a[192:207]
    v_mfma_f32_32x32x16_bf16 a[208:223], v[32:35], v[40:43], a[208:223]
    v_mfma_f32_32x32x16_bf16 a[224:239], v[32:35], v[44:47], a[224:239]
    ds_read_b64_tr_b16 v[32:33], v23 offset:20480
    ds_read_b64_tr_b16 v[34:35], v23 offset:22528
    ds_read_b128 v[36:39], v25 offset:18432
    ds_read_b128 v[40:43], v25 offset:19456
    ds_read_b128 v[44:47], v25 offset:20480
    s_waitcnt lgkmcnt(0)
    v_mfma_f32_32x32x16_bf16 a[192:207], v[32:35], v[36:39], a[192:207]
    v_mfma_f32_32x32x16_bf16 a[208:223], v[32:35], v[40:43], a[208:223]
    v_mfma_f32_32x32x16_bf16 a[224:239], v[32:35], v[44:47], a[224:239]
    ds_read_b64_tr_b16 v[32:33], v23 offset:53248
    ds_read_b64_tr_b16 v[34:35], v23 offset:55296
    ds_read_b128 v[36:39], v25 offset:21504
    ds_read_b128 v[40:43], v25 offset:22528
    ds_read_b128 v[44:47], v25 offset:23552
    s_waitcnt lgkmcnt(0)
    v_mfma_f32_32x32x16_bf16 a[192:207], v[32:35], v[36:39], a[192:207]
    v_mfma_f32_32x32x16_bf16 a[208:223], v[32:35], v[40:43], a[208:223]
    v_mfma_f32_32x32x16_bf16 a[224:239], v[32:35], v[44:47], a[224:239]
    s_barrier
    ds_write_b128 v24, v[208:211] offset:0
    ds_write_b128 v24, v[224:227] offset:1024
    ds_write_b128 v24, v[240:243] offset:2048
    ds_write_b128 v24, v[212:215] offset:12288
    ds_write_b128 v24, v[228:231] offset:13312
    ds_write_b128 v24, v[244:247] offset:14336
    s_waitcnt lgkmcnt(0)
    s_barrier
    ds_read_b64_tr_b16 v[32:33], v22 offset:24576
    ds_read_b64_tr_b16 v[34:35], v22 offset:26624
    ds_read_b128 v[36:39], v25 offset:0
    ds_read_b128 v[40:43], v25 offset:1024
    ds_read_b128 v[44:47], v25 offset:2048
    s_waitcnt lgkmcnt(0)
    v_mfma_f32_32x32x16_bf16 a[192:207], v[32:35], v[36:39], a[192:207]
    v_mfma_f32_32x32x16_bf16 a[208:223], v[32:35], v[40:43], a[208:223]
    v_mfma_f32_32x32x16_bf16 a[224:239], v[32:35], v[44:47], a[224:239]
    ds_read_b64_tr_b16 v[32:33], v22 offset:57344
    ds_read_b64_tr_b16 v[34:35], v22 offset:59392
    ds_read_b128 v[36:39], v25 offset:3072
    ds_read_b128 v[40:43], v25 offset:4096
    ds_read_b128 v[44:47], v25 offset:5120
    s_waitcnt lgkmcnt(0)
    v_mfma_f32_32x32x16_bf16 a[192:207], v[32:35], v[36:39], a[192:207]
    v_mfma_f32_32x32x16_bf16 a[208:223], v[32:35], v[40:43], a[208:223]
    v_mfma_f32_32x32x16_bf16 a[224:239], v[32:35], v[44:47], a[224:239]
    ds_read_b64_tr_b16 v[32:33], v23 offset:24576
    ds_read_b64_tr_b16 v[34:35], v23 offset:26624
    ds_read_b128 v[36:39], v25 offset:6144
    ds_read_b128 v[40:43], v25 offset:7168
    ds_read_b128 v[44:47], v25 offset:8192
    s_waitcnt lgkmcnt(0)
    v_mfma_f32_32x32x16_bf16 a[192:207], v[32:35], v[36:39], a[192:207]
    v_mfma_f32_32x32x16_bf16 a[208:223], v[32:35], v[40:43], a[208:223]
    v_mfma_f32_32x32x16_bf16 a[224:239], v[32:35], v[44:47], a[224:239]
    ds_read_b64_tr_b16 v[32:33], v23 offset:57344
    ds_read_b64_tr_b16 v[34:35], v23 offset:59392
    ds_read_b128 v[36:39], v25 offset:9216
    ds_read_b128 v[40:43], v25 offset:10240
    ds_read_b128 v[44:47], v25 offset:11264
    s_waitcnt lgkmcnt(0)
    v_mfma_f32_32x32x16_bf16 a[192:207], v[32:35], v[36:39], a[192:207]
    v_mfma_f32_32x32x16_bf16 a[208:223], v[32:35], v[40:43], a[208:223]
    v_mfma_f32_32x32x16_bf16 a[224:239], v[32:35], v[44:47], a[224:239]
    ds_read_b64_tr_b16 v[32:33], v22 offset:28672
    ds_read_b64_tr_b16 v[34:35], v22 offset:30720
    ds_read_b128 v[36:39], v25 offset:12288
    ds_read_b128 v[40:43], v25 offset:13312
    ds_read_b128 v[44:47], v25 offset:14336
    s_waitcnt lgkmcnt(0)
    v_mfma_f32_32x32x16_bf16 a[192:207], v[32:35], v[36:39], a[192:207]
    v_mfma_f32_32x32x16_bf16 a[208:223], v[32:35], v[40:43], a[208:223]
    v_mfma_f32_32x32x16_bf16 a[224:239], v[32:35], v[44:47], a[224:239]
    ds_read_b64_tr_b16 v[32:33], v22 offset:61440
    ds_read_b64_tr_b16 v[34:35], v22 offset:63488
    ds_read_b128 v[36:39], v25 offset:15360
    ds_read_b128 v[40:43], v25 offset:16384
    ds_read_b128 v[44:47], v25 offset:17408
    s_waitcnt lgkmcnt(0)
    v_mfma_f32_32x32x16_bf16 a[192:207], v[32:35], v[36:39], a[192:207]
    v_mfma_f32_32x32x16_bf16 a[208:223], v[32:35], v[40:43], a[208:223]
    v_mfma_f32_32x32x16_bf16 a[224:239], v[32:35], v[44:47], a[224:239]
    ds_read_b64_tr_b16 v[32:33], v23 offset:28672
    ds_read_b64_tr_b16 v[34:35], v23 offset:30720
    ds_read_b128 v[36:39], v25 offset:18432
    ds_read_b128 v[40:43], v25 offset:19456
    ds_read_b128 v[44:47], v25 offset:20480
    s_waitcnt lgkmcnt(0)
    v_mfma_f32_32x32x16_bf16 a[192:207], v[32:35], v[36:39], a[192:207]
    v_mfma_f32_32x32x16_bf16 a[208:223], v[32:35], v[40:43], a[208:223]
    v_mfma_f32_32x32x16_bf16 a[224:239], v[32:35], v[44:47], a[224:239]
    ds_read_b64_tr_b16 v[32:33], v23 offset:61440
    ds_read_b64_tr_b16 v[34:35], v23 offset:63488
    ds_read_b128 v[36:39], v25 offset:21504
    ds_read_b128 v[40:43], v25 offset:22528
    ds_read_b128 v[44:47], v25 offset:23552
    s_waitcnt lgkmcnt(0)
    v_mfma_f32_32x32x16_bf16 a[192:207], v[32:35], v[36:39], a[192:207]
    v_mfma_f32_32x32x16_bf16 a[208:223], v[32:35], v[40:43], a[208:223]
    v_mfma_f32_32x32x16_bf16 a[224:239], v[32:35], v[44:47], a[224:239]
    s_barrier
    s_add_u32 m0, s28, 8192
    s_add_u32 s29, s94, 131072
    buffer_load_dwordx4 v2, s[12:15], s29 offen offset:0 nt lds
    buffer_load_dwordx4 v3, s[12:15], s29 offen offset:1024 nt lds
    buffer_load_dwordx4 v4, s[12:15], s29 offen offset:2048 nt lds
    buffer_load_dwordx4 v5, s[12:15], s29 offen offset:3072 nt lds
    s_add_u32 m0, s28, 12288
    s_add_u32 s29, s94, 135168
    buffer_load_dwordx4 v2, s[12:15], s29 offen offset:0 nt lds
    buffer_load_dwordx4 v3, s[12:15], s29 offen offset:1024 nt lds
    buffer_load_dwordx4 v4, s[12:15], s29 offen offset:2048 nt lds
    buffer_load_dwordx4 v5, s[12:15], s29 offen offset:3072 nt lds
    s_add_u32 m0, s28, 16384
    s_add_u32 s29, s95, 131072
    buffer_load_dwordx4 v2, s[12:15], s29 offen offset:0 nt lds
    buffer_load_dwordx4 v3, s[12:15], s29 offen offset:1024 nt lds
    buffer_load_dwordx4 v4, s[12:15], s29 offen offset:2048 nt lds
    buffer_load_dwordx4 v5, s[12:15], s29 offen offset:3072 nt lds
    s_add_u32 m0, s28, 20480
    s_add_u32 s29, s95, 135168
    buffer_load_dwordx4 v2, s[12:15], s29 offen offset:0 nt lds
    buffer_load_dwordx4 v3, s[12:15], s29 offen offset:1024 nt lds
    buffer_load_dwordx4 v4, s[12:15], s29 offen offset:2048 nt lds
    buffer_load_dwordx4 v5, s[12:15], s29 offen offset:3072 nt lds
    s_add_u32 m0, s28, 24576
    s_add_u32 s29, s96, 131072
    buffer_load_dwordx4 v2, s[12:15], s29 offen offset:0 nt lds
    buffer_load_dwordx4 v3, s[12:15], s29 offen offset:1024 nt lds
    buffer_load_dwordx4 v4, s[12:15], s29 offen offset:2048 nt lds
    buffer_load_dwordx4 v5, s[12:15], s29 offen offset:3072 nt lds
    s_add_u32 m0, s28, 28672
    s_add_u32 s29, s96, 135168
    buffer_load_dwordx4 v2, s[12:15], s29 offen offset:0 nt lds
    buffer_load_dwordx4 v3, s[12:15], s29 offen offset:1024 nt lds
    buffer_load_dwordx4 v4, s[12:15], s29 offen offset:2048 nt lds
    buffer_load_dwordx4 v5, s[12:15], s29 offen offset:3072 nt lds
    ds_read_b128 v[112:115], v27 offset:1536
    ds_read_b128 v[116:119], v27 offset:2048
    ds_read_b128 v[120:123], v27 offset:2560
    s_mov_b32 s50, 0x30800000
    s_mov_b32 s51, 0x4e800000
    s_waitcnt lgkmcnt(2)
    v_add_f32 v112, v112, v113
    v_add_f32 v114, v114, v115
    v_add_f32 v112, v112, v114
    s_waitcnt lgkmcnt(1)
    v_add_f32 v116, v116, v117
    v_add_f32 v118, v118, v119
    v_add_f32 v116, v116, v118
    s_waitcnt lgkmcnt(0)
    v_add_f32 v120, v120, v121
    v_add_f32 v122, v122, v123
    v_add_f32 v120, v120, v122
    v_min3_f32 v113, v112, v116, v120
    v_max3_f32 v114, v112, v116, v120
    v_cmp_u_f32 vcc, v112, v116
    v_cmp_u_f32 s[0:1], v120, v120
    s_or_b64 s[0:1], vcc, s[0:1]
    v_cmp_nle_f32 vcc, s50, v113
    s_or_b64 s[0:1], vcc, s[0:1]
    v_cmp_nge_f32 vcc, s51, v114
    s_or_b64 s[0:1], vcc, s[0:1]
    v_rcp_f32 v124, v112
    v_rcp_f32 v125, v112
    v_rcp_f32 v126, v116
    v_rcp_f32 v127, v116
    v_rcp_f32 v128, v120
    v_rcp_f32 v129, v120
    v_not_b32 v30, s36
    s_waitcnt vmcnt(0)
    s_nop 15
    s_branch L_epi0
L_slow1:
    s_waitcnt vmcnt(0) lgkmcnt(0)
    s_barrier
    s_mov_b64 s[38:39], 0
    v_mbcnt_lo_u32_b32 v33, -1, 0
    v_mbcnt_hi_u32_b32 v33, -1, v33
    v_lshrrev_b32 v34, 4, v33
    v_and_b32 v35, 15, v33
    v_lshrrev_b32 v36, 5, v33
    v_and_b32 v37, 31, v33
    v_add_u32 v39, 0, v34
    v_xor_b32 v39, v35, v39
    v_lshlrev_b32 v39, 4, v39
    v_lshl_add_u32 v2, v34, 8, v39
    v_add_u32 v39, 4, v34
    v_xor_b32 v39, v35, v39
    v_lshlrev_b32 v39, 4, v39
    v_lshl_add_u32 v3, v34, 8, v39
    v_add_u32 v39, 8, v34
    v_xor_b32 v39, v35, v39
    v_lshlrev_b32 v39, 4, v39
    v_lshl_add_u32 v4, v34, 8, v39
    v_add_u32 v39, 12, v34
    v_xor_b32 v39, v35, v39
    v_lshlrev_b32 v39, 4, v39
    v_lshl_add_u32 v5, v34, 8, v39
    v_add_u32 v39, 0, v36
    v_xor_b32 v39, v35, v39
    v_lshlrev_b32 v39, 4, v39
    v_lshl_add_u32 v39, v37, 8, v39
    v_add_u32 v12, s28, v39
    v_add_u32 v39, 2, v36
    v_xor_b32 v39, v35, v39
    v_lshlrev_b32 v39, 4, v39
    v_lshl_add_u32 v39, v37, 8, v39
    v_add_u32 v13, s28, v39
    v_add_u32 v39, 4, v36
    v_xor_b32 v39, v35, v39
    v_lshlrev_b32 v39, 4, v39
    v_lshl_add_u32 v39, v37, 8, v39
    v_add_u32 v14, s28, v39
    v_add_u32 v39, 6, v36
    v_xor_b32 v39, v35, v39
    v_lshlrev_b32 v39, 4, v39
    v_lshl_add_u32 v39, v37, 8, v39
    v_add_u32 v15, s28, v39
    v_add_u32 v39, 8, v36
    v_xor_b32 v39, v35, v39
    v_lshlrev_b32 v39, 4, v39
    v_lshl_add_u32 v39, v37, 8, v39
    v_add_u32 v16, s28, v39
    v_add_u32 v39, 10, v36
    v_xor_b32 v39, v35, v39
    v_lshlrev_b32 v39, 4, v39
    v_lshl_add_u32 v39, v37, 8, v39
    v_add_u32 v17, s28, v39
    v_add_u32 v39, 12, v36
    v_xor_b32 v39, v35, v39
    v_lshlrev_b32 v39, 4, v39
    v_lshl_add_u32 v39, v37, 8, v39
    v_add_u32 v18, s28, v39
    v_add_u32 v39, 14, v36
    v_xor_b32 v39, v35, v39
    v_lshlrev_b32 v39, 4, v39
    v_lshl_add_u32 v39, v37, 8, v39
    v_add_u32 v19, s28, v39
    s_add_u32 m0, s28, 0
    s_add_u32 s29, s94, 131072
    buffer_load_dwordx4 v2, s[12:15], s29 offen offset:0 nt lds
    buffer_load_dwordx4 v3, s[12:15], s29 offen offset:1024 nt lds
    buffer_load_dwordx4 v4, s[12:15], s29 offen offset:2048 nt lds
    buffer_load_dwordx4 v5, s[12:15], s29 offen offset:3072 nt lds
    s_add_u32 m0, s28, 4096
    s_add_u32 s29, s94, 135168
    buffer_load_dwordx4 v2, s[12:15], s29 offen offset:0 nt lds
    buffer_load_dwordx4 v3, s[12:15], s29 offen offset:1024 nt lds
    buffer_load_dwordx4 v4, s[12:15], s29 offen offset:2048 nt lds
    buffer_load_dwordx4 v5, s[12:15], s29 offen offset:3072 nt lds
    s_add_u32 m0, s28, 8192
    s_add_u32 s29, s95, 131072
    buffer_load_dwordx4 v2, s[12:15], s29 offen offset:0 nt lds
    buffer_load_dwordx4 v3, s[12:15], s29 offen offset:1024 nt lds
    buffer_load_dwordx4 v4, s[12:15], s29 offen offset:2048 nt lds
    buffer_load_dwordx4 v5, s[12:15], s29 offen offset:3072 nt lds
    s_add_u32 m0, s28, 12288
    s_add_u32 s29, s95, 135168
    buffer_load_dwordx4 v2, s[12:15], s29 offen offset:0 nt lds
    buffer_load_dwordx4 v3, s[12:15], s29 offen offset:1024 nt lds
    buffer_load_dwordx4 v4, s[12:15], s29 offen offset:2048 nt lds
    buffer_load_dwordx4 v5, s[12:15], s29 offen offset:3072 nt lds
    s_add_u32 m0, s28, 16384
    s_add_u32 s29, s96, 131072
    buffer_load_dwordx4 v2, s[12:15], s29 offen offset:0 nt lds
    buffer_load_dwordx4 v3, s[12:15], s29 offen offset:1024 nt lds
    buffer_load_dwordx4 v4, s[12:15], s29 offen offset:2048 nt lds
    buffer_load_dwordx4 v5, s[12:15], s29 offen offset:3072 nt lds
    s_add_u32 m0, s28, 20480
    s_add_u32 s29, s96, 135168
    buffer_load_dwordx4 v2, s[12:15], s29 offen offset:0 nt lds
    buffer_load_dwordx4 v3, s[12:15], s29 offen offset:1024 nt lds
    buffer_load_dwordx4 v4, s[12:15], s29 offen offset:2048 nt lds
    buffer_load_dwordx4 v5, s[12:15], s29 offen offset:3072 nt lds
    s_add_u32 m0, s28, 24576
    s_add_u32 s29, s97, 131072
    buffer_load_dwordx4 v2, s[12:15], s29 offen offset:0 nt lds
    buffer_load_dwordx4 v3, s[12:15], s29 offen offset:1024 nt lds
    buffer_load_dwordx4 v4, s[12:15], s29 offen offset:2048 nt lds
    buffer_load_dwordx4 v5, s[12:15], s29 offen offset:3072 nt lds
    s_add_u32 m0, s28, 28672
    s_add_u32 s29, s97, 135168
    buffer_load_dwordx4 v2, s[12:15], s29 offen offset:0 nt lds
    buffer_load_dwordx4 v3, s[12:15], s29 offen offset:1024 nt lds
    buffer_load_dwordx4 v4, s[12:15], s29 offen offset:2048 nt lds
    buffer_load_dwordx4 v5, s[12:15], s29 offen offset:3072 nt lds
    s_waitcnt vmcnt(0)
    ds_read_b128 v[32:35], v12 offset:0
    ds_read_b128 v[36:39], v13 offset:0
    ds_read_b128 v[40:43], v14 offset:0
    ds_read_b128 v[44:47], v15 offset:0
    ds_read_b128 v[48:51], v16 offset:0
    ds_read_b128 v[52:55], v17 offset:0
    ds_read_b128 v[56:59], v18 offset:0
    ds_read_b128 v[60:63], v19 offset:0
    s_waitcnt lgkmcnt(0)
    v_mfma_f32_32x32x16_bf16 v[64:79], v[32:35], a[96:99], 0
    v_mfma_f32_32x32x16_bf16 v[80:95], v[32:35], a[100:103], 0
    v_mfma_f32_32x32x16_bf16 v[96:111], v[32:35], a[104:107], 0
    v_mfma_f32_32x32x16_bf16 v[64:79], v[36:39], a[108:111], v[64:79]
    v_mfma_f32_32x32x16_bf16 v[80:95], v[36:39], a[112:115], v[80:95]
    v_mfma_f32_32x32x16_bf16 v[96:111], v[36:39], a[116:119], v[96:111]
    v_mfma_f32_32x32x16_bf16 v[64:79], v[40:43], a[120:123], v[64:79]
    v_mfma_f32_32x32x16_bf16 v[80:95], v[40:43], a[124:127], v[80:95]
    v_mfma_f32_32x32x16_bf16 v[96:111], v[40:43], a[128:131], v[96:111]
    v_mfma_f32_32x32x16_bf16 v[64:79], v[44:47], a[132:135], v[64:79]
    v_mfma_f32_32x32x16_bf16 v[80:95], v[44:47], a[136:139], v[80:95]
    v_mfma_f32_32x32x16_bf16 v[96:111], v[44:47], a[140:143], v[96:111]
    v_mfma_f32_32x32x16_bf16 v[64:79], v[48:51], a[144:147], v[64:79]
    v_mfma_f32_32x32x16_bf16 v[80:95], v[48:51], a[148:151], v[80:95]
    v_mfma_f32_32x32x16_bf16 v[96:111], v[48:51], a[152:155], v[96:111]
    v_mfma_f32_32x32x16_bf16 v[64:79], v[52:55], a[156:159], v[64:79]
    v_mfma_f32_32x32x16_bf16 v[80:95], v[52:55], a[160:163], v[80:95]
    v_mfma_f32_32x32x16_bf16 v[96:111], v[52:55], a[164:167], v[96:111]
    v_mfma_f32_32x32x16_bf16 v[64:79], v[56:59], a[168:171], v[64:79]
    v_mfma_f32_32x32x16_bf16 v[80:95], v[56:59], a[172:175], v[80:95]
    v_mfma_f32_32x32x16_bf16 v[96:111], v[56:59], a[176:179], v[96:111]
    v_mfma_f32_32x32x16_bf16 v[64:79], v[60:63], a[180:183], v[64:79]
    v_mfma_f32_32x32x16_bf16 v[80:95], v[60:63], a[184:187], v[80:95]
    v_mfma_f32_32x32x16_bf16 v[96:111], v[60:63], a[188:191], v[96:111]
    ds_read_b128 v[32:35], v12 offset:8192
    ds_read_b128 v[36:39], v13 offset:8192
    ds_read_b128 v[40:43], v14 offset:8192
    ds_read_b128 v[44:47], v15 offset:8192
    ds_read_b128 v[48:51], v16 offset:8192
    ds_read_b128 v[52:55], v17 offset:8192
    ds_read_b128 v[56:59], v18 offset:8192
    ds_read_b128 v[60:63], v19 offset:8192
    s_waitcnt lgkmcnt(0)
    v_mfma_f32_32x32x16_bf16 v[112:127], v[32:35], a[96:99], 0
    v_mfma_f32_32x32x16_bf16 v[128:143], v[32:35], a[100:103], 0
    v_mfma_f32_32x32x16_bf16 v[144:159], v[32:35], a[104:107], 0
    v_mfma_f32_32x32x16_bf16 v[112:127], v[36:39], a[108:111], v[112:127]
    v_mfma_f32_32x32x16_bf16 v[128:143], v[36:39], a[112:115], v[128:143]
    v_mfma_f32_32x32x16_bf16 v[144:159], v[36:39], a[116:119], v[144:159]
    v_mfma_f32_32x32x16_bf16 v[112:127], v[40:43], a[120:123], v[112:127]
    v_mfma_f32_32x32x16_bf16 v[128:143], v[40:43], a[124:127], v[128:143]
    v_mfma_f32_32x32x16_bf16 v[144:159], v[40:43], a[128:131], v[144:159]
    v_mfma_f32_32x32x16_bf16 v[112:127], v[44:47], a[132:135], v[112:127]
    v_mfma_f32_32x32x16_bf16 v[128:143], v[44:47], a[136:139], v[128:143]
    v_mfma_f32_32x32x16_bf16 v[144:159], v[44:47], a[140:143], v[144:159]
    v_mfma_f32_32x32x16_bf16 v[112:127], v[48:51], a[144:147], v[112:127]
    v_mfma_f32_32x32x16_bf16 v[128:143], v[48:51], a[148:151], v[128:143]
    v_mfma_f32_32x32x16_bf16 v[144:159], v[48:51], a[152:155], v[144:159]
    v_mfma_f32_32x32x16_bf16 v[112:127], v[52:55], a[156:159], v[112:127]
    v_mfma_f32_32x32x16_bf16 v[128:143], v[52:55], a[160:163], v[128:143]
    v_mfma_f32_32x32x16_bf16 v[144:159], v[52:55], a[164:167], v[144:159]
    v_mfma_f32_32x32x16_bf16 v[112:127], v[56:59], a[168:171], v[112:127]
    v_mfma_f32_32x32x16_bf16 v[128:143], v[56:59], a[172:175], v[128:143]
    v_mfma_f32_32x32x16_bf16 v[144:159], v[56:59], a[176:179], v[144:159]
    v_mfma_f32_32x32x16_bf16 v[112:127], v[60:63], a[180:183], v[112:127]
    v_mfma_f32_32x32x16_bf16 v[128:143], v[60:63], a[184:187], v[128:143]
    v_mfma_f32_32x32x16_bf16 v[144:159], v[60:63], a[188:191], v[144:159]
    ds_read_b128 v[32:35], v12 offset:16384
    ds_read_b128 v[36:39], v13 offset:16384
    ds_read_b128 v[40:43], v14 offset:16384
    ds_read_b128 v[44:47], v15 offset:16384
    ds_read_b128 v[48:51], v16 offset:16384
    ds_read_b128 v[52:55], v17 offset:16384
    ds_read_b128 v[56:59], v18 offset:16384
    ds_read_b128 v[60:63], v19 offset:16384
    s_waitcnt lgkmcnt(0)
    v_mfma_f32_32x32x16_bf16 v[160:175], v[32:35], a[96:99], 0
    v_mfma_f32_32x32x16_bf16 v[176:191], v[32:35], a[100:103], 0
    v_mfma_f32_32x32x16_bf16 v[192:207], v[32:35], a[104:107], 0
    v_mfma_f32_32x32x16_bf16 v[160:175], v[36:39], a[108:111], v[160:175]
    v_mfma_f32_32x32x16_bf16 v[176:191], v[36:39], a[112:115], v[176:191]
    v_mfma_f32_32x32x16_bf16 v[192:207], v[36:39], a[116:119], v[192:207]
    v_mfma_f32_32x32x16_bf16 v[160:175], v[40:43], a[120:123], v[160:175]
    v_mfma_f32_32x32x16_bf16 v[176:191], v[40:43], a[124:127], v[176:191]
    v_mfma_f32_32x32x16_bf16 v[192:207], v[40:43], a[128:131], v[192:207]
    v_mfma_f32_32x32x16_bf16 v[160:175], v[44:47], a[132:135], v[160:175]
    v_mfma_f32_32x32x16_bf16 v[176:191], v[44:47], a[136:139], v[176:191]
    v_mfma_f32_32x32x16_bf16 v[192:207], v[44:47], a[140:143], v[192:207]
    v_mfma_f32_32x32x16_bf16 v[160:175], v[48:51], a[144:147], v[160:175]
    v_mfma_f32_32x32x16_bf16 v[176:191], v[48:51], a[148:151], v[176:191]
    v_mfma_f32_32x32x16_bf16 v[192:207], v[48:51], a[152:155], v[192:207]
    v_mfma_f32_32x32x16_bf16 v[160:175], v[52:55], a[156:159], v[160:175]
    v_mfma_f32_32x32x16_bf16 v[176:191], v[52:55], a[160:163], v[176:191]
    v_mfma_f32_32x32x16_bf16 v[192:207], v[52:55], a[164:167], v[192:207]
    v_mfma_f32_32x32x16_bf16 v[160:175], v[56:59], a[168:171], v[160:175]
    v_mfma_f32_32x32x16_bf16 v[176:191], v[56:59], a[172:175], v[176:191]
    v_mfma_f32_32x32x16_bf16 v[192:207], v[56:59], a[176:179], v[192:207]
    v_mfma_f32_32x32x16_bf16 v[160:175], v[60:63], a[180:183], v[160:175]
    v_mfma_f32_32x32x16_bf16 v[176:191], v[60:63], a[184:187], v[176:191]
    v_mfma_f32_32x32x16_bf16 v[192:207], v[60:63], a[188:191], v[192:207]
    ds_read_b128 v[32:35], v12 offset:24576
    ds_read_b128 v[36:39], v13 offset:24576
    ds_read_b128 v[40:43], v14 offset:24576
    ds_read_b128 v[44:47], v15 offset:24576
    ds_read_b128 v[48:51], v16 offset:24576
    ds_read_b128 v[52:55], v17 offset:24576
    ds_read_b128 v[56:59], v18 offset:24576
    ds_read_b128 v[60:63], v19 offset:24576
    s_waitcnt lgkmcnt(0)
    v_mfma_f32_32x32x16_bf16 v[208:223], v[32:35], a[96:99], 0
    v_mfma_f32_32x32x16_bf16 v[224:239], v[32:35], a[100:103], 0
    v_mfma_f32_32x32x16_bf16 v[240:255], v[32:35], a[104:107], 0
    v_mfma_f32_32x32x16_bf16 v[208:223], v[36:39], a[108:111], v[208:223]
    v_mfma_f32_32x32x16_bf16 v[224:239], v[36:39], a[112:115], v[224:239]
    v_mfma_f32_32x32x16_bf16 v[240:255], v[36:39], a[116:119], v[240:255]
    v_mfma_f32_32x32x16_bf16 v[208:223], v[40:43], a[120:123], v[208:223]
    v_mfma_f32_32x32x16_bf16 v[224:239], v[40:43], a[124:127], v[224:239]
    v_mfma_f32_32x32x16_bf16 v[240:255], v[40:43], a[128:131], v[240:255]
    v_mfma_f32_32x32x16_bf16 v[208:223], v[44:47], a[132:135], v[208:223]
    v_mfma_f32_32x32x16_bf16 v[224:239], v[44:47], a[136:139], v[224:239]
    v_mfma_f32_32x32x16_bf16 v[240:255], v[44:47], a[140:143], v[240:255]
    v_mfma_f32_32x32x16_bf16 v[208:223], v[48:51], a[144:147], v[208:223]
    v_mfma_f32_32x32x16_bf16 v[224:239], v[48:51], a[148:151], v[224:239]
    v_mfma_f32_32x32x16_bf16 v[240:255], v[48:51], a[152:155], v[240:255]
    v_mfma_f32_32x32x16_bf16 v[208:223], v[52:55], a[156:159], v[208:223]
    v_mfma_f32_32x32x16_bf16 v[224:239], v[52:55], a[160:163], v[224:239]
    v_mfma_f32_32x32x16_bf16 v[240:255], v[52:55], a[164:167], v[240:255]
    v_mfma_f32_32x32x16_bf16 v[208:223], v[56:59], a[168:171], v[208:223]
    v_mfma_f32_32x32x16_bf16 v[224:239], v[56:59], a[172:175], v[224:239]
    v_mfma_f32_32x32x16_bf16 v[240:255], v[56:59], a[176:179], v[240:255]
    v_mfma_f32_32x32x16_bf16 v[208:223], v[60:63], a[180:183], v[208:223]
    v_mfma_f32_32x32x16_bf16 v[224:239], v[60:63], a[184:187], v[224:239]
    v_mfma_f32_32x32x16_bf16 v[240:255], v[60:63], a[188:191], v[240:255]
    s_add_u32 m0, s28, 0
    s_add_u32 s29, s94, 131072
    buffer_load_dwordx4 v6, s[16:19], s29 offen offset:0 nt lds
    buffer_load_dwordx4 v6, s[16:19], s29 offen offset:1024 nt lds
    buffer_load_dwordx4 v6, s[16:19], s29 offen offset:2048 nt lds
    buffer_load_dwordx4 v6, s[16:19], s29 offen offset:3072 nt lds
    s_add_u32 m0, s28, 4096
    s_add_u32 s29, s94, 135168
    buffer_load_dwordx4 v6, s[16:19], s29 offen offset:0 nt lds
    buffer_load_dwordx4 v6, s[16:19], s29 offen offset:1024 nt lds
    buffer_load_dwordx4 v6, s[16:19], s29 offen offset:2048 nt lds
    buffer_load_dwordx4 v6, s[16:19], s29 offen offset:3072 nt lds
    s_add_u32 m0, s28, 8192
    s_add_u32 s29, s95, 131072
    buffer_load_dwordx4 v6, s[16:19], s29 offen offset:0 nt lds
    buffer_load_dwordx4 v6, s[16:19], s29 offen offset:1024 nt lds
    buffer_load_dwordx4 v6, s[16:19], s29 offen offset:2048 nt lds
    buffer_load_dwordx4 v6, s[16:19], s29 offen offset:3072 nt lds
    s_add_u32 m0, s28, 12288
    s_add_u32 s29, s95, 135168
    buffer_load_dwordx4 v6, s[16:19], s29 offen offset:0 nt lds
    buffer_load_dwordx4 v6, s[16:19], s29 offen offset:1024 nt lds
    buffer_load_dwordx4 v6, s[16:19], s29 offen offset:2048 nt lds
    buffer_load_dwordx4 v6, s[16:19], s29 offen offset:3072 nt lds
    s_add_u32 m0, s28, 16384
    s_add_u32 s29, s96, 131072
    buffer_load_dwordx4 v6, s[16:19], s29 offen offset:0 nt lds
    buffer_load_dwordx4 v6, s[16:19], s29 offen offset:1024 nt lds
    buffer_load_dwordx4 v6, s[16:19], s29 offen offset:2048 nt lds
    buffer_load_dwordx4 v6, s[16:19], s29 offen offset:3072 nt lds
    s_add_u32 m0, s28, 20480
    s_add_u32 s29, s96, 135168
    buffer_load_dwordx4 v6, s[16:19], s29 offen offset:0 nt lds
    buffer_load_dwordx4 v6, s[16:19], s29 offen offset:1024 nt lds
    buffer_load_dwordx4 v6, s[16:19], s29 offen offset:2048 nt lds
    buffer_load_dwordx4 v6, s[16:19], s29 offen offset:3072 nt lds
    s_add_u32 m0, s28, 24576
    s_add_u32 s29, s97, 131072
    buffer_load_dwordx4 v6, s[16:19], s29 offen offset:0 nt lds
    buffer_load_dwordx4 v6, s[16:19], s29 offen offset:1024 nt lds
    buffer_load_dwordx4 v6, s[16:19], s29 offen offset:2048 nt lds
    buffer_load_dwordx4 v6, s[16:19], s29 offen offset:3072 nt lds
    s_add_u32 m0, s28, 28672
    s_add_u32 s29, s97, 135168
    buffer_load_dwordx4 v6, s[16:19], s29 offen offset:0 nt lds
    buffer_load_dwordx4 v6, s[16:19], s29 offen offset:1024 nt lds
    buffer_load_dwordx4 v6, s[16:19], s29 offen offset:2048 nt lds
    buffer_load_dwordx4 v6, s[16:19], s29 offen offset:3072 nt lds
    v_mov_b32 v29, v64
    v_max3_f32 v29, v29, v64, v65
    v_max3_f32 v29, v29, v66, v67
    v_max3_f32 v29, v29, v68, v69
    v_max3_f32 v29, v29, v70, v71
    v_max3_f32 v29, v29, v72, v73
    v_max3_f32 v29, v29, v74, v75
    v_max3_f32 v29, v29, v76, v77
    v_max3_f32 v29, v29, v78, v79
    v_max3_f32 v29, v29, v112, v113
    v_max3_f32 v29, v29, v114, v115
    v_max3_f32 v29, v29, v116, v117
    v_max3_f32 v29, v29, v118, v119
    v_max3_f32 v29, v29, v120, v121
    v_max3_f32 v29, v29, v122, v123
    v_max3_f32 v29, v29, v124, v125
    v_max3_f32 v29, v29, v126, v127
    v_max3_f32 v29, v29, v160, v161
    v_max3_f32 v29, v29, v162, v163
    v_max3_f32 v29, v29, v164, v165
    v_max3_f32 v29, v29, v166, v167
    v_max3_f32 v29, v29, v168, v169
    v_max3_f32 v29, v29, v170, v171
    v_max3_f32 v29, v29, v172, v173
    v_max3_f32 v29, v29, v174, v175
    v_max3_f32 v29, v29, v208, v209
    v_max3_f32 v29, v29, v210, v211
    v_max3_f32 v29, v29, v212, v213
    v_max3_f32 v29, v29, v214, v215
    v_max3_f32 v29, v29, v216, v217
    v_max3_f32 v29, v29, v218, v219
    v_max3_f32 v29, v29, v220, v221
    v_max3_f32 v29, v29, v222, v223
    v_mov_b32 v30, v80
    v_max3_f32 v30, v30, v80, v81
    v_max3_f32 v30, v30, v82, v83
    v_max3_f32 v30, v30, v84, v85
    v_max3_f32 v30, v30, v86, v87
    v_max3_f32 v30, v30, v88, v89
    v_max3_f32 v30, v30, v90, v91
    v_max3_f32 v30, v30, v92, v93
    v_max3_f32 v30, v30, v94, v95
    v_max3_f32 v30, v30, v128, v129
    v_max3_f32 v30, v30, v130, v131
    v_max3_f32 v30, v30, v132, v133
    v_max3_f32 v30, v30, v134, v135
    v_max3_f32 v30, v30, v136, v137
    v_max3_f32 v30, v30, v138, v139
    v_max3_f32 v30, v30, v140, v141
    v_max3_f32 v30, v30, v142, v143
    v_max3_f32 v30, v30, v176, v177
    v_max3_f32 v30, v30, v178, v179
    v_max3_f32 v30, v30, v180, v181
    v_max3_f32 v30, v30, v182, v183
    v_max3_f32 v30, v30, v184, v185
    v_max3_f32 v30, v30, v186, v187
    v_max3_f32 v30, v30, v188, v189
    v_max3_f32 v30, v30, v190, v191
    v_max3_f32 v30, v30, v224, v225
    v_max3_f32 v30, v30, v226, v227
    v_max3_f32 v30, v30, v228, v229
    v_max3_f32 v30, v30, v230, v231
    v_max3_f32 v30, v30, v232, v233
    v_max3_f32 v30, v30, v234, v235
    v_max3_f32 v30, v30, v236, v237
    v_max3_f32 v30, v30, v238, v239
    v_mov_b32 v31, v96
    v_max3_f32 v31, v31, v96, v97
    v_max3_f32 v31, v31, v98, v99
    v_max3_f32 v31, v31, v100, v101
    v_max3_f32 v31, v31, v102, v103
    v_max3_f32 v31, v31, v104, v105
    v_max3_f32 v31, v31, v106, v107
    v_max3_f32 v31, v31, v108, v109
    v_max3_f32 v31, v31, v110, v111
    v_max3_f32 v31, v31, v144, v145
    v_max3_f32 v31, v31, v146, v147
    v_max3_f32 v31, v31, v148, v149
    v_max3_f32 v31, v31, v150, v151
    v_max3_f32 v31, v31, v152, v153
    v_max3_f32 v31, v31, v154, v155
    v_max3_f32 v31, v31, v156, v157
    v_max3_f32 v31, v31, v158, v159
    v_max3_f32 v31, v31, v192, v193
    v_max3_f32 v31, v31, v194, v195
    v_max3_f32 v31, v31, v196, v197
    v_max3_f32 v31, v31, v198, v199
    v_max3_f32 v31, v31, v200, v201
    v_max3_f32 v31, v31, v202, v203
    v_max3_f32 v31, v31, v204, v205
    v_max3_f32 v31, v31, v206, v207
    v_max3_f32 v31, v31, v240, v241
    v_max3_f32 v31, v31, v242, v243
    v_max3_f32 v31, v31, v244, v245
    v_max3_f32 v31, v31, v246, v247
    v_max3_f32 v31, v31, v248, v249
    v_max3_f32 v31, v31, v250, v251
    v_max3_f32 v31, v31, v252, v253
    v_max3_f32 v31, v31, v254, v255
    v_mov_b32 v32, v29
    v_mov_b32 v33, v30
    v_mov_b32 v34, v31
    v_permlane32_swap_b32 v29, v32
    v_permlane32_swap_b32 v30, v33
    v_permlane32_swap_b32 v31, v34
    v_max_f32 v29, v29, v32
    v_max_f32 v30, v30, v33
    v_max_f32 v31, v31, v34
    ds_write_b32 v26, v29 offset:0
    ds_write_b32 v26, v30 offset:512
    ds_write_b32 v26, v31 offset:1024
    s_waitcnt lgkmcnt(0)
    s_barrier
    ds_read_b128 v[36:39], v27 offset:0
    ds_read_b128 v[40:43], v27 offset:512
    ds_read_b128 v[44:47], v27 offset:1024
    s_waitcnt lgkmcnt(0)
    v_max3_f32 v36, v36, v37, v38
    v_max_f32 v20, v36, v39
    v_mov_b32 v60, 0
    v_max3_f32 v40, v40, v41, v42
    v_max_f32 v21, v40, v43
    v_mov_b32 v61, 0
    v_max3_f32 v44, v44, v45, v46
    v_max_f32 v1, v44, v47
    v_mov_b32 v62, 0
    v_sub_f32 v64, v64, v20
    v_sub_f32 v65, v65, v20
    v_sub_f32 v66, v66, v20
    v_sub_f32 v67, v67, v20
    v_sub_f32 v68, v68, v20
    v_sub_f32 v69, v69, v20
    v_sub_f32 v70, v70, v20
    v_sub_f32 v71, v71, v20
    v_sub_f32 v72, v72, v20
    v_sub_f32 v73, v73, v20
    v_sub_f32 v74, v74, v20
    v_sub_f32 v75, v75, v20
    v_sub_f32 v76, v76, v20
    v_sub_f32 v77, v77, v20
    v_sub_f32 v78, v78, v20
    v_sub_f32 v79, v79, v20
    v_exp_f32 v64, v64
    v_exp_f32 v65, v65
    v_exp_f32 v66, v66
    v_exp_f32 v67, v67
    v_exp_f32 v68, v68
    v_exp_f32 v69, v69
    v_exp_f32 v70, v70
    v_exp_f32 v71, v71
    v_exp_f32 v72, v72
    v_exp_f32 v73, v73
    v_exp_f32 v74, v74
    v_exp_f32 v75, v75
    v_exp_f32 v76, v76
    v_exp_f32 v77, v77
    v_exp_f32 v78, v78
    v_exp_f32 v79, v79
    v_add_f32 v60, v60, v64
    v_add_f32 v60, v60, v65
    v_cvt_pk_bf16_f32 v64, v64, v65
    v_add_f32 v60, v60, v66
    v_add_f32 v60, v60, v67
    v_cvt_pk_bf16_f32 v65, v66, v67
    v_add_f32 v60, v60, v68
    v_add_f32 v60, v60, v69
    v_cvt_pk_bf16_f32 v66, v68, v69
    v_add_f32 v60, v60, v70
    v_add_f32 v60, v60, v71
    v_cvt_pk_bf16_f32 v67, v70, v71
    v_add_f32 v60, v60, v72
    v_add_f32 v60, v60, v73
    v_cvt_pk_bf16_f32 v68, v72, v73
    v_add_f32 v60, v60, v74
    v_add_f32 v60, v60, v75
    v_cvt_pk_bf16_f32 v69, v74, v75
    v_add_f32 v60, v60, v76
    v_add_f32 v60, v60, v77
    v_cvt_pk_bf16_f32 v70, v76, v77
    v_add_f32 v60, v60, v78
    v_add_f32 v60, v60, v79
    v_cvt_pk_bf16_f32 v71, v78, v79
    v_sub_f32 v80, v80, v21
    v_sub_f32 v81, v81, v21
    v_sub_f32 v82, v82, v21
    v_sub_f32 v83, v83, v21
    v_sub_f32 v84, v84, v21
    v_sub_f32 v85, v85, v21
    v_sub_f32 v86, v86, v21
    v_sub_f32 v87, v87, v21
    v_sub_f32 v88, v88, v21
    v_sub_f32 v89, v89, v21
    v_sub_f32 v90, v90, v21
    v_sub_f32 v91, v91, v21
    v_sub_f32 v92, v92, v21
    v_sub_f32 v93, v93, v21
    v_sub_f32 v94, v94, v21
    v_sub_f32 v95, v95, v21
    v_exp_f32 v80, v80
    v_exp_f32 v81, v81
    v_exp_f32 v82, v82
    v_exp_f32 v83, v83
    v_exp_f32 v84, v84
    v_exp_f32 v85, v85
    v_exp_f32 v86, v86
    v_exp_f32 v87, v87
    v_exp_f32 v88, v88
    v_exp_f32 v89, v89
    v_exp_f32 v90, v90
    v_exp_f32 v91, v91
    v_exp_f32 v92, v92
    v_exp_f32 v93, v93
    v_exp_f32 v94, v94
    v_exp_f32 v95, v95
    v_add_f32 v61, v61, v80
    v_add_f32 v61, v61, v81
    v_cvt_pk_bf16_f32 v80, v80, v81
    v_add_f32 v61, v61, v82
    v_add_f32 v61, v61, v83
    v_cvt_pk_bf16_f32 v81, v82, v83
    v_add_f32 v61, v61, v84
    v_add_f32 v61, v61, v85
    v_cvt_pk_bf16_f32 v82, v84, v85
    v_add_f32 v61, v61, v86
    v_add_f32 v61, v61, v87
    v_cvt_pk_bf16_f32 v83, v86, v87
    v_add_f32 v61, v61, v88
    v_add_f32 v61, v61, v89
    v_cvt_pk_bf16_f32 v84, v88, v89
    v_add_f32 v61, v61, v90
    v_add_f32 v61, v61, v91
    v_cvt_pk_bf16_f32 v85, v90, v91
    v_add_f32 v61, v61, v92
    v_add_f32 v61, v61, v93
    v_cvt_pk_bf16_f32 v86, v92, v93
    v_add_f32 v61, v61, v94
    v_add_f32 v61, v61, v95
    v_cvt_pk_bf16_f32 v87, v94, v95
    v_sub_f32 v96, v96, v1
    v_sub_f32 v97, v97, v1
    v_sub_f32 v98, v98, v1
    v_sub_f32 v99, v99, v1
    v_sub_f32 v100, v100, v1
    v_sub_f32 v101, v101, v1
    v_sub_f32 v102, v102, v1
    v_sub_f32 v103, v103, v1
    v_sub_f32 v104, v104, v1
    v_sub_f32 v105, v105, v1
    v_sub_f32 v106, v106, v1
    v_sub_f32 v107, v107, v1
    v_sub_f32 v108, v108, v1
    v_sub_f32 v109, v109, v1
    v_sub_f32 v110, v110, v1
    v_sub_f32 v111, v111, v1
    v_exp_f32 v96, v96
    v_exp_f32 v97, v97
    v_exp_f32 v98, v98
    v_exp_f32 v99, v99
    v_exp_f32 v100, v100
    v_exp_f32 v101, v101
    v_exp_f32 v102, v102
    v_exp_f32 v103, v103
    v_exp_f32 v104, v104
    v_exp_f32 v105, v105
    v_exp_f32 v106, v106
    v_exp_f32 v107, v107
    v_exp_f32 v108, v108
    v_exp_f32 v109, v109
    v_exp_f32 v110, v110
    v_exp_f32 v111, v111
    v_add_f32 v62, v62, v96
    v_add_f32 v62, v62, v97
    v_cvt_pk_bf16_f32 v96, v96, v97
    v_add_f32 v62, v62, v98
    v_add_f32 v62, v62, v99
    v_cvt_pk_bf16_f32 v97, v98, v99
    v_add_f32 v62, v62, v100
    v_add_f32 v62, v62, v101
    v_cvt_pk_bf16_f32 v98, v100, v101
    v_add_f32 v62, v62, v102
    v_add_f32 v62, v62, v103
    v_cvt_pk_bf16_f32 v99, v102, v103
    v_add_f32 v62, v62, v104
    v_add_f32 v62, v62, v105
    v_cvt_pk_bf16_f32 v100, v104, v105
    v_add_f32 v62, v62, v106
    v_add_f32 v62, v62, v107
    v_cvt_pk_bf16_f32 v101, v106, v107
    v_add_f32 v62, v62, v108
    v_add_f32 v62, v62, v109
    v_cvt_pk_bf16_f32 v102, v108, v109
    v_add_f32 v62, v62, v110
    v_add_f32 v62, v62, v111
    v_cvt_pk_bf16_f32 v103, v110, v111
    v_sub_f32 v112, v112, v20
    v_sub_f32 v113, v113, v20
    v_sub_f32 v114, v114, v20
    v_sub_f32 v115, v115, v20
    v_sub_f32 v116, v116, v20
    v_sub_f32 v117, v117, v20
    v_sub_f32 v118, v118, v20
    v_sub_f32 v119, v119, v20
    v_sub_f32 v120, v120, v20
    v_sub_f32 v121, v121, v20
    v_sub_f32 v122, v122, v20
    v_sub_f32 v123, v123, v20
    v_sub_f32 v124, v124, v20
    v_sub_f32 v125, v125, v20
    v_sub_f32 v126, v126, v20
    v_sub_f32 v127, v127, v20
    v_exp_f32 v112, v112
    v_exp_f32 v113, v113
    v_exp_f32 v114, v114
    v_exp_f32 v115, v115
    v_exp_f32 v116, v116
    v_exp_f32 v117, v117
    v_exp_f32 v118, v118
    v_exp_f32 v119, v119
    v_exp_f32 v120, v120
    v_exp_f32 v121, v121
    v_exp_f32 v122, v122
    v_exp_f32 v123, v123
    v_exp_f32 v124, v124
    v_exp_f32 v125, v125
    v_exp_f32 v126, v126
    v_exp_f32 v127, v127
    v_add_f32 v60, v60, v112
    v_add_f32 v60, v60, v113
    v_cvt_pk_bf16_f32 v112, v112, v113
    v_add_f32 v60, v60, v114
    v_add_f32 v60, v60, v115
    v_cvt_pk_bf16_f32 v113, v114, v115
    v_add_f32 v60, v60, v116
    v_add_f32 v60, v60, v117
    v_cvt_pk_bf16_f32 v114, v116, v117
    v_add_f32 v60, v60, v118
    v_add_f32 v60, v60, v119
    v_cvt_pk_bf16_f32 v115, v118, v119
    v_add_f32 v60, v60, v120
    v_add_f32 v60, v60, v121
    v_cvt_pk_bf16_f32 v116, v120, v121
    v_add_f32 v60, v60, v122
    v_add_f32 v60, v60, v123
    v_cvt_pk_bf16_f32 v117, v122, v123
    v_add_f32 v60, v60, v124
    v_add_f32 v60, v60, v125
    v_cvt_pk_bf16_f32 v118, v124, v125
    v_add_f32 v60, v60, v126
    v_add_f32 v60, v60, v127
    v_cvt_pk_bf16_f32 v119, v126, v127
    v_sub_f32 v128, v128, v21
    v_sub_f32 v129, v129, v21
    v_sub_f32 v130, v130, v21
    v_sub_f32 v131, v131, v21
    v_sub_f32 v132, v132, v21
    v_sub_f32 v133, v133, v21
    v_sub_f32 v134, v134, v21
    v_sub_f32 v135, v135, v21
    v_sub_f32 v136, v136, v21
    v_sub_f32 v137, v137, v21
    v_sub_f32 v138, v138, v21
    v_sub_f32 v139, v139, v21
    v_sub_f32 v140, v140, v21
    v_sub_f32 v141, v141, v21
    v_sub_f32 v142, v142, v21
    v_sub_f32 v143, v143, v21
    v_exp_f32 v128, v128
    v_exp_f32 v129, v129
    v_exp_f32 v130, v130
    v_exp_f32 v131, v131
    v_exp_f32 v132, v132
    v_exp_f32 v133, v133
    v_exp_f32 v134, v134
    v_exp_f32 v135, v135
    v_exp_f32 v136, v136
    v_exp_f32 v137, v137
    v_exp_f32 v138, v138
    v_exp_f32 v139, v139
    v_exp_f32 v140, v140
    v_exp_f32 v141, v141
    v_exp_f32 v142, v142
    v_exp_f32 v143, v143
    v_add_f32 v61, v61, v128
    v_add_f32 v61, v61, v129
    v_cvt_pk_bf16_f32 v128, v128, v129
    v_add_f32 v61, v61, v130
    v_add_f32 v61, v61, v131
    v_cvt_pk_bf16_f32 v129, v130, v131
    v_add_f32 v61, v61, v132
    v_add_f32 v61, v61, v133
    v_cvt_pk_bf16_f32 v130, v132, v133
    v_add_f32 v61, v61, v134
    v_add_f32 v61, v61, v135
    v_cvt_pk_bf16_f32 v131, v134, v135
    v_add_f32 v61, v61, v136
    v_add_f32 v61, v61, v137
    v_cvt_pk_bf16_f32 v132, v136, v137
    v_add_f32 v61, v61, v138
    v_add_f32 v61, v61, v139
    v_cvt_pk_bf16_f32 v133, v138, v139
    v_add_f32 v61, v61, v140
    v_add_f32 v61, v61, v141
    v_cvt_pk_bf16_f32 v134, v140, v141
    v_add_f32 v61, v61, v142
    v_add_f32 v61, v61, v143
    v_cvt_pk_bf16_f32 v135, v142, v143
    v_sub_f32 v144, v144, v1
    v_sub_f32 v145, v145, v1
    v_sub_f32 v146, v146, v1
    v_sub_f32 v147, v147, v1
    v_sub_f32 v148, v148, v1
    v_sub_f32 v149, v149, v1
    v_sub_f32 v150, v150, v1
    v_sub_f32 v151, v151, v1
    v_sub_f32 v152, v152, v1
    v_sub_f32 v153, v153, v1
    v_sub_f32 v154, v154, v1
    v_sub_f32 v155, v155, v1
    v_sub_f32 v156, v156, v1
    v_sub_f32 v157, v157, v1
    v_sub_f32 v158, v158, v1
    v_sub_f32 v159, v159, v1
    v_exp_f32 v144, v144
    v_exp_f32 v145, v145
    v_exp_f32 v146, v146
    v_exp_f32 v147, v147
    v_exp_f32 v148, v148
    v_exp_f32 v149, v149
    v_exp_f32 v150, v150
    v_exp_f32 v151, v151
    v_exp_f32 v152, v152
    v_exp_f32 v153, v153
    v_exp_f32 v154, v154
    v_exp_f32 v155, v155
    v_exp_f32 v156, v156
    v_exp_f32 v157, v157
    v_exp_f32 v158, v158
    v_exp_f32 v159, v159
    v_add_f32 v62, v62, v144
    v_add_f32 v62, v62, v145
    v_cvt_pk_bf16_f32 v144, v144, v145
    v_add_f32 v62, v62, v146
    v_add_f32 v62, v62, v147
    v_cvt_pk_bf16_f32 v145, v146, v147
    v_add_f32 v62, v62, v148
    v_add_f32 v62, v62, v149
    v_cvt_pk_bf16_f32 v146, v148, v149
    v_add_f32 v62, v62, v150
    v_add_f32 v62, v62, v151
    v_cvt_pk_bf16_f32 v147, v150, v151
    v_add_f32 v62, v62, v152
    v_add_f32 v62, v62, v153
    v_cvt_pk_bf16_f32 v148, v152, v153
    v_add_f32 v62, v62, v154
    v_add_f32 v62, v62, v155
    v_cvt_pk_bf16_f32 v149, v154, v155
    v_add_f32 v62, v62, v156
    v_add_f32 v62, v62, v157
    v_cvt_pk_bf16_f32 v150, v156, v157
    v_add_f32 v62, v62, v158
    v_add_f32 v62, v62, v159
    v_cvt_pk_bf16_f32 v151, v158, v159
    v_sub_f32 v160, v160, v20
    v_sub_f32 v161, v161, v20
    v_sub_f32 v162, v162, v20
    v_sub_f32 v163, v163, v20
    v_sub_f32 v164, v164, v20
    v_sub_f32 v165, v165, v20
    v_sub_f32 v166, v166, v20
    v_sub_f32 v167, v167, v20
    v_sub_f32 v168, v168, v20
    v_sub_f32 v169, v169, v20
    v_sub_f32 v170, v170, v20
    v_sub_f32 v171, v171, v20
    v_sub_f32 v172, v172, v20
    v_sub_f32 v173, v173, v20
    v_sub_f32 v174, v174, v20
    v_sub_f32 v175, v175, v20
    v_exp_f32 v160, v160
    v_exp_f32 v161, v161
    v_exp_f32 v162, v162
    v_exp_f32 v163, v163
    v_exp_f32 v164, v164
    v_exp_f32 v165, v165
    v_exp_f32 v166, v166
    v_exp_f32 v167, v167
    v_exp_f32 v168, v168
    v_exp_f32 v169, v169
    v_exp_f32 v170, v170
    v_exp_f32 v171, v171
    v_exp_f32 v172, v172
    v_exp_f32 v173, v173
    v_exp_f32 v174, v174
    v_exp_f32 v175, v175
    v_add_f32 v60, v60, v160
    v_add_f32 v60, v60, v161
    v_cvt_pk_bf16_f32 v160, v160, v161
    v_add_f32 v60, v60, v162
    v_add_f32 v60, v60, v163
    v_cvt_pk_bf16_f32 v161, v162, v163
    v_add_f32 v60, v60, v164
    v_add_f32 v60, v60, v165
    v_cvt_pk_bf16_f32 v162, v164, v165
    v_add_f32 v60, v60, v166
    v_add_f32 v60, v60, v167
    v_cvt_pk_bf16_f32 v163, v166, v167
    v_add_f32 v60, v60, v168
    v_add_f32 v60, v60, v169
    v_cvt_pk_bf16_f32 v164, v168, v169
    v_add_f32 v60, v60, v170
    v_add_f32 v60, v60, v171
    v_cvt_pk_bf16_f32 v165, v170, v171
    v_add_f32 v60, v60, v172
    v_add_f32 v60, v60, v173
    v_cvt_pk_bf16_f32 v166, v172, v173
    v_add_f32 v60, v60, v174
    v_add_f32 v60, v60, v175
    v_cvt_pk_bf16_f32 v167, v174, v175
    v_sub_f32 v176, v176, v21
    v_sub_f32 v177, v177, v21
    v_sub_f32 v178, v178, v21
    v_sub_f32 v179, v179, v21
    v_sub_f32 v180, v180, v21
    v_sub_f32 v181, v181, v21
    v_sub_f32 v182, v182, v21
    v_sub_f32 v183, v183, v21
    v_sub_f32 v184, v184, v21
    v_sub_f32 v185, v185, v21
    v_sub_f32 v186, v186, v21
    v_sub_f32 v187, v187, v21
    v_sub_f32 v188, v188, v21
    v_sub_f32 v189, v189, v21
    v_sub_f32 v190, v190, v21
    v_sub_f32 v191, v191, v21
    v_exp_f32 v176, v176
    v_exp_f32 v177, v177
    v_exp_f32 v178, v178
    v_exp_f32 v179, v179
    v_exp_f32 v180, v180
    v_exp_f32 v181, v181
    v_exp_f32 v182, v182
    v_exp_f32 v183, v183
    v_exp_f32 v184, v184
    v_exp_f32 v185, v185
    v_exp_f32 v186, v186
    v_exp_f32 v187, v187
    v_exp_f32 v188, v188
    v_exp_f32 v189, v189
    v_exp_f32 v190, v190
    v_exp_f32 v191, v191
    v_add_f32 v61, v61, v176
    v_add_f32 v61, v61, v177
    v_cvt_pk_bf16_f32 v176, v176, v177
    v_add_f32 v61, v61, v178
    v_add_f32 v61, v61, v179
    v_cvt_pk_bf16_f32 v177, v178, v179
    v_add_f32 v61, v61, v180
    v_add_f32 v61, v61, v181
    v_cvt_pk_bf16_f32 v178, v180, v181
    v_add_f32 v61, v61, v182
    v_add_f32 v61, v61, v183
    v_cvt_pk_bf16_f32 v179, v182, v183
    v_add_f32 v61, v61, v184
    v_add_f32 v61, v61, v185
    v_cvt_pk_bf16_f32 v180, v184, v185
    v_add_f32 v61, v61, v186
    v_add_f32 v61, v61, v187
    v_cvt_pk_bf16_f32 v181, v186, v187
    v_add_f32 v61, v61, v188
    v_add_f32 v61, v61, v189
    v_cvt_pk_bf16_f32 v182, v188, v189
    v_add_f32 v61, v61, v190
    v_add_f32 v61, v61, v191
    v_cvt_pk_bf16_f32 v183, v190, v191
    v_sub_f32 v192, v192, v1
    v_sub_f32 v193, v193, v1
    v_sub_f32 v194, v194, v1
    v_sub_f32 v195, v195, v1
    v_sub_f32 v196, v196, v1
    v_sub_f32 v197, v197, v1
    v_sub_f32 v198, v198, v1
    v_sub_f32 v199, v199, v1
    v_sub_f32 v200, v200, v1
    v_sub_f32 v201, v201, v1
    v_sub_f32 v202, v202, v1
    v_sub_f32 v203, v203, v1
    v_sub_f32 v204, v204, v1
    v_sub_f32 v205, v205, v1
    v_sub_f32 v206, v206, v1
    v_sub_f32 v207, v207, v1
    v_exp_f32 v192, v192
    v_exp_f32 v193, v193
    v_exp_f32 v194, v194
    v_exp_f32 v195, v195
    v_exp_f32 v196, v196
    v_exp_f32 v197, v197
    v_exp_f32 v198, v198
    v_exp_f32 v199, v199
    v_exp_f32 v200, v200
    v_exp_f32 v201, v201
    v_exp_f32 v202, v202
    v_exp_f32 v203, v203
    v_exp_f32 v204, v204
    v_exp_f32 v205, v205
    v_exp_f32 v206, v206
    v_exp_f32 v207, v207
    v_add_f32 v62, v62, v192
    v_add_f32 v62, v62, v193
    v_cvt_pk_bf16_f32 v192, v192, v193
    v_add_f32 v62, v62, v194
    v_add_f32 v62, v62, v195
    v_cvt_pk_bf16_f32 v193, v194, v195
    v_add_f32 v62, v62, v196
    v_add_f32 v62, v62, v197
    v_cvt_pk_bf16_f32 v194, v196, v197
    v_add_f32 v62, v62, v198
    v_add_f32 v62, v62, v199
    v_cvt_pk_bf16_f32 v195, v198, v199
    v_add_f32 v62, v62, v200
    v_add_f32 v62, v62, v201
    v_cvt_pk_bf16_f32 v196, v200, v201
    v_add_f32 v62, v62, v202
    v_add_f32 v62, v62, v203
    v_cvt_pk_bf16_f32 v197, v202, v203
    v_add_f32 v62, v62, v204
    v_add_f32 v62, v62, v205
    v_cvt_pk_bf16_f32 v198, v204, v205
    v_add_f32 v62, v62, v206
    v_add_f32 v62, v62, v207
    v_cvt_pk_bf16_f32 v199, v206, v207
    v_sub_f32 v208, v208, v20
    v_sub_f32 v209, v209, v20
    v_sub_f32 v210, v210, v20
    v_sub_f32 v211, v211, v20
    v_sub_f32 v212, v212, v20
    v_sub_f32 v213, v213, v20
    v_sub_f32 v214, v214, v20
    v_sub_f32 v215, v215, v20
    v_sub_f32 v216, v216, v20
    v_sub_f32 v217, v217, v20
    v_sub_f32 v218, v218, v20
    v_sub_f32 v219, v219, v20
    v_sub_f32 v220, v220, v20
    v_sub_f32 v221, v221, v20
    v_sub_f32 v222, v222, v20
    v_sub_f32 v223, v223, v20
    v_exp_f32 v208, v208
    v_exp_f32 v209, v209
    v_exp_f32 v210, v210
    v_exp_f32 v211, v211
    v_exp_f32 v212, v212
    v_exp_f32 v213, v213
    v_exp_f32 v214, v214
    v_exp_f32 v215, v215
    v_exp_f32 v216, v216
    v_exp_f32 v217, v217
    v_exp_f32 v218, v218
    v_exp_f32 v219, v219
    v_exp_f32 v220, v220
    v_exp_f32 v221, v221
    v_exp_f32 v222, v222
    v_exp_f32 v223, v223
    v_add_f32 v60, v60, v208
    v_add_f32 v60, v60, v209
    v_cvt_pk_bf16_f32 v208, v208, v209
    v_add_f32 v60, v60, v210
    v_add_f32 v60, v60, v211
    v_cvt_pk_bf16_f32 v209, v210, v211
    v_add_f32 v60, v60, v212
    v_add_f32 v60, v60, v213
    v_cvt_pk_bf16_f32 v210, v212, v213
    v_add_f32 v60, v60, v214
    v_add_f32 v60, v60, v215
    v_cvt_pk_bf16_f32 v211, v214, v215
    v_add_f32 v60, v60, v216
    v_add_f32 v60, v60, v217
    v_cvt_pk_bf16_f32 v212, v216, v217
    v_add_f32 v60, v60, v218
    v_add_f32 v60, v60, v219
    v_cvt_pk_bf16_f32 v213, v218, v219
    v_add_f32 v60, v60, v220
    v_add_f32 v60, v60, v221
    v_cvt_pk_bf16_f32 v214, v220, v221
    v_add_f32 v60, v60, v222
    v_add_f32 v60, v60, v223
    v_cvt_pk_bf16_f32 v215, v222, v223
    v_sub_f32 v224, v224, v21
    v_sub_f32 v225, v225, v21
    v_sub_f32 v226, v226, v21
    v_sub_f32 v227, v227, v21
    v_sub_f32 v228, v228, v21
    v_sub_f32 v229, v229, v21
    v_sub_f32 v230, v230, v21
    v_sub_f32 v231, v231, v21
    v_sub_f32 v232, v232, v21
    v_sub_f32 v233, v233, v21
    v_sub_f32 v234, v234, v21
    v_sub_f32 v235, v235, v21
    v_sub_f32 v236, v236, v21
    v_sub_f32 v237, v237, v21
    v_sub_f32 v238, v238, v21
    v_sub_f32 v239, v239, v21
    v_exp_f32 v224, v224
    v_exp_f32 v225, v225
    v_exp_f32 v226, v226
    v_exp_f32 v227, v227
    v_exp_f32 v228, v228
    v_exp_f32 v229, v229
    v_exp_f32 v230, v230
    v_exp_f32 v231, v231
    v_exp_f32 v232, v232
    v_exp_f32 v233, v233
    v_exp_f32 v234, v234
    v_exp_f32 v235, v235
    v_exp_f32 v236, v236
    v_exp_f32 v237, v237
    v_exp_f32 v238, v238
    v_exp_f32 v239, v239
    v_add_f32 v61, v61, v224
    v_add_f32 v61, v61, v225
    v_cvt_pk_bf16_f32 v224, v224, v225
    v_add_f32 v61, v61, v226
    v_add_f32 v61, v61, v227
    v_cvt_pk_bf16_f32 v225, v226, v227
    v_add_f32 v61, v61, v228
    v_add_f32 v61, v61, v229
    v_cvt_pk_bf16_f32 v226, v228, v229
    v_add_f32 v61, v61, v230
    v_add_f32 v61, v61, v231
    v_cvt_pk_bf16_f32 v227, v230, v231
    v_add_f32 v61, v61, v232
    v_add_f32 v61, v61, v233
    v_cvt_pk_bf16_f32 v228, v232, v233
    v_add_f32 v61, v61, v234
    v_add_f32 v61, v61, v235
    v_cvt_pk_bf16_f32 v229, v234, v235
    v_add_f32 v61, v61, v236
    v_add_f32 v61, v61, v237
    v_cvt_pk_bf16_f32 v230, v236, v237
    v_add_f32 v61, v61, v238
    v_add_f32 v61, v61, v239
    v_cvt_pk_bf16_f32 v231, v238, v239
    v_sub_f32 v240, v240, v1
    v_sub_f32 v241, v241, v1
    v_sub_f32 v242, v242, v1
    v_sub_f32 v243, v243, v1
    v_sub_f32 v244, v244, v1
    v_sub_f32 v245, v245, v1
    v_sub_f32 v246, v246, v1
    v_sub_f32 v247, v247, v1
    v_sub_f32 v248, v248, v1
    v_sub_f32 v249, v249, v1
    v_sub_f32 v250, v250, v1
    v_sub_f32 v251, v251, v1
    v_sub_f32 v252, v252, v1
    v_sub_f32 v253, v253, v1
    v_sub_f32 v254, v254, v1
    v_sub_f32 v255, v255, v1
    v_exp_f32 v240, v240
    v_exp_f32 v241, v241
    v_exp_f32 v242, v242
    v_exp_f32 v243, v243
    v_exp_f32 v244, v244
    v_exp_f32 v245, v245
    v_exp_f32 v246, v246
    v_exp_f32 v247, v247
    v_exp_f32 v248, v248
    v_exp_f32 v249, v249
    v_exp_f32 v250, v250
    v_exp_f32 v251, v251
    v_exp_f32 v252, v252
    v_exp_f32 v253, v253
    v_exp_f32 v254, v254
    v_exp_f32 v255, v255
    v_add_f32 v62, v62, v240
    v_add_f32 v62, v62, v241
    v_cvt_pk_bf16_f32 v240, v240, v241
    v_add_f32 v62, v62, v242
    v_add_f32 v62, v62, v243
    v_cvt_pk_bf16_f32 v241, v242, v243
    v_add_f32 v62, v62, v244
    v_add_f32 v62, v62, v245
    v_cvt_pk_bf16_f32 v242, v244, v245
    v_add_f32 v62, v62, v246
    v_add_f32 v62, v62, v247
    v_cvt_pk_bf16_f32 v243, v246, v247
    v_add_f32 v62, v62, v248
    v_add_f32 v62, v62, v249
    v_cvt_pk_bf16_f32 v244, v248, v249
    v_add_f32 v62, v62, v250
    v_add_f32 v62, v62, v251
    v_cvt_pk_bf16_f32 v245, v250, v251
    v_add_f32 v62, v62, v252
    v_add_f32 v62, v62, v253
    v_cvt_pk_bf16_f32 v246, v252, v253
    v_add_f32 v62, v62, v254
    v_add_f32 v62, v62, v255
    v_cvt_pk_bf16_f32 v247, v254, v255
    v_mov_b32 v32, v60
    v_mov_b32 v33, v61
    v_mov_b32 v34, v62
    v_permlane32_swap_b32 v60, v32
    v_permlane32_swap_b32 v61, v33
    v_permlane32_swap_b32 v62, v34
    v_add_f32 v60, v60, v32
    v_add_f32 v61, v61, v33
    v_add_f32 v62, v62, v34
    ds_write_b32 v26, v60 offset:1536
    ds_write_b32 v26, v61 offset:2048
    ds_write_b32 v26, v62 offset:2560
    s_waitcnt vmcnt(0)
    ds_write_b128 v24, v[64:67] offset:0
    ds_write_b128 v24, v[80:83] offset:1024
    ds_write_b128 v24, v[96:99] offset:2048
    ds_write_b128 v24, v[68:71] offset:12288
    ds_write_b128 v24, v[84:87] offset:13312
    ds_write_b128 v24, v[100:103] offset:14336
    s_waitcnt lgkmcnt(0)
    s_barrier
    ds_read_b64_tr_b16 v[32:33], v22 offset:0
    ds_read_b64_tr_b16 v[34:35], v22 offset:2048
    ds_read_b128 v[36:39], v25 offset:0
    ds_read_b128 v[40:43], v25 offset:1024
    ds_read_b128 v[44:47], v25 offset:2048
    s_waitcnt lgkmcnt(0)
    v_mfma_f32_32x32x16_bf16 a[192:207], v[32:35], v[36:39], 0
    v_mfma_f32_32x32x16_bf16 a[208:223], v[32:35], v[40:43], 0
    v_mfma_f32_32x32x16_bf16 a[224:239], v[32:35], v[44:47], 0
    ds_read_b64_tr_b16 v[32:33], v22 offset:32768
    ds_read_b64_tr_b16 v[34:35], v22 offset:34816
    ds_read_b128 v[36:39], v25 offset:3072
    ds_read_b128 v[40:43], v25 offset:4096
    ds_read_b128 v[44:47], v25 offset:5120
    s_waitcnt lgkmcnt(0)
    v_mfma_f32_32x32x16_bf16 a[192:207], v[32:35], v[36:39], a[192:207]
    v_mfma_f32_32x32x16_bf16 a[208:223], v[32:35], v[40:43], a[208:223]
    v_mfma_f32_32x32x16_bf16 a[224:239], v[32:35], v[44:47], a[224:239]
    ds_read_b64_tr_b16 v[32:33], v23 offset:0
    ds_read_b64_tr_b16 v[34:35], v23 offset:2048
    ds_read_b128 v[36:39], v25 offset:6144
    ds_read_b128 v[40:43], v25 offset:7168
    ds_read_b128 v[44:47], v25 offset:8192
    s_waitcnt lgkmcnt(0)
    v_mfma_f32_32x32x16_bf16 a[192:207], v[32:35], v[36:39], a[192:207]
    v_mfma_f32_32x32x16_bf16 a[208:223], v[32:35], v[40:43], a[208:223]
    v_mfma_f32_32x32x16_bf16 a[224:239], v[32:35], v[44:47], a[224:239]
    ds_read_b64_tr_b16 v[32:33], v23 offset:32768
    ds_read_b64_tr_b16 v[34:35], v23 offset:34816
    ds_read_b128 v[36:39], v25 offset:9216
    ds_read_b128 v[40:43], v25 offset:10240
    ds_read_b128 v[44:47], v25 offset:11264
    s_waitcnt lgkmcnt(0)
    v_mfma_f32_32x32x16_bf16 a[192:207], v[32:35], v[36:39], a[192:207]
    v_mfma_f32_32x32x16_bf16 a[208:223], v[32:35], v[40:43], a[208:223]
    v_mfma_f32_32x32x16_bf16 a[224:239], v[32:35], v[44:47], a[224:239]
    ds_read_b64_tr_b16 v[32:33], v22 offset:4096
    ds_read_b64_tr_b16 v[34:35], v22 offset:6144
    ds_read_b128 v[36:39], v25 offset:12288
    ds_read_b128 v[40:43], v25 offset:13312
    ds_read_b128 v[44:47], v25 offset:14336
    s_waitcnt lgkmcnt(0)
    v_mfma_f32_32x32x16_bf16 a[192:207], v[32:35], v[36:39], a[192:207]
    v_mfma_f32_32x32x16_bf16 a[208:223], v[32:35], v[40:43], a[208:223]
    v_mfma_f32_32x32x16_bf16 a[224:239], v[32:35], v[44:47], a[224:239]
    ds_read_b64_tr_b16 v[32:33], v22 offset:36864
    ds_read_b64_tr_b16 v[34:35], v22 offset:38912
    ds_read_b128 v[36:39], v25 offset:15360
    ds_read_b128 v[40:43], v25 offset:16384
    ds_read_b128 v[44:47], v25 offset:17408
    s_waitcnt lgkmcnt(0)
    v_mfma_f32_32x32x16_bf16 a[192:207], v[32:35], v[36:39], a[192:207]
    v_mfma_f32_32x32x16_bf16 a[208:223], v[32:35], v[40:43], a[208:223]
    v_mfma_f32_32x32x16_bf16 a[224:239], v[32:35], v[44:47], a[224:239]
    ds_read_b64_tr_b16 v[32:33], v23 offset:4096
    ds_read_b64_tr_b16 v[34:35], v23 offset:6144
    ds_read_b128 v[36:39], v25 offset:18432
    ds_read_b128 v[40:43], v25 offset:19456
    ds_read_b128 v[44:47], v25 offset:20480
    s_waitcnt lgkmcnt(0)
    v_mfma_f32_32x32x16_bf16 a[192:207], v[32:35], v[36:39], a[192:207]
    v_mfma_f32_32x32x16_bf16 a[208:223], v[32:35], v[40:43], a[208:223]
    v_mfma_f32_32x32x16_bf16 a[224:239], v[32:35], v[44:47], a[224:239]
    ds_read_b64_tr_b16 v[32:33], v23 offset:36864
    ds_read_b64_tr_b16 v[34:35], v23 offset:38912
    ds_read_b128 v[36:39], v25 offset:21504
    ds_read_b128 v[40:43], v25 offset:22528
    ds_read_b128 v[44:47], v25 offset:23552
    s_waitcnt lgkmcnt(0)
    v_mfma_f32_32x32x16_bf16 a[192:207], v[32:35], v[36:39], a[192:207]
    v_mfma_f32_32x32x16_bf16 a[208:223], v[32:35], v[40:43], a[208:223]
    v_mfma_f32_32x32x16_bf16 a[224:239], v[32:35], v[44:47], a[224:239]
    s_barrier
    ds_write_b128 v24, v[112:115] offset:0
    ds_write_b128 v24, v[128:131] offset:1024
    ds_write_b128 v24, v[144:147] offset:2048
    ds_write_b128 v24, v[116:119] offset:12288
    ds_write_b128 v24, v[132:135] offset:13312
    ds_write_b128 v24, v[148:151] offset:14336
    s_waitcnt lgkmcnt(0)
    s_barrier
    ds_read_b64_tr_b16 v[32:33], v22 offset:8192
    ds_read_b64_tr_b16 v[34:35], v22 offset:10240
    ds_read_b128 v[36:39], v25 offset:0
    ds_read_b128 v[40:43], v25 offset:1024
    ds_read_b128 v[44:47], v25 offset:2048
    s_waitcnt lgkmcnt(0)
    v_mfma_f32_32x32x16_bf16 a[192:207], v[32:35], v[36:39], a[192:207]
    v_mfma_f32_32x32x16_bf16 a[208:223], v[32:35], v[40:43], a[208:223]
    v_mfma_f32_32x32x16_bf16 a[224:239], v[32:35], v[44:47], a[224:239]
    ds_read_b64_tr_b16 v[32:33], v22 offset:40960
    ds_read_b64_tr_b16 v[34:35], v22 offset:43008
    ds_read_b128 v[36:39], v25 offset:3072
    ds_read_b128 v[40:43], v25 offset:4096
    ds_read_b128 v[44:47], v25 offset:5120
    s_waitcnt lgkmcnt(0)
    v_mfma_f32_32x32x16_bf16 a[192:207], v[32:35], v[36:39], a[192:207]
    v_mfma_f32_32x32x16_bf16 a[208:223], v[32:35], v[40:43], a[208:223]
    v_mfma_f32_32x32x16_bf16 a[224:239], v[32:35], v[44:47], a[224:239]
    ds_read_b64_tr_b16 v[32:33], v23 offset:8192
    ds_read_b64_tr_b16 v[34:35], v23 offset:10240
    ds_read_b128 v[36:39], v25 offset:6144
    ds_read_b128 v[40:43], v25 offset:7168
    ds_read_b128 v[44:47], v25 offset:8192
    s_waitcnt lgkmcnt(0)
    v_mfma_f32_32x32x16_bf16 a[192:207], v[32:35], v[36:39], a[192:207]
    v_mfma_f32_32x32x16_bf16 a[208:223], v[32:35], v[40:43], a[208:223]
    v_mfma_f32_32x32x16_bf16 a[224:239], v[32:35], v[44:47], a[224:239]
    ds_read_b64_tr_b16 v[32:33], v23 offset:40960
    ds_read_b64_tr_b16 v[34:35], v23 offset:43008
    ds_read_b128 v[36:39], v25 offset:9216
    ds_read_b128 v[40:43], v25 offset:10240
    ds_read_b128 v[44:47], v25 offset:11264
    s_waitcnt lgkmcnt(0)
    v_mfma_f32_32x32x16_bf16 a[192:207], v[32:35], v[36:39], a[192:207]
    v_mfma_f32_32x32x16_bf16 a[208:223], v[32:35], v[40:43], a[208:223]
    v_mfma_f32_32x32x16_bf16 a[224:239], v[32:35], v[44:47], a[224:239]
    ds_read_b64_tr_b16 v[32:33], v22 offset:12288
    ds_read_b64_tr_b16 v[34:35], v22 offset:14336
    ds_read_b128 v[36:39], v25 offset:12288
    ds_read_b128 v[40:43], v25 offset:13312
    ds_read_b128 v[44:47], v25 offset:14336
    s_waitcnt lgkmcnt(0)
    v_mfma_f32_32x32x16_bf16 a[192:207], v[32:35], v[36:39], a[192:207]
    v_mfma_f32_32x32x16_bf16 a[208:223], v[32:35], v[40:43], a[208:223]
    v_mfma_f32_32x32x16_bf16 a[224:239], v[32:35], v[44:47], a[224:239]
    ds_read_b64_tr_b16 v[32:33], v22 offset:45056
    ds_read_b64_tr_b16 v[34:35], v22 offset:47104
    ds_read_b128 v[36:39], v25 offset:15360
    ds_read_b128 v[40:43], v25 offset:16384
    ds_read_b128 v[44:47], v25 offset:17408
    s_waitcnt lgkmcnt(0)
    v_mfma_f32_32x32x16_bf16 a[192:207], v[32:35], v[36:39], a[192:207]
    v_mfma_f32_32x32x16_bf16 a[208:223], v[32:35], v[40:43], a[208:223]
    v_mfma_f32_32x32x16_bf16 a[224:239], v[32:35], v[44:47], a[224:239]
    ds_read_b64_tr_b16 v[32:33], v23 offset:12288
    ds_read_b64_tr_b16 v[34:35], v23 offset:14336
    ds_read_b128 v[36:39], v25 offset:18432
    ds_read_b128 v[40:43], v25 offset:19456
    ds_read_b128 v[44:47], v25 offset:20480
    s_waitcnt lgkmcnt(0)
    v_mfma_f32_32x32x16_bf16 a[192:207], v[32:35], v[36:39], a[192:207]
    v_mfma_f32_32x32x16_bf16 a[208:223], v[32:35], v[40:43], a[208:223]
    v_mfma_f32_32x32x16_bf16 a[224:239], v[32:35], v[44:47], a[224:239]
    ds_read_b64_tr_b16 v[32:33], v23 offset:45056
    ds_read_b64_tr_b16 v[34:35], v23 offset:47104
    ds_read_b128 v[36:39], v25 offset:21504
    ds_read_b128 v[40:43], v25 offset:22528
    ds_read_b128 v[44:47], v25 offset:23552
    s_waitcnt lgkmcnt(0)
    v_mfma_f32_32x32x16_bf16 a[192:207], v[32:35], v[36:39], a[192:207]
    v_mfma_f32_32x32x16_bf16 a[208:223], v[32:35], v[40:43], a[208:223]
    v_mfma_f32_32x32x16_bf16 a[224:239], v[32:35], v[44:47], a[224:239]
    s_barrier
    ds_write_b128 v24, v[160:163] offset:0
    ds_write_b128 v24, v[176:179] offset:1024
    ds_write_b128 v24, v[192:195] offset:2048
    ds_write_b128 v24, v[164:167] offset:12288
    ds_write_b128 v24, v[180:183] offset:13312
    ds_write_b128 v24, v[196:199] offset:14336
    s_waitcnt lgkmcnt(0)
    s_barrier
    ds_read_b64_tr_b16 v[32:33], v22 offset:16384
    ds_read_b64_tr_b16 v[34:35], v22 offset:18432
    ds_read_b128 v[36:39], v25 offset:0
    ds_read_b128 v[40:43], v25 offset:1024
    ds_read_b128 v[44:47], v25 offset:2048
    s_waitcnt lgkmcnt(0)
    v_mfma_f32_32x32x16_bf16 a[192:207], v[32:35], v[36:39], a[192:207]
    v_mfma_f32_32x32x16_bf16 a[208:223], v[32:35], v[40:43], a[208:223]
    v_mfma_f32_32x32x16_bf16 a[224:239], v[32:35], v[44:47], a[224:239]
    ds_read_b64_tr_b16 v[32:33], v22 offset:49152
    ds_read_b64_tr_b16 v[34:35], v22 offset:51200
    ds_read_b128 v[36:39], v25 offset:3072
    ds_read_b128 v[40:43], v25 offset:4096
    ds_read_b128 v[44:47], v25 offset:5120
    s_waitcnt lgkmcnt(0)
    v_mfma_f32_32x32x16_bf16 a[192:207], v[32:35], v[36:39], a[192:207]
    v_mfma_f32_32x32x16_bf16 a[208:223], v[32:35], v[40:43], a[208:223]
    v_mfma_f32_32x32x16_bf16 a[224:239], v[32:35], v[44:47], a[224:239]
    ds_read_b64_tr_b16 v[32:33], v23 offset:16384
    ds_read_b64_tr_b16 v[34:35], v23 offset:18432
    ds_read_b128 v[36:39], v25 offset:6144
    ds_read_b128 v[40:43], v25 offset:7168
    ds_read_b128 v[44:47], v25 offset:8192
    s_waitcnt lgkmcnt(0)
    v_mfma_f32_32x32x16_bf16 a[192:207], v[32:35], v[36:39], a[192:207]
    v_mfma_f32_32x32x16_bf16 a[208:223], v[32:35], v[40:43], a[208:223]
    v_mfma_f32_32x32x16_bf16 a[224:239], v[32:35], v[44:47], a[224:239]
    ds_read_b64_tr_b16 v[32:33], v23 offset:49152
    ds_read_b64_tr_b16 v[34:35], v23 offset:51200
    ds_read_b128 v[36:39], v25 offset:9216
    ds_read_b128 v[40:43], v25 offset:10240
    ds_read_b128 v[44:47], v25 offset:11264
    s_waitcnt lgkmcnt(0)
    v_mfma_f32_32x32x16_bf16 a[192:207], v[32:35], v[36:39], a[192:207]
    v_mfma_f32_32x32x16_bf16 a[208:223], v[32:35], v[40:43], a[208:223]
    v_mfma_f32_32x32x16_bf16 a[224:239], v[32:35], v[44:47], a[224:239]
    ds_read_b64_tr_b16 v[32:33], v22 offset:20480
    ds_read_b64_tr_b16 v[34:35], v22 offset:22528
    ds_read_b128 v[36:39], v25 offset:12288
    ds_read_b128 v[40:43], v25 offset:13312
    ds_read_b128 v[44:47], v25 offset:14336
    s_waitcnt lgkmcnt(0)
    v_mfma_f32_32x32x16_bf16 a[192:207], v[32:35], v[36:39], a[192:207]
    v_mfma_f32_32x32x16_bf16 a[208:223], v[32:35], v[40:43], a[208:223]
    v_mfma_f32_32x32x16_bf16 a[224:239], v[32:35], v[44:47], a[224:239]
    ds_read_b64_tr_b16 v[32:33], v22 offset:53248
    ds_read_b64_tr_b16 v[34:35], v22 offset:55296
    ds_read_b128 v[36:39], v25 offset:15360
    ds_read_b128 v[40:43], v25 offset:16384
    ds_read_b128 v[44:47], v25 offset:17408
    s_waitcnt lgkmcnt(0)
    v_mfma_f32_32x32x16_bf16 a[192:207], v[32:35], v[36:39], a[192:207]
    v_mfma_f32_32x32x16_bf16 a[208:223], v[32:35], v[40:43], a[208:223]
    v_mfma_f32_32x32x16_bf16 a[224:239], v[32:35], v[44:47], a[224:239]
    ds_read_b64_tr_b16 v[32:33], v23 offset:20480
    ds_read_b64_tr_b16 v[34:35], v23 offset:22528
    ds_read_b128 v[36:39], v25 offset:18432
    ds_read_b128 v[40:43], v25 offset:19456
    ds_read_b128 v[44:47], v25 offset:20480
    s_waitcnt lgkmcnt(0)
    v_mfma_f32_32x32x16_bf16 a[192:207], v[32:35], v[36:39], a[192:207]
    v_mfma_f32_32x32x16_bf16 a[208:223], v[32:35], v[40:43], a[208:223]
    v_mfma_f32_32x32x16_bf16 a[224:239], v[32:35], v[44:47], a[224:239]
    ds_read_b64_tr_b16 v[32:33], v23 offset:53248
    ds_read_b64_tr_b16 v[34:35], v23 offset:55296
    ds_read_b128 v[36:39], v25 offset:21504
    ds_read_b128 v[40:43], v25 offset:22528
    ds_read_b128 v[44:47], v25 offset:23552
    s_waitcnt lgkmcnt(0)
    v_mfma_f32_32x32x16_bf16 a[192:207], v[32:35], v[36:39], a[192:207]
    v_mfma_f32_32x32x16_bf16 a[208:223], v[32:35], v[40:43], a[208:223]
    v_mfma_f32_32x32x16_bf16 a[224:239], v[32:35], v[44:47], a[224:239]
    s_barrier
    ds_write_b128 v24, v[208:211] offset:0
    ds_write_b128 v24, v[224:227] offset:1024
    ds_write_b128 v24, v[240:243] offset:2048
    ds_write_b128 v24, v[212:215] offset:12288
    ds_write_b128 v24, v[228:231] offset:13312
    ds_write_b128 v24, v[244:247] offset:14336
    s_waitcnt lgkmcnt(0)
    s_barrier
    ds_read_b64_tr_b16 v[32:33], v22 offset:24576
    ds_read_b64_tr_b16 v[34:35], v22 offset:26624
    ds_read_b128 v[36:39], v25 offset:0
    ds_read_b128 v[40:43], v25 offset:1024
    ds_read_b128 v[44:47], v25 offset:2048
    s_waitcnt lgkmcnt(0)
    v_mfma_f32_32x32x16_bf16 a[192:207], v[32:35], v[36:39], a[192:207]
    v_mfma_f32_32x32x16_bf16 a[208:223], v[32:35], v[40:43], a[208:223]
    v_mfma_f32_32x32x16_bf16 a[224:239], v[32:35], v[44:47], a[224:239]
    ds_read_b64_tr_b16 v[32:33], v22 offset:57344
    ds_read_b64_tr_b16 v[34:35], v22 offset:59392
    ds_read_b128 v[36:39], v25 offset:3072
    ds_read_b128 v[40:43], v25 offset:4096
    ds_read_b128 v[44:47], v25 offset:5120
    s_waitcnt lgkmcnt(0)
    v_mfma_f32_32x32x16_bf16 a[192:207], v[32:35], v[36:39], a[192:207]
    v_mfma_f32_32x32x16_bf16 a[208:223], v[32:35], v[40:43], a[208:223]
    v_mfma_f32_32x32x16_bf16 a[224:239], v[32:35], v[44:47], a[224:239]
    ds_read_b64_tr_b16 v[32:33], v23 offset:24576
    ds_read_b64_tr_b16 v[34:35], v23 offset:26624
    ds_read_b128 v[36:39], v25 offset:6144
    ds_read_b128 v[40:43], v25 offset:7168
    ds_read_b128 v[44:47], v25 offset:8192
    s_waitcnt lgkmcnt(0)
    v_mfma_f32_32x32x16_bf16 a[192:207], v[32:35], v[36:39], a[192:207]
    v_mfma_f32_32x32x16_bf16 a[208:223], v[32:35], v[40:43], a[208:223]
    v_mfma_f32_32x32x16_bf16 a[224:239], v[32:35], v[44:47], a[224:239]
    ds_read_b64_tr_b16 v[32:33], v23 offset:57344
    ds_read_b64_tr_b16 v[34:35], v23 offset:59392
    ds_read_b128 v[36:39], v25 offset:9216
    ds_read_b128 v[40:43], v25 offset:10240
    ds_read_b128 v[44:47], v25 offset:11264
    s_waitcnt lgkmcnt(0)
    v_mfma_f32_32x32x16_bf16 a[192:207], v[32:35], v[36:39], a[192:207]
    v_mfma_f32_32x32x16_bf16 a[208:223], v[32:35], v[40:43], a[208:223]
    v_mfma_f32_32x32x16_bf16 a[224:239], v[32:35], v[44:47], a[224:239]
    ds_read_b64_tr_b16 v[32:33], v22 offset:28672
    ds_read_b64_tr_b16 v[34:35], v22 offset:30720
    ds_read_b128 v[36:39], v25 offset:12288
    ds_read_b128 v[40:43], v25 offset:13312
    ds_read_b128 v[44:47], v25 offset:14336
    s_waitcnt lgkmcnt(0)
    v_mfma_f32_32x32x16_bf16 a[192:207], v[32:35], v[36:39], a[192:207]
    v_mfma_f32_32x32x16_bf16 a[208:223], v[32:35], v[40:43], a[208:223]
    v_mfma_f32_32x32x16_bf16 a[224:239], v[32:35], v[44:47], a[224:239]
    ds_read_b64_tr_b16 v[32:33], v22 offset:61440
    ds_read_b64_tr_b16 v[34:35], v22 offset:63488
    ds_read_b128 v[36:39], v25 offset:15360
    ds_read_b128 v[40:43], v25 offset:16384
    ds_read_b128 v[44:47], v25 offset:17408
    s_waitcnt lgkmcnt(0)
    v_mfma_f32_32x32x16_bf16 a[192:207], v[32:35], v[36:39], a[192:207]
    v_mfma_f32_32x32x16_bf16 a[208:223], v[32:35], v[40:43], a[208:223]
    v_mfma_f32_32x32x16_bf16 a[224:239], v[32:35], v[44:47], a[224:239]
    ds_read_b64_tr_b16 v[32:33], v23 offset:28672
    ds_read_b64_tr_b16 v[34:35], v23 offset:30720
    ds_read_b128 v[36:39], v25 offset:18432
    ds_read_b128 v[40:43], v25 offset:19456
    ds_read_b128 v[44:47], v25 offset:20480
    s_waitcnt lgkmcnt(0)
    v_mfma_f32_32x32x16_bf16 a[192:207], v[32:35], v[36:39], a[192:207]
    v_mfma_f32_32x32x16_bf16 a[208:223], v[32:35], v[40:43], a[208:223]
    v_mfma_f32_32x32x16_bf16 a[224:239], v[32:35], v[44:47], a[224:239]
    ds_read_b64_tr_b16 v[32:33], v23 offset:61440
    ds_read_b64_tr_b16 v[34:35], v23 offset:63488
    ds_read_b128 v[36:39], v25 offset:21504
    ds_read_b128 v[40:43], v25 offset:22528
    ds_read_b128 v[44:47], v25 offset:23552
    s_waitcnt lgkmcnt(0)
    v_mfma_f32_32x32x16_bf16 a[192:207], v[32:35], v[36:39], a[192:207]
    v_mfma_f32_32x32x16_bf16 a[208:223], v[32:35], v[40:43], a[208:223]
    v_mfma_f32_32x32x16_bf16 a[224:239], v[32:35], v[44:47], a[224:239]
    s_barrier
    v_mbcnt_lo_u32_b32 v48, -1, 0
    v_mbcnt_hi_u32_b32 v48, -1, v48
    v_lshrrev_b32 v49, 4, v48
    v_and_b32 v50, 15, v48
    v_lshrrev_b32 v51, 5, v48
    v_and_b32 v52, 31, v48
    v_lshlrev_b32 v53, 2, v49
    v_xor_b32 v53, v50, v53
    v_lshlrev_b32 v53, 4, v53
    v_lshl_add_u32 v2, v49, 10, v53
    v_add_u32 v3, 3072, v2
    v_add_u32 v4, 6144, v2
    v_add_u32 v5, 9216, v2
    v_lshlrev_b32 v53, 1, v52
    v_lshl_add_u32 v12, v51, 13, v53
    v_add_u32 v1, s28, v7
    v_add_u32 v31, 0x10000, v7
    s_lshl_b32 s26, s24, 11
    v_add_u32 v19, s26, v7
    s_xor_b32 s50, s24, 1
    s_mul_i32 s26, s50, 3072
    v_add_u32 v17, s26, v25
    s_lshl_b32 s26, s50, 15
    v_add_u32 v18, s26, v7
    s_xor_b32 s26, s28, 0x10000
    v_add_u32 v31, s26, v7
    s_and_b32 s26, s24, 1
    s_lshl_b32 s26, s26, 1
    s_lshr_b32 s50, s24, 1
    s_xor_b32 s50, s50, 0
    s_add_u32 s26, s26, s50
    s_xor_b32 s26, s26, s24
    s_lshl_b32 s26, s26, 6
    v_xor_b32 v53, s26, v22
    s_xor_b32 s26, s28, 0
    v_add_u32 v13, s26, v53
    s_and_b32 s26, s24, 1
    s_lshl_b32 s26, s26, 1
    s_lshr_b32 s50, s24, 1
    s_xor_b32 s50, s50, 1
    s_add_u32 s26, s26, s50
    s_xor_b32 s26, s26, s24
    s_lshl_b32 s26, s26, 6
    v_xor_b32 v53, s26, v22
    s_xor_b32 s26, s28, 0
    v_add_u32 v14, s26, v53
    s_and_b32 s26, s24, 1
    s_lshl_b32 s26, s26, 1
    s_lshr_b32 s50, s24, 1
    s_xor_b32 s50, s50, 0
    s_add_u32 s26, s26, s50
    s_xor_b32 s26, s26, s24
    s_lshl_b32 s26, s26, 6
    v_xor_b32 v53, s26, v22
    s_xor_b32 s26, s28, 32768
    v_add_u32 v15, s26, v53
    s_and_b32 s26, s24, 1
    s_lshl_b32 s26, s26, 1
    s_lshr_b32 s50, s24, 1
    s_xor_b32 s50, s50, 1
    s_add_u32 s26, s26, s50
    s_xor_b32 s26, s26, s24
    s_lshl_b32 s26, s26, 6
    v_xor_b32 v53, s26, v22
    s_xor_b32 s26, s28, 32768
    v_add_u32 v16, s26, v53
    s_add_u32 m0, s28, 8192
    s_add_u32 s43, s56, 0
    buffer_load_dwordx4 v2, s[4:7], s43 offen offset:0 lds
    buffer_load_dwordx4 v3, s[4:7], s43 offen offset:1024 lds
    buffer_load_dwordx4 v4, s[4:7], s43 offen offset:2048 lds
    buffer_load_dwordx4 v5, s[4:7], s43 offen offset:3072 lds
    s_add_u32 m0, s28, 12288
    s_add_u32 s43, s56, 16384
    buffer_load_dwordx4 v2, s[4:7], s43 offen offset:0 lds
    buffer_load_dwordx4 v3, s[4:7], s43 offen offset:1024 lds
    buffer_load_dwordx4 v4, s[4:7], s43 offen offset:2048 lds
    buffer_load_dwordx4 v5, s[4:7], s43 offen offset:3072 lds
    s_add_u32 m0, s28, 16384
    s_add_u32 s43, s57, 0
    buffer_load_dwordx4 v2, s[4:7], s43 offen offset:0 lds
    buffer_load_dwordx4 v3, s[4:7], s43 offen offset:1024 lds
    buffer_load_dwordx4 v4, s[4:7], s43 offen offset:2048 lds
    buffer_load_dwordx4 v5, s[4:7], s43 offen offset:3072 lds
    s_add_u32 m0, s28, 20480
    s_add_u32 s43, s57, 16384
    buffer_load_dwordx4 v2, s[4:7], s43 offen offset:0 lds
    buffer_load_dwordx4 v3, s[4:7], s43 offen offset:1024 lds
    buffer_load_dwordx4 v4, s[4:7], s43 offen offset:2048 lds
    buffer_load_dwordx4 v5, s[4:7], s43 offen offset:3072 lds
    s_add_u32 m0, s28, 24576
    s_add_u32 s43, s58, 0
    buffer_load_dwordx4 v2, s[4:7], s43 offen offset:0 lds
    buffer_load_dwordx4 v3, s[4:7], s43 offen offset:1024 lds
    buffer_load_dwordx4 v4, s[4:7], s43 offen offset:2048 lds
    buffer_load_dwordx4 v5, s[4:7], s43 offen offset:3072 lds
    s_add_u32 m0, s28, 28672
    s_add_u32 s43, s58, 16384
    buffer_load_dwordx4 v2, s[4:7], s43 offen offset:0 lds
    buffer_load_dwordx4 v3, s[4:7], s43 offen offset:1024 lds
    buffer_load_dwordx4 v4, s[4:7], s43 offen offset:2048 lds
    buffer_load_dwordx4 v5, s[4:7], s43 offen offset:3072 lds
    ds_read_b128 v[112:115], v27 offset:1536
    ds_read_b128 v[116:119], v27 offset:2048
    ds_read_b128 v[120:123], v27 offset:2560
    s_mov_b32 s50, 0x30800000
    s_mov_b32 s51, 0x4e800000
    s_waitcnt lgkmcnt(2)
    v_add_f32 v112, v112, v113
    v_add_f32 v114, v114, v115
    v_add_f32 v112, v112, v114
    s_waitcnt lgkmcnt(1)
    v_add_f32 v116, v116, v117
    v_add_f32 v118, v118, v119
    v_add_f32 v116, v116, v118
    s_waitcnt lgkmcnt(0)
    v_add_f32 v120, v120, v121
    v_add_f32 v122, v122, v123
    v_add_f32 v120, v120, v122
    v_min3_f32 v113, v112, v116, v120
    v_max3_f32 v114, v112, v116, v120
    v_cmp_u_f32 vcc, v112, v116
    v_cmp_u_f32 s[0:1], v120, v120
    s_or_b64 s[0:1], vcc, s[0:1]
    v_cmp_nle_f32 vcc, s50, v113
    s_or_b64 s[0:1], vcc, s[0:1]
    v_cmp_nge_f32 vcc, s51, v114
    s_or_b64 s[0:1], vcc, s[0:1]
    v_rcp_f32 v124, v112
    v_rcp_f32 v125, v112
    v_rcp_f32 v126, v116
    v_rcp_f32 v127, v116
    v_rcp_f32 v128, v120
    v_rcp_f32 v129, v120
    s_waitcnt vmcnt(0)
    s_nop 15
    s_branch L_epi1

.section .rodata,"a"
.p2align 6
.amdhsa_kernel concat_heads__gqa_block_cached__mha_block_cached__near_ridge_kernel
  .amdhsa_next_free_vgpr 512
  .amdhsa_next_free_sgpr 102
  .amdhsa_accum_offset 256
  .amdhsa_group_segment_fixed_size 0
  .amdhsa_kernarg_size 104
  .amdhsa_user_sgpr_count 2
  .amdhsa_user_sgpr_kernarg_segment_ptr 1
  .amdhsa_system_sgpr_workgroup_id_x 1
.end_amdhsa_kernel
```
